```python
import torch

def _softmax(x, axis=-1):
    return torch.softmax(x, dim=axis)
def _gelu(x):
    return torch.nn.functional.gelu(x, approximate="tanh")
def _silu(x):
    return torch.nn.functional.silu(x)
def _sigmoid(x):
    return torch.sigmoid(x)
def _layernorm(x, axis=-1, eps=1e-5):
    m = x.mean(dim=axis, keepdim=True)
    v = x.var(dim=axis, keepdim=True, unbiased=False)
    return (x - m) / torch.sqrt(v + eps)
def _scatter_add(tgt, idx, src, axis=0):
    return tgt.clone().index_add_(axis, idx, src)
def _segment_sum(src, seg, n):
    out = torch.zeros((n,) + src.shape[1:], dtype=src.dtype)
    return out.index_add_(0, seg, src)
def _pad(x, pw):
    flat = tuple(v for pair in reversed(pw) for v in pair)
    return torch.nn.functional.pad(x, flat)

kernel_name = 'interleave_layers__spectral_fnet__glu_gated_glu__prompt'

def setup_inputs():

    _w = (lambda a: (lambda t: t.to(torch.bfloat16) if t.is_floating_point() else t)(torch.as_tensor(a)))
    def _A_setup():
        B, S, D = 1, 2048, 576
        ns = torch.arange(S)[:, None] * torch.arange(S)[None, :]
        nd = torch.arange(D)[:, None] * torch.arange(D)[None, :]
        Ws_re = torch.cos(-2.0 * torch.pi * ns / S).to(float)
        Ws_im = torch.sin(-2.0 * torch.pi * ns / S).to(float)
        Wd_re = torch.cos(-2.0 * torch.pi * nd / D).to(float)
        Wd_im = torch.sin(-2.0 * torch.pi * nd / D).to(float)
        return {
            "x": _w((lambda *s: torch.randn(*s, dtype=torch.bfloat16) * 0.05)(B, S, D)),
            "dft_seq_re": _w(Ws_re),
            "dft_seq_im": _w(Ws_im),
            "dft_hid_re": _w(Wd_re),
            "dft_hid_im": _w(Wd_im),
        }
    _A_in = _A_setup()

    def _B_setup():
        B, S, D, F = 1, 2048, 576, 4608
        return {
            "x": _w((lambda *s: torch.randn(*s, dtype=torch.bfloat16) * 0.05)(B, S, D)),
            "w_gate": _w((lambda *s: torch.randn(*s, dtype=torch.bfloat16) * 1.6)(D, F)),
            "w_up": _w((lambda *s: torch.randn(*s, dtype=torch.bfloat16) * 0.4)(D, F)),
            "w_down": _w((lambda *s: torch.randn(*s, dtype=torch.bfloat16) * 0.4)(F, D)),
        }
    _B_in = _B_setup()

    return {
        "A_x": _A_in["x"],
        "A_dft_seq_re": _A_in["dft_seq_re"],
        "A_dft_seq_im": _A_in["dft_seq_im"],
        "A_dft_hid_re": _A_in["dft_hid_re"],
        "A_dft_hid_im": _A_in["dft_hid_im"],
        "B_x": _B_in["x"],
        "B_w_gate": _B_in["w_gate"],
        "B_w_up": _B_in["w_up"],
        "B_w_down": _B_in["w_down"],
    }

def reference(A_x, A_dft_seq_re, A_dft_seq_im, A_dft_hid_re, A_dft_hid_im, B_x, B_w_gate, B_w_up, B_w_down):
    def _A_ref(x, dft_seq_re, dft_seq_im, dft_hid_re, dft_hid_im):
        a = torch.einsum("bsd,ed->bse", x, dft_hid_re)
        b = torch.einsum("bsd,ed->bse", x, dft_hid_im)
        y = torch.einsum("ts,bse->bte", dft_seq_re, a) - torch.einsum("ts,bse->bte", dft_seq_im, b)
        return y

    def _B_ref(x, w_gate, w_up, w_down):
        g = torch.einsum("bsd,df->bsf", x, w_gate)
        u = torch.einsum("bsd,df->bsf", x, w_up)
        h = _sigmoid(g) * u
        return torch.einsum("bsf,fd->bsd", h, w_down)

    x = A_x
    x = x + _A_ref(_layernorm(x, axis=-1), A_dft_seq_re, A_dft_seq_im, A_dft_hid_re, A_dft_hid_im)
    x = x + _B_ref(_layernorm(x, axis=-1), B_w_gate, B_w_up, B_w_down)
    x = x + _A_ref(_layernorm(x, axis=-1), A_dft_seq_re, A_dft_seq_im, A_dft_hid_re, A_dft_hid_im)
    x = x + _B_ref(_layernorm(x, axis=-1), B_w_gate, B_w_up, B_w_down)
    return x
```

```asm
; @launch kernel=mega_kernel grid=(256,1,1) block=(512,1,1) lds=159744
.amdgcn_target "amdgcn-amd-amdhsa--gfx950"
.text
.globl mega_kernel
.p2align 8
.type mega_kernel,@function
mega_kernel:
 s_cmp_ge_u32 s2, 256
 s_cbranch_scc1 mega_exit
mega_p0:
 s_mov_b32 s72, 91045888
 s_mov_b32 s100, 0
 s_branch kh1_body
mega_p1:
 s_mov_b32 s70, 0
 s_mov_b32 s71, 2363392
 s_mov_b32 s72, 9719808
 s_mov_b32 s73, 0
 s_mov_b32 s75, 50401280
 s_mov_b32 s68, 91045888
 s_mov_b32 s69, 0
 s_mov_b32 s64, 319488
 s_mov_b32 s65, 262144
 s_mov_b32 s100, 1
 s_branch ks_body
mega_p2:
 s_mov_b32 s70, 2363392
 s_mov_b32 s71, 9719808
 s_mov_b32 s72, 95768576
 s_mov_b32 s64, 262144
 s_mov_b32 s65, 270336
 s_mov_b32 s100, 2
 s_branch kg_body
mega_p3:
 s_mov_b32 s70, 2363392
 s_mov_b32 s71, 4726784
 s_mov_b32 s72, 9986048
 s_mov_b32 s73, 0
 s_mov_b32 s75, 59838464
 s_mov_b32 s68, 95768576
 s_mov_b32 s69, 65536
 s_mov_b32 s64, 270336
 s_mov_b32 s65, 278528
 s_mov_b32 s100, 3
 s_branch kd_body
mega_p4:
 s_mov_b32 s70, 4726784
 s_mov_b32 s71, 9986048
 s_mov_b32 s72, 10518528
 s_mov_b32 s64, 278528
 s_mov_b32 s65, 286720
 s_mov_b32 s100, 4
 s_branch kh_body
mega_p5:
 s_mov_b32 s70, 4726784
 s_mov_b32 s71, 7090176
 s_mov_b32 s72, 10252288
 s_mov_b32 s73, 0
 s_mov_b32 s75, 69275648
 s_mov_b32 s68, 10518528
 s_mov_b32 s69, 131072
 s_mov_b32 s64, 286720
 s_mov_b32 s65, 294912
 s_mov_b32 s100, 5
 s_branch ks_body
mega_p6:
 s_mov_b32 s70, 7090176
 s_mov_b32 s71, 10252288
 s_mov_b32 s72, 15241216
 s_mov_b32 s64, 294912
 s_mov_b32 s65, 303104
 s_mov_b32 s100, 6
 s_branch kg_body
mega_p7:
 s_mov_b32 s70, 7090176
 s_mov_b32 s71, 4726784
 s_mov_b32 s72, 9986048
 s_mov_b32 s73, 1
 s_mov_b32 s75, 78712832
 s_mov_b32 s68, 15241216
 s_mov_b32 s69, 196608
 s_mov_b32 s64, 303104
 s_mov_b32 s65, 311296
 s_mov_b32 s100, 7
 s_branch kd_body
mega_exit:
 s_endpgm
.p2align 6
kh1_body:
 s_load_dwordx4 s[8:11], s[0:1], 24
 s_load_dwordx2 s[18:19], s[0:1], 88
 s_load_dwordx2 s[6:7], s[0:1], 0
 s_load_dwordx4 s[12:15], s[0:1], 48
 s_load_dwordx2 s[16:17], s[0:1], 64
 s_load_dwordx4 s[60:63], s[0:1], 8
 v_lshrrev_b32 v1, 6, v0
 v_and_b32 v2, 63, v0
 v_readfirstlane_b32 s20, v1
 s_and_b32 s21, s2, 7
 s_lshr_b32 s22, s2, 3
 s_lshl_b32 s21, s21, 1
 s_and_b32 s23, s22, 1
 s_add_u32 s21, s21, s23
 s_mov_b32 s55, s21
 s_lshr_b32 s22, s22, 1
 s_mov_b32 s54, s22
 s_and_b32 s23, s22, 7
 s_lshr_b32 s22, s22, 3
 s_lshl_b32 s21, s21, 2
 s_add_u32 s21, s21, s20
 s_waitcnt lgkmcnt(0)
 s_add_u32 s76, s18, 90517504
 s_addc_u32 s77, s19, 0
 s_and_b32 s77, s77, 0xffff
 s_mov_b32 s78, 524288
 s_mov_b32 s79, 0x00020000
 s_mov_b32 s101, 1
 s_cmp_ge_u32 s20, 4
 s_cbranch_scc1 kh1_rep
 s_cmp_eq_u32 s22, 1
 s_cselect_b32 s4, s10, s8
 s_cselect_b32 s5, s11, s9
 s_mov_b32 s24, s4
 s_and_b32 s25, s5, 0xffff
 s_mov_b32 s26, 663552
 s_mov_b32 s27, 0x00020000
 s_mov_b32 s28, s6
 s_and_b32 s29, s7, 0xffff
 s_mov_b32 s30, 2359296
 s_mov_b32 s31, 0x00020000
 s_add_u32 s32, s18, 0
 s_addc_u32 s33, s19, 0
 s_and_b32 s33, s33, 0xffff
 s_mov_b32 s34, 2359296
 s_mov_b32 s35, 0x00020000
 s_add_u32 s36, s18, 50388992
 s_addc_u32 s37, s19, 0
 s_and_b32 s37, s37, 0xffff
 s_mov_b32 s38, 5120
 s_mov_b32 s39, 0x00020000
 s_add_u32 s40, s18, s72
 s_addc_u32 s41, s19, 0
 s_and_b32 s41, s41, 0xffff
 s_mov_b32 s42, 4718592
 s_mov_b32 s43, 0x00020000
 v_lshrrev_b32 v3, 3, v2
 v_and_b32 v4, 7, v2
 v_lshrrev_b32 v5, 1, v3
 v_xor_b32 v5, v5, v4
 v_lshlrev_b32 v5, 4, v5
 v_lshrrev_b32 v6, 2, v3
 v_and_b32 v7, 3, v3
 v_lshl_add_u32 v6, v6, 3, v7
 v_mul_u32_u24 v6, 1152, v6
 v_add_u32 v8, v6, v5
 v_xor_b32 v7, 64, v5
 v_add_u32 v9, v6, v7
 v_mul_u32_u24 v6, 1152, v3
 v_add_u32 v10, v6, v5
 v_and_b32 v11, 15, v2
 v_lshrrev_b32 v12, 4, v2
 v_lshlrev_b32 v13, 9, v12
 v_lshl_add_u32 v13, v11, 4, v13
 s_mul_i32 s48, s23, 82944
 s_lshl_b32 s49, s20, 7
 s_add_u32 s48, s48, s49
 s_mul_i32 s49, s20, 9216
 v_lshrrev_b32 v14, 4, v2
 v_bfe_u32 v15, v2, 2, 2
 v_lshl_add_u32 v14, v14, 3, v15
 v_mul_u32_u24 v14, 1152, v14
 v_and_b32 v15, 3, v2
 v_lshl_add_u32 v14, v15, 4, v14
 v_add_u32 v15, 4608, v14
 v_lshl_add_u32 v7, v11, 2, v12
 s_lshl_b32 s50, s20, 11
 s_add_u32 s50, s50, 151552
 v_lshl_add_u32 v7, v7, 4, s50
 v_lshl_add_u32 v5, v2, 4, s50
 s_mul_i32 s44, s21, 36864
 s_mov_b32 s45, s44
 s_mov_b32 s46, s44
 s_add_u32 m0, s49, 0
 s_add_u32 s50, s48, 0
 buffer_load_dwordx4 v8, s[24:27], s50 offen lds
 s_add_u32 m0, s49, 1024
 s_add_u32 s50, s48, 18432
 buffer_load_dwordx4 v9, s[24:27], s50 offen lds
 s_add_u32 m0, s49, 2048
 s_add_u32 s50, s48, 4608
 buffer_load_dwordx4 v8, s[24:27], s50 offen lds
 s_add_u32 m0, s49, 3072
 s_add_u32 s50, s48, 23040
 buffer_load_dwordx4 v9, s[24:27], s50 offen lds
 s_add_u32 m0, s49, 4096
 s_add_u32 s50, s48, 36864
 buffer_load_dwordx4 v8, s[24:27], s50 offen lds
 s_add_u32 m0, s49, 5120
 s_add_u32 s50, s48, 55296
 buffer_load_dwordx4 v9, s[24:27], s50 offen lds
 s_add_u32 m0, s49, 6144
 s_add_u32 s50, s48, 41472
 buffer_load_dwordx4 v8, s[24:27], s50 offen lds
 s_add_u32 m0, s49, 7168
 s_add_u32 s50, s48, 59904
 buffer_load_dwordx4 v9, s[24:27], s50 offen lds
 s_add_u32 m0, s49, 8192
 s_add_u32 s50, s48, 73728
 buffer_load_dwordx4 v10, s[24:27], s50 offen lds
 s_add_u32 s48, s48, 512
 s_add_u32 s49, s49, 36864
 buffer_load_dwordx4 v[16:19], v14, s[28:31], s44 offen offset:0
 buffer_load_dwordx4 v[20:23], v15, s[28:31], s44 offen offset:0
 buffer_load_dwordx4 v[24:27], v14, s[28:31], s44 offen offset:64
 buffer_load_dwordx4 v[28:31], v15, s[28:31], s44 offen offset:64
 s_add_u32 m0, s49, 0
 s_add_u32 s50, s48, 0
 buffer_load_dwordx4 v8, s[24:27], s50 offen lds
 s_add_u32 m0, s49, 1024
 s_add_u32 s50, s48, 18432
 buffer_load_dwordx4 v9, s[24:27], s50 offen lds
 s_add_u32 m0, s49, 2048
 s_add_u32 s50, s48, 4608
 buffer_load_dwordx4 v8, s[24:27], s50 offen lds
 s_add_u32 m0, s49, 3072
 s_add_u32 s50, s48, 23040
 buffer_load_dwordx4 v9, s[24:27], s50 offen lds
 s_add_u32 m0, s49, 4096
 s_add_u32 s50, s48, 36864
 buffer_load_dwordx4 v8, s[24:27], s50 offen lds
 s_add_u32 m0, s49, 5120
 s_add_u32 s50, s48, 55296
 buffer_load_dwordx4 v9, s[24:27], s50 offen lds
 s_add_u32 m0, s49, 6144
 s_add_u32 s50, s48, 41472
 buffer_load_dwordx4 v8, s[24:27], s50 offen lds
 s_add_u32 m0, s49, 7168
 s_add_u32 s50, s48, 59904
 buffer_load_dwordx4 v9, s[24:27], s50 offen lds
 s_add_u32 m0, s49, 8192
 s_add_u32 s50, s48, 73728
 buffer_load_dwordx4 v10, s[24:27], s50 offen lds
 s_add_u32 s48, s48, 512
 s_add_u32 s49, s49, 36864
 buffer_load_dwordx4 v[32:35], v14, s[28:31], s44 offen offset:128
 buffer_load_dwordx4 v[36:39], v15, s[28:31], s44 offen offset:128
 buffer_load_dwordx4 v[40:43], v14, s[28:31], s44 offen offset:192
 buffer_load_dwordx4 v[44:47], v15, s[28:31], s44 offen offset:192
 buffer_load_dwordx4 v[48:51], v14, s[28:31], s44 offen offset:256
 buffer_load_dwordx4 v[52:55], v15, s[28:31], s44 offen offset:256
 buffer_load_dwordx4 v[56:59], v14, s[28:31], s44 offen offset:320
 buffer_load_dwordx4 v[60:63], v15, s[28:31], s44 offen offset:320
 buffer_load_dwordx4 v[64:67], v14, s[28:31], s44 offen offset:384
 buffer_load_dwordx4 v[68:71], v15, s[28:31], s44 offen offset:384
 buffer_load_dwordx4 v[72:75], v14, s[28:31], s44 offen offset:448
 buffer_load_dwordx4 v[76:79], v15, s[28:31], s44 offen offset:448
 buffer_load_dwordx4 v[80:83], v14, s[28:31], s44 offen offset:512
 buffer_load_dwordx4 v[84:87], v15, s[28:31], s44 offen offset:512
 buffer_load_dwordx4 v[88:91], v14, s[28:31], s44 offen offset:576
 buffer_load_dwordx4 v[92:95], v15, s[28:31], s44 offen offset:576
 buffer_load_dwordx4 v[96:99], v14, s[28:31], s44 offen offset:640
 buffer_load_dwordx4 v[100:103], v15, s[28:31], s44 offen offset:640
 v_mov_b32 v152, 0
 v_mov_b32 v153, 0
 v_mov_b32 v154, 0
 v_mov_b32 v155, 0
 v_mov_b32 v156, 0
 v_mov_b32 v157, 0
 v_mov_b32 v158, 0
 v_mov_b32 v159, 0
 v_mov_b32 v160, 0
 v_mov_b32 v161, 0
 v_mov_b32 v162, 0
 v_mov_b32 v163, 0
 v_mov_b32 v164, 0
 v_mov_b32 v165, 0
 v_mov_b32 v166, 0
 v_mov_b32 v167, 0
 v_mov_b32 v168, 0
 v_mov_b32 v169, 0
 v_mov_b32 v170, 0
 v_mov_b32 v171, 0
 v_mov_b32 v172, 0
 v_mov_b32 v173, 0
 v_mov_b32 v174, 0
 v_mov_b32 v175, 0
 v_mov_b32 v176, 0
 v_mov_b32 v177, 0
 v_mov_b32 v178, 0
 v_mov_b32 v179, 0
 v_mov_b32 v180, 0
 v_mov_b32 v181, 0
 v_mov_b32 v182, 0
 v_mov_b32 v183, 0
 v_mov_b32 v184, 0
 v_mov_b32 v185, 0
 v_mov_b32 v186, 0
 v_mov_b32 v187, 0
 v_mov_b32 v188, 0
 v_mov_b32 v189, 0
 v_mov_b32 v190, 0
 v_mov_b32 v191, 0
 v_mov_b32 v192, 0
 v_mov_b32 v193, 0
 v_mov_b32 v194, 0
 v_mov_b32 v195, 0
 v_mov_b32 v196, 0
 v_mov_b32 v197, 0
 v_mov_b32 v198, 0
 v_mov_b32 v199, 0
 v_mov_b32 v200, 0
 v_mov_b32 v201, 0
 v_mov_b32 v202, 0
 v_mov_b32 v203, 0
 v_mov_b32 v204, 0
 v_mov_b32 v205, 0
 v_mov_b32 v206, 0
 v_mov_b32 v207, 0
 v_mov_b32 v208, 0
 v_mov_b32 v209, 0
 v_mov_b32 v210, 0
 v_mov_b32 v211, 0
 v_mov_b32 v212, 0x3f803f80
 v_mov_b32 v213, 0x3f803f80
 v_mov_b32 v214, 0x3f803f80
 v_mov_b32 v215, 0x3f803f80
 v_mov_b32 v220, 0
 v_mov_b32 v221, 0
 v_mov_b32 v222, 0
 v_mov_b32 v223, 0
 v_mov_b32 v224, 0
 v_mov_b32 v225, 0
 v_mov_b32 v226, 0
 v_mov_b32 v227, 0
 v_mov_b32 v248, 0
 v_mov_b32 v249, 0
 v_mov_b32 v250, 0
 v_mov_b32 v251, 0
 v_mov_b32 v252, 0
 v_mov_b32 v253, 0
 v_mov_b32 v254, 0
 v_mov_b32 v255, 0
 v_lshrrev_b32 v1, 1, v11
 v_xor_b32 v1, v1, v12
 v_lshlrev_b32 v1, 4, v1
 v_lshl_add_u32 v216, v11, 7, v1
 v_xor_b32 v217, 64, v216
 v_add_u32 v218, 46080, v216
 v_add_u32 v219, 46080, v217
 s_waitcnt vmcnt(31)
 s_barrier
 s_waitcnt vmcnt(29)
 ds_write_b128 v5, v[16:19] offset:0
 ds_write_b128 v5, v[20:23] offset:1024
 ds_read_b128 v[16:19], v7 offset:0
 ds_read_b128 v[20:23], v7 offset:1024
 ds_read_b128 v[112:115], v216 offset:0
 ds_read_b128 v[116:119], v216 offset:2048
 ds_read_b128 v[120:123], v216 offset:4096
 ds_read_b128 v[124:127], v216 offset:6144
 ds_read_b128 v[128:131], v216 offset:8192
 buffer_load_dwordx4 v[104:107], v14, s[28:31], s44 offen offset:704
 buffer_load_dwordx4 v[108:111], v15, s[28:31], s44 offen offset:704
 s_waitcnt lgkmcnt(0)
 s_waitcnt vmcnt(29)
 ds_write_b128 v5, v[24:27] offset:0
 ds_write_b128 v5, v[28:31] offset:1024
 ds_read_b128 v[24:27], v7 offset:0
 ds_read_b128 v[28:31], v7 offset:1024
 ds_read_b128 v[132:135], v217 offset:0
 ds_read_b128 v[136:139], v217 offset:2048
 ds_read_b128 v[140:143], v217 offset:4096
 ds_read_b128 v[144:147], v217 offset:6144
 ds_read_b128 v[148:151], v217 offset:8192
 v_mfma_f32_16x16x32_bf16 v[152:155], v[16:19], v[112:115], v[152:155]
 v_mfma_f32_16x16x32_bf16 v[156:159], v[16:19], v[116:119], v[156:159]
 v_mfma_f32_16x16x32_bf16 v[160:163], v[16:19], v[120:123], v[160:163]
 v_mfma_f32_16x16x32_bf16 v[164:167], v[16:19], v[124:127], v[164:167]
 v_mfma_f32_16x16x32_bf16 v[168:171], v[16:19], v[128:131], v[168:171]
 v_mfma_f32_16x16x32_bf16 v[248:251], v[16:19], v[212:215], v[248:251]
 v_mfma_f32_16x16x32_bf16 v[220:223], v[16:19], v[16:19], v[220:223]
 v_mfma_f32_16x16x32_bf16 v[172:175], v[20:23], v[112:115], v[172:175]
 v_mfma_f32_16x16x32_bf16 v[176:179], v[20:23], v[116:119], v[176:179]
 v_mfma_f32_16x16x32_bf16 v[180:183], v[20:23], v[120:123], v[180:183]
 v_mfma_f32_16x16x32_bf16 v[184:187], v[20:23], v[124:127], v[184:187]
 v_mfma_f32_16x16x32_bf16 v[188:191], v[20:23], v[128:131], v[188:191]
 v_mfma_f32_16x16x32_bf16 v[252:255], v[20:23], v[212:215], v[252:255]
 v_mfma_f32_16x16x32_bf16 v[224:227], v[20:23], v[20:23], v[224:227]
 buffer_load_dwordx4 v[16:19], v14, s[28:31], s44 offen offset:768
 buffer_load_dwordx4 v[20:23], v15, s[28:31], s44 offen offset:768
 s_waitcnt lgkmcnt(0)
 s_waitcnt vmcnt(20)
 ds_write_b128 v5, v[32:35] offset:0
 ds_write_b128 v5, v[36:39] offset:1024
 ds_read_b128 v[32:35], v7 offset:0
 ds_read_b128 v[36:39], v7 offset:1024
 ds_read_b128 v[112:115], v216 offset:9216
 ds_read_b128 v[116:119], v216 offset:11264
 ds_read_b128 v[120:123], v216 offset:13312
 ds_read_b128 v[124:127], v216 offset:15360
 ds_read_b128 v[128:131], v216 offset:17408
 v_mfma_f32_16x16x32_bf16 v[152:155], v[24:27], v[132:135], v[152:155]
 v_mfma_f32_16x16x32_bf16 v[156:159], v[24:27], v[136:139], v[156:159]
 v_mfma_f32_16x16x32_bf16 v[160:163], v[24:27], v[140:143], v[160:163]
 v_mfma_f32_16x16x32_bf16 v[164:167], v[24:27], v[144:147], v[164:167]
 v_mfma_f32_16x16x32_bf16 v[168:171], v[24:27], v[148:151], v[168:171]
 v_mfma_f32_16x16x32_bf16 v[248:251], v[24:27], v[212:215], v[248:251]
 v_mfma_f32_16x16x32_bf16 v[220:223], v[24:27], v[24:27], v[220:223]
 v_mfma_f32_16x16x32_bf16 v[172:175], v[28:31], v[132:135], v[172:175]
 v_mfma_f32_16x16x32_bf16 v[176:179], v[28:31], v[136:139], v[176:179]
 v_mfma_f32_16x16x32_bf16 v[180:183], v[28:31], v[140:143], v[180:183]
 v_mfma_f32_16x16x32_bf16 v[184:187], v[28:31], v[144:147], v[184:187]
 v_mfma_f32_16x16x32_bf16 v[188:191], v[28:31], v[148:151], v[188:191]
 v_mfma_f32_16x16x32_bf16 v[252:255], v[28:31], v[212:215], v[252:255]
 v_mfma_f32_16x16x32_bf16 v[224:227], v[28:31], v[28:31], v[224:227]
 buffer_load_dwordx4 v[24:27], v14, s[28:31], s44 offen offset:832
 buffer_load_dwordx4 v[28:31], v15, s[28:31], s44 offen offset:832
 s_waitcnt lgkmcnt(0)
 s_waitcnt vmcnt(20)
 ds_write_b128 v5, v[40:43] offset:0
 ds_write_b128 v5, v[44:47] offset:1024
 ds_read_b128 v[40:43], v7 offset:0
 ds_read_b128 v[44:47], v7 offset:1024
 ds_read_b128 v[132:135], v217 offset:9216
 ds_read_b128 v[136:139], v217 offset:11264
 ds_read_b128 v[140:143], v217 offset:13312
 ds_read_b128 v[144:147], v217 offset:15360
 ds_read_b128 v[148:151], v217 offset:17408
 v_mfma_f32_16x16x32_bf16 v[152:155], v[32:35], v[112:115], v[152:155]
 v_mfma_f32_16x16x32_bf16 v[156:159], v[32:35], v[116:119], v[156:159]
 v_mfma_f32_16x16x32_bf16 v[160:163], v[32:35], v[120:123], v[160:163]
 v_mfma_f32_16x16x32_bf16 v[164:167], v[32:35], v[124:127], v[164:167]
 v_mfma_f32_16x16x32_bf16 v[168:171], v[32:35], v[128:131], v[168:171]
 v_mfma_f32_16x16x32_bf16 v[248:251], v[32:35], v[212:215], v[248:251]
 v_mfma_f32_16x16x32_bf16 v[220:223], v[32:35], v[32:35], v[220:223]
 v_mfma_f32_16x16x32_bf16 v[172:175], v[36:39], v[112:115], v[172:175]
 v_mfma_f32_16x16x32_bf16 v[176:179], v[36:39], v[116:119], v[176:179]
 v_mfma_f32_16x16x32_bf16 v[180:183], v[36:39], v[120:123], v[180:183]
 v_mfma_f32_16x16x32_bf16 v[184:187], v[36:39], v[124:127], v[184:187]
 v_mfma_f32_16x16x32_bf16 v[188:191], v[36:39], v[128:131], v[188:191]
 v_mfma_f32_16x16x32_bf16 v[252:255], v[36:39], v[212:215], v[252:255]
 v_mfma_f32_16x16x32_bf16 v[224:227], v[36:39], v[36:39], v[224:227]
 buffer_load_dwordx4 v[32:35], v14, s[28:31], s44 offen offset:896
 buffer_load_dwordx4 v[36:39], v15, s[28:31], s44 offen offset:896
 s_waitcnt lgkmcnt(0)
 s_waitcnt vmcnt(20)
 ds_write_b128 v5, v[48:51] offset:0
 ds_write_b128 v5, v[52:55] offset:1024
 ds_read_b128 v[48:51], v7 offset:0
 ds_read_b128 v[52:55], v7 offset:1024
 ds_read_b128 v[112:115], v216 offset:18432
 ds_read_b128 v[116:119], v216 offset:20480
 ds_read_b128 v[120:123], v216 offset:22528
 ds_read_b128 v[124:127], v216 offset:24576
 ds_read_b128 v[128:131], v216 offset:26624
 v_mfma_f32_16x16x32_bf16 v[152:155], v[40:43], v[132:135], v[152:155]
 v_mfma_f32_16x16x32_bf16 v[156:159], v[40:43], v[136:139], v[156:159]
 v_mfma_f32_16x16x32_bf16 v[160:163], v[40:43], v[140:143], v[160:163]
 v_mfma_f32_16x16x32_bf16 v[164:167], v[40:43], v[144:147], v[164:167]
 v_mfma_f32_16x16x32_bf16 v[168:171], v[40:43], v[148:151], v[168:171]
 v_mfma_f32_16x16x32_bf16 v[248:251], v[40:43], v[212:215], v[248:251]
 v_mfma_f32_16x16x32_bf16 v[220:223], v[40:43], v[40:43], v[220:223]
 v_mfma_f32_16x16x32_bf16 v[172:175], v[44:47], v[132:135], v[172:175]
 v_mfma_f32_16x16x32_bf16 v[176:179], v[44:47], v[136:139], v[176:179]
 v_mfma_f32_16x16x32_bf16 v[180:183], v[44:47], v[140:143], v[180:183]
 v_mfma_f32_16x16x32_bf16 v[184:187], v[44:47], v[144:147], v[184:187]
 v_mfma_f32_16x16x32_bf16 v[188:191], v[44:47], v[148:151], v[188:191]
 v_mfma_f32_16x16x32_bf16 v[252:255], v[44:47], v[212:215], v[252:255]
 v_mfma_f32_16x16x32_bf16 v[224:227], v[44:47], v[44:47], v[224:227]
 buffer_load_dwordx4 v[40:43], v14, s[28:31], s44 offen offset:960
 buffer_load_dwordx4 v[44:47], v15, s[28:31], s44 offen offset:960
 s_waitcnt lgkmcnt(0)
 s_waitcnt vmcnt(20)
 ds_write_b128 v5, v[56:59] offset:0
 ds_write_b128 v5, v[60:63] offset:1024
 ds_read_b128 v[56:59], v7 offset:0
 ds_read_b128 v[60:63], v7 offset:1024
 ds_read_b128 v[132:135], v217 offset:18432
 ds_read_b128 v[136:139], v217 offset:20480
 ds_read_b128 v[140:143], v217 offset:22528
 ds_read_b128 v[144:147], v217 offset:24576
 ds_read_b128 v[148:151], v217 offset:26624
 v_mfma_f32_16x16x32_bf16 v[152:155], v[48:51], v[112:115], v[152:155]
 v_mfma_f32_16x16x32_bf16 v[156:159], v[48:51], v[116:119], v[156:159]
 v_mfma_f32_16x16x32_bf16 v[160:163], v[48:51], v[120:123], v[160:163]
 v_mfma_f32_16x16x32_bf16 v[164:167], v[48:51], v[124:127], v[164:167]
 v_mfma_f32_16x16x32_bf16 v[168:171], v[48:51], v[128:131], v[168:171]
 v_mfma_f32_16x16x32_bf16 v[248:251], v[48:51], v[212:215], v[248:251]
 v_mfma_f32_16x16x32_bf16 v[220:223], v[48:51], v[48:51], v[220:223]
 v_mfma_f32_16x16x32_bf16 v[172:175], v[52:55], v[112:115], v[172:175]
 v_mfma_f32_16x16x32_bf16 v[176:179], v[52:55], v[116:119], v[176:179]
 v_mfma_f32_16x16x32_bf16 v[180:183], v[52:55], v[120:123], v[180:183]
 v_mfma_f32_16x16x32_bf16 v[184:187], v[52:55], v[124:127], v[184:187]
 v_mfma_f32_16x16x32_bf16 v[188:191], v[52:55], v[128:131], v[188:191]
 v_mfma_f32_16x16x32_bf16 v[252:255], v[52:55], v[212:215], v[252:255]
 v_mfma_f32_16x16x32_bf16 v[224:227], v[52:55], v[52:55], v[224:227]
 buffer_load_dwordx4 v[48:51], v14, s[28:31], s44 offen offset:1024
 buffer_load_dwordx4 v[52:55], v15, s[28:31], s44 offen offset:1024
 s_waitcnt lgkmcnt(0)
 s_waitcnt vmcnt(20)
 ds_write_b128 v5, v[64:67] offset:0
 ds_write_b128 v5, v[68:71] offset:1024
 ds_read_b128 v[64:67], v7 offset:0
 ds_read_b128 v[68:71], v7 offset:1024
 ds_read_b128 v[112:115], v216 offset:27648
 ds_read_b128 v[116:119], v216 offset:29696
 ds_read_b128 v[120:123], v216 offset:31744
 ds_read_b128 v[124:127], v216 offset:33792
 ds_read_b128 v[128:131], v216 offset:35840
 v_mfma_f32_16x16x32_bf16 v[152:155], v[56:59], v[132:135], v[152:155]
 v_mfma_f32_16x16x32_bf16 v[156:159], v[56:59], v[136:139], v[156:159]
 v_mfma_f32_16x16x32_bf16 v[160:163], v[56:59], v[140:143], v[160:163]
 v_mfma_f32_16x16x32_bf16 v[164:167], v[56:59], v[144:147], v[164:167]
 v_mfma_f32_16x16x32_bf16 v[168:171], v[56:59], v[148:151], v[168:171]
 v_mfma_f32_16x16x32_bf16 v[248:251], v[56:59], v[212:215], v[248:251]
 v_mfma_f32_16x16x32_bf16 v[220:223], v[56:59], v[56:59], v[220:223]
 v_mfma_f32_16x16x32_bf16 v[172:175], v[60:63], v[132:135], v[172:175]
 v_mfma_f32_16x16x32_bf16 v[176:179], v[60:63], v[136:139], v[176:179]
 v_mfma_f32_16x16x32_bf16 v[180:183], v[60:63], v[140:143], v[180:183]
 v_mfma_f32_16x16x32_bf16 v[184:187], v[60:63], v[144:147], v[184:187]
 v_mfma_f32_16x16x32_bf16 v[188:191], v[60:63], v[148:151], v[188:191]
 v_mfma_f32_16x16x32_bf16 v[252:255], v[60:63], v[212:215], v[252:255]
 v_mfma_f32_16x16x32_bf16 v[224:227], v[60:63], v[60:63], v[224:227]
 buffer_load_dwordx4 v[56:59], v14, s[28:31], s44 offen offset:1088
 buffer_load_dwordx4 v[60:63], v15, s[28:31], s44 offen offset:1088
 s_waitcnt lgkmcnt(0)
 s_waitcnt vmcnt(20)
 ds_write_b128 v5, v[72:75] offset:0
 ds_write_b128 v5, v[76:79] offset:1024
 ds_read_b128 v[72:75], v7 offset:0
 ds_read_b128 v[76:79], v7 offset:1024
 ds_read_b128 v[132:135], v217 offset:27648
 ds_read_b128 v[136:139], v217 offset:29696
 ds_read_b128 v[140:143], v217 offset:31744
 ds_read_b128 v[144:147], v217 offset:33792
 ds_read_b128 v[148:151], v217 offset:35840
 v_mfma_f32_16x16x32_bf16 v[152:155], v[64:67], v[112:115], v[152:155]
 v_mfma_f32_16x16x32_bf16 v[156:159], v[64:67], v[116:119], v[156:159]
 v_mfma_f32_16x16x32_bf16 v[160:163], v[64:67], v[120:123], v[160:163]
 v_mfma_f32_16x16x32_bf16 v[164:167], v[64:67], v[124:127], v[164:167]
 v_mfma_f32_16x16x32_bf16 v[168:171], v[64:67], v[128:131], v[168:171]
 v_mfma_f32_16x16x32_bf16 v[248:251], v[64:67], v[212:215], v[248:251]
 v_mfma_f32_16x16x32_bf16 v[220:223], v[64:67], v[64:67], v[220:223]
 v_mfma_f32_16x16x32_bf16 v[172:175], v[68:71], v[112:115], v[172:175]
 v_mfma_f32_16x16x32_bf16 v[176:179], v[68:71], v[116:119], v[176:179]
 v_mfma_f32_16x16x32_bf16 v[180:183], v[68:71], v[120:123], v[180:183]
 v_mfma_f32_16x16x32_bf16 v[184:187], v[68:71], v[124:127], v[184:187]
 v_mfma_f32_16x16x32_bf16 v[188:191], v[68:71], v[128:131], v[188:191]
 v_mfma_f32_16x16x32_bf16 v[252:255], v[68:71], v[212:215], v[252:255]
 v_mfma_f32_16x16x32_bf16 v[224:227], v[68:71], v[68:71], v[224:227]
 s_barrier
 s_and_b32 s50, s20, 1
 s_cmp_eq_u32 s50, 1
 s_cselect_b64 vcc, -1, 0
 v_cndmask_b32 v1, v8, v9, vcc
 s_lshl_b32 s50, s50, 4
 s_lshr_b32 s51, s20, 1
 s_lshl_b32 s51, s51, 2
 s_add_u32 s50, s50, s51
 s_mul_i32 s50, s50, 1152
 s_mul_i32 s48, s23, 82944
 s_add_u32 s48, s48, 1024
 s_add_u32 s50, s50, s48
 s_lshl_b32 s51, s20, 10
 s_add_u32 s51, s51, 0
 s_mov_b32 m0, s51
 s_nop 0
 buffer_load_dwordx4 v1, s[24:27], s50 offen lds
 s_add_u32 m0, s51, 4096
 s_add_u32 s50, s50, 36864
 buffer_load_dwordx4 v1, s[24:27], s50 offen lds
 s_mov_b32 m0, 8192
 s_add_u32 s50, s48, 73728
 s_lshl_b32 s51, s20, 4
 s_mov_b64 exec, 0xffff
 s_lshl_b64 exec, exec, s51
 buffer_load_dwordx4 v10, s[24:27], s50 offen lds
 s_mov_b64 exec, -1
 s_waitcnt lgkmcnt(0)
 s_waitcnt vmcnt(21)
 ds_write_b128 v5, v[80:83] offset:0
 ds_write_b128 v5, v[84:87] offset:1024
 ds_read_b128 v[80:83], v7 offset:0
 ds_read_b128 v[84:87], v7 offset:1024
 ds_read_b128 v[112:115], v216 offset:36864
 ds_read_b128 v[116:119], v216 offset:38912
 ds_read_b128 v[120:123], v216 offset:40960
 ds_read_b128 v[124:127], v216 offset:43008
 ds_read_b128 v[128:131], v216 offset:45056
 v_mfma_f32_16x16x32_bf16 v[152:155], v[72:75], v[132:135], v[152:155]
 v_mfma_f32_16x16x32_bf16 v[156:159], v[72:75], v[136:139], v[156:159]
 v_mfma_f32_16x16x32_bf16 v[160:163], v[72:75], v[140:143], v[160:163]
 v_mfma_f32_16x16x32_bf16 v[164:167], v[72:75], v[144:147], v[164:167]
 v_mfma_f32_16x16x32_bf16 v[168:171], v[72:75], v[148:151], v[168:171]
 v_mfma_f32_16x16x32_bf16 v[248:251], v[72:75], v[212:215], v[248:251]
 v_mfma_f32_16x16x32_bf16 v[220:223], v[72:75], v[72:75], v[220:223]
 v_mfma_f32_16x16x32_bf16 v[172:175], v[76:79], v[132:135], v[172:175]
 v_mfma_f32_16x16x32_bf16 v[176:179], v[76:79], v[136:139], v[176:179]
 v_mfma_f32_16x16x32_bf16 v[180:183], v[76:79], v[140:143], v[180:183]
 v_mfma_f32_16x16x32_bf16 v[184:187], v[76:79], v[144:147], v[184:187]
 v_mfma_f32_16x16x32_bf16 v[188:191], v[76:79], v[148:151], v[188:191]
 v_mfma_f32_16x16x32_bf16 v[252:255], v[76:79], v[212:215], v[252:255]
 v_mfma_f32_16x16x32_bf16 v[224:227], v[76:79], v[76:79], v[224:227]
 s_waitcnt lgkmcnt(0)
 s_waitcnt vmcnt(19)
 ds_write_b128 v5, v[88:91] offset:0
 ds_write_b128 v5, v[92:95] offset:1024
 ds_read_b128 v[88:91], v7 offset:0
 ds_read_b128 v[92:95], v7 offset:1024
 ds_read_b128 v[132:135], v217 offset:36864
 ds_read_b128 v[136:139], v217 offset:38912
 ds_read_b128 v[140:143], v217 offset:40960
 ds_read_b128 v[144:147], v217 offset:43008
 ds_read_b128 v[148:151], v217 offset:45056
 v_mfma_f32_16x16x32_bf16 v[152:155], v[80:83], v[112:115], v[152:155]
 v_mfma_f32_16x16x32_bf16 v[156:159], v[80:83], v[116:119], v[156:159]
 v_mfma_f32_16x16x32_bf16 v[160:163], v[80:83], v[120:123], v[160:163]
 v_mfma_f32_16x16x32_bf16 v[164:167], v[80:83], v[124:127], v[164:167]
 v_mfma_f32_16x16x32_bf16 v[168:171], v[80:83], v[128:131], v[168:171]
 v_mfma_f32_16x16x32_bf16 v[248:251], v[80:83], v[212:215], v[248:251]
 v_mfma_f32_16x16x32_bf16 v[220:223], v[80:83], v[80:83], v[220:223]
 v_mfma_f32_16x16x32_bf16 v[172:175], v[84:87], v[112:115], v[172:175]
 v_mfma_f32_16x16x32_bf16 v[176:179], v[84:87], v[116:119], v[176:179]
 v_mfma_f32_16x16x32_bf16 v[180:183], v[84:87], v[120:123], v[180:183]
 v_mfma_f32_16x16x32_bf16 v[184:187], v[84:87], v[124:127], v[184:187]
 v_mfma_f32_16x16x32_bf16 v[188:191], v[84:87], v[128:131], v[188:191]
 v_mfma_f32_16x16x32_bf16 v[252:255], v[84:87], v[212:215], v[252:255]
 v_mfma_f32_16x16x32_bf16 v[224:227], v[84:87], v[84:87], v[224:227]
 s_waitcnt lgkmcnt(0)
 s_waitcnt vmcnt(17)
 ds_write_b128 v5, v[96:99] offset:0
 ds_write_b128 v5, v[100:103] offset:1024
 ds_read_b128 v[96:99], v7 offset:0
 ds_read_b128 v[100:103], v7 offset:1024
 ds_read_b128 v[112:115], v218 offset:0
 ds_read_b128 v[116:119], v218 offset:2048
 ds_read_b128 v[120:123], v218 offset:4096
 ds_read_b128 v[124:127], v218 offset:6144
 ds_read_b128 v[128:131], v218 offset:8192
 v_mfma_f32_16x16x32_bf16 v[152:155], v[88:91], v[132:135], v[152:155]
 v_mfma_f32_16x16x32_bf16 v[156:159], v[88:91], v[136:139], v[156:159]
 v_mfma_f32_16x16x32_bf16 v[160:163], v[88:91], v[140:143], v[160:163]
 v_mfma_f32_16x16x32_bf16 v[164:167], v[88:91], v[144:147], v[164:167]
 v_mfma_f32_16x16x32_bf16 v[168:171], v[88:91], v[148:151], v[168:171]
 v_mfma_f32_16x16x32_bf16 v[248:251], v[88:91], v[212:215], v[248:251]
 v_mfma_f32_16x16x32_bf16 v[220:223], v[88:91], v[88:91], v[220:223]
 v_mfma_f32_16x16x32_bf16 v[172:175], v[92:95], v[132:135], v[172:175]
 v_mfma_f32_16x16x32_bf16 v[176:179], v[92:95], v[136:139], v[176:179]
 v_mfma_f32_16x16x32_bf16 v[180:183], v[92:95], v[140:143], v[180:183]
 v_mfma_f32_16x16x32_bf16 v[184:187], v[92:95], v[144:147], v[184:187]
 v_mfma_f32_16x16x32_bf16 v[188:191], v[92:95], v[148:151], v[188:191]
 v_mfma_f32_16x16x32_bf16 v[252:255], v[92:95], v[212:215], v[252:255]
 v_mfma_f32_16x16x32_bf16 v[224:227], v[92:95], v[92:95], v[224:227]
 s_waitcnt lgkmcnt(0)
 s_waitcnt vmcnt(15)
 ds_write_b128 v5, v[104:107] offset:0
 ds_write_b128 v5, v[108:111] offset:1024
 ds_read_b128 v[104:107], v7 offset:0
 ds_read_b128 v[108:111], v7 offset:1024
 ds_read_b128 v[132:135], v219 offset:0
 ds_read_b128 v[136:139], v219 offset:2048
 ds_read_b128 v[140:143], v219 offset:4096
 ds_read_b128 v[144:147], v219 offset:6144
 ds_read_b128 v[148:151], v219 offset:8192
 v_mfma_f32_16x16x32_bf16 v[152:155], v[96:99], v[112:115], v[152:155]
 v_mfma_f32_16x16x32_bf16 v[156:159], v[96:99], v[116:119], v[156:159]
 v_mfma_f32_16x16x32_bf16 v[160:163], v[96:99], v[120:123], v[160:163]
 v_mfma_f32_16x16x32_bf16 v[164:167], v[96:99], v[124:127], v[164:167]
 v_mfma_f32_16x16x32_bf16 v[168:171], v[96:99], v[128:131], v[168:171]
 v_mfma_f32_16x16x32_bf16 v[248:251], v[96:99], v[212:215], v[248:251]
 v_mfma_f32_16x16x32_bf16 v[220:223], v[96:99], v[96:99], v[220:223]
 v_mfma_f32_16x16x32_bf16 v[172:175], v[100:103], v[112:115], v[172:175]
 v_mfma_f32_16x16x32_bf16 v[176:179], v[100:103], v[116:119], v[176:179]
 v_mfma_f32_16x16x32_bf16 v[180:183], v[100:103], v[120:123], v[180:183]
 v_mfma_f32_16x16x32_bf16 v[184:187], v[100:103], v[124:127], v[184:187]
 v_mfma_f32_16x16x32_bf16 v[188:191], v[100:103], v[128:131], v[188:191]
 v_mfma_f32_16x16x32_bf16 v[252:255], v[100:103], v[212:215], v[252:255]
 v_mfma_f32_16x16x32_bf16 v[224:227], v[100:103], v[100:103], v[224:227]
 s_waitcnt lgkmcnt(0)
 s_waitcnt vmcnt(13)
 ds_write_b128 v5, v[16:19] offset:0
 ds_write_b128 v5, v[20:23] offset:1024
 ds_read_b128 v[16:19], v7 offset:0
 ds_read_b128 v[20:23], v7 offset:1024
 ds_read_b128 v[112:115], v218 offset:9216
 ds_read_b128 v[116:119], v218 offset:11264
 ds_read_b128 v[120:123], v218 offset:13312
 ds_read_b128 v[124:127], v218 offset:15360
 ds_read_b128 v[128:131], v218 offset:17408
 v_mfma_f32_16x16x32_bf16 v[152:155], v[104:107], v[132:135], v[152:155]
 v_mfma_f32_16x16x32_bf16 v[156:159], v[104:107], v[136:139], v[156:159]
 v_mfma_f32_16x16x32_bf16 v[160:163], v[104:107], v[140:143], v[160:163]
 v_mfma_f32_16x16x32_bf16 v[164:167], v[104:107], v[144:147], v[164:167]
 v_mfma_f32_16x16x32_bf16 v[168:171], v[104:107], v[148:151], v[168:171]
 v_mfma_f32_16x16x32_bf16 v[248:251], v[104:107], v[212:215], v[248:251]
 v_mfma_f32_16x16x32_bf16 v[220:223], v[104:107], v[104:107], v[220:223]
 v_mfma_f32_16x16x32_bf16 v[172:175], v[108:111], v[132:135], v[172:175]
 v_mfma_f32_16x16x32_bf16 v[176:179], v[108:111], v[136:139], v[176:179]
 v_mfma_f32_16x16x32_bf16 v[180:183], v[108:111], v[140:143], v[180:183]
 v_mfma_f32_16x16x32_bf16 v[184:187], v[108:111], v[144:147], v[184:187]
 v_mfma_f32_16x16x32_bf16 v[188:191], v[108:111], v[148:151], v[188:191]
 v_mfma_f32_16x16x32_bf16 v[252:255], v[108:111], v[212:215], v[252:255]
 v_mfma_f32_16x16x32_bf16 v[224:227], v[108:111], v[108:111], v[224:227]
 s_waitcnt lgkmcnt(0)
 s_waitcnt vmcnt(11)
 ds_write_b128 v5, v[24:27] offset:0
 ds_write_b128 v5, v[28:31] offset:1024
 ds_read_b128 v[24:27], v7 offset:0
 ds_read_b128 v[28:31], v7 offset:1024
 ds_read_b128 v[132:135], v219 offset:9216
 ds_read_b128 v[136:139], v219 offset:11264
 ds_read_b128 v[140:143], v219 offset:13312
 ds_read_b128 v[144:147], v219 offset:15360
 ds_read_b128 v[148:151], v219 offset:17408
 v_mfma_f32_16x16x32_bf16 v[152:155], v[16:19], v[112:115], v[152:155]
 v_mfma_f32_16x16x32_bf16 v[156:159], v[16:19], v[116:119], v[156:159]
 v_mfma_f32_16x16x32_bf16 v[160:163], v[16:19], v[120:123], v[160:163]
 v_mfma_f32_16x16x32_bf16 v[164:167], v[16:19], v[124:127], v[164:167]
 v_mfma_f32_16x16x32_bf16 v[168:171], v[16:19], v[128:131], v[168:171]
 v_mfma_f32_16x16x32_bf16 v[248:251], v[16:19], v[212:215], v[248:251]
 v_mfma_f32_16x16x32_bf16 v[220:223], v[16:19], v[16:19], v[220:223]
 v_mfma_f32_16x16x32_bf16 v[172:175], v[20:23], v[112:115], v[172:175]
 v_mfma_f32_16x16x32_bf16 v[176:179], v[20:23], v[116:119], v[176:179]
 v_mfma_f32_16x16x32_bf16 v[180:183], v[20:23], v[120:123], v[180:183]
 v_mfma_f32_16x16x32_bf16 v[184:187], v[20:23], v[124:127], v[184:187]
 v_mfma_f32_16x16x32_bf16 v[188:191], v[20:23], v[128:131], v[188:191]
 v_mfma_f32_16x16x32_bf16 v[252:255], v[20:23], v[212:215], v[252:255]
 v_mfma_f32_16x16x32_bf16 v[224:227], v[20:23], v[20:23], v[224:227]
 s_waitcnt lgkmcnt(0)
 s_waitcnt vmcnt(9)
 ds_write_b128 v5, v[32:35] offset:0
 ds_write_b128 v5, v[36:39] offset:1024
 ds_read_b128 v[32:35], v7 offset:0
 ds_read_b128 v[36:39], v7 offset:1024
 ds_read_b128 v[112:115], v218 offset:18432
 ds_read_b128 v[116:119], v218 offset:20480
 ds_read_b128 v[120:123], v218 offset:22528
 ds_read_b128 v[124:127], v218 offset:24576
 ds_read_b128 v[128:131], v218 offset:26624
 v_mfma_f32_16x16x32_bf16 v[152:155], v[24:27], v[132:135], v[152:155]
 v_mfma_f32_16x16x32_bf16 v[156:159], v[24:27], v[136:139], v[156:159]
 v_mfma_f32_16x16x32_bf16 v[160:163], v[24:27], v[140:143], v[160:163]
 v_mfma_f32_16x16x32_bf16 v[164:167], v[24:27], v[144:147], v[164:167]
 v_mfma_f32_16x16x32_bf16 v[168:171], v[24:27], v[148:151], v[168:171]
 v_mfma_f32_16x16x32_bf16 v[248:251], v[24:27], v[212:215], v[248:251]
 v_mfma_f32_16x16x32_bf16 v[220:223], v[24:27], v[24:27], v[220:223]
 v_mfma_f32_16x16x32_bf16 v[172:175], v[28:31], v[132:135], v[172:175]
 v_mfma_f32_16x16x32_bf16 v[176:179], v[28:31], v[136:139], v[176:179]
 v_mfma_f32_16x16x32_bf16 v[180:183], v[28:31], v[140:143], v[180:183]
 v_mfma_f32_16x16x32_bf16 v[184:187], v[28:31], v[144:147], v[184:187]
 v_mfma_f32_16x16x32_bf16 v[188:191], v[28:31], v[148:151], v[188:191]
 v_mfma_f32_16x16x32_bf16 v[252:255], v[28:31], v[212:215], v[252:255]
 v_mfma_f32_16x16x32_bf16 v[224:227], v[28:31], v[28:31], v[224:227]
 s_waitcnt lgkmcnt(0)
 s_waitcnt vmcnt(7)
 ds_write_b128 v5, v[40:43] offset:0
 ds_write_b128 v5, v[44:47] offset:1024
 ds_read_b128 v[40:43], v7 offset:0
 ds_read_b128 v[44:47], v7 offset:1024
 ds_read_b128 v[132:135], v219 offset:18432
 ds_read_b128 v[136:139], v219 offset:20480
 ds_read_b128 v[140:143], v219 offset:22528
 ds_read_b128 v[144:147], v219 offset:24576
 ds_read_b128 v[148:151], v219 offset:26624
 v_mfma_f32_16x16x32_bf16 v[152:155], v[32:35], v[112:115], v[152:155]
 v_mfma_f32_16x16x32_bf16 v[156:159], v[32:35], v[116:119], v[156:159]
 v_mfma_f32_16x16x32_bf16 v[160:163], v[32:35], v[120:123], v[160:163]
 v_mfma_f32_16x16x32_bf16 v[164:167], v[32:35], v[124:127], v[164:167]
 v_mfma_f32_16x16x32_bf16 v[168:171], v[32:35], v[128:131], v[168:171]
 v_mfma_f32_16x16x32_bf16 v[248:251], v[32:35], v[212:215], v[248:251]
 v_mfma_f32_16x16x32_bf16 v[220:223], v[32:35], v[32:35], v[220:223]
 v_mfma_f32_16x16x32_bf16 v[172:175], v[36:39], v[112:115], v[172:175]
 v_mfma_f32_16x16x32_bf16 v[176:179], v[36:39], v[116:119], v[176:179]
 v_mfma_f32_16x16x32_bf16 v[180:183], v[36:39], v[120:123], v[180:183]
 v_mfma_f32_16x16x32_bf16 v[184:187], v[36:39], v[124:127], v[184:187]
 v_mfma_f32_16x16x32_bf16 v[188:191], v[36:39], v[128:131], v[188:191]
 v_mfma_f32_16x16x32_bf16 v[252:255], v[36:39], v[212:215], v[252:255]
 v_mfma_f32_16x16x32_bf16 v[224:227], v[36:39], v[36:39], v[224:227]
 s_waitcnt vmcnt(0)
 s_barrier
 s_waitcnt lgkmcnt(0)
 ds_write_b128 v5, v[48:51] offset:0
 ds_write_b128 v5, v[52:55] offset:1024
 ds_read_b128 v[48:51], v7 offset:0
 ds_read_b128 v[52:55], v7 offset:1024
 ds_read_b128 v[112:115], v216 offset:0
 ds_read_b128 v[116:119], v216 offset:2048
 ds_read_b128 v[120:123], v216 offset:4096
 ds_read_b128 v[124:127], v216 offset:6144
 ds_read_b128 v[128:131], v216 offset:8192
 v_mfma_f32_16x16x32_bf16 v[152:155], v[40:43], v[132:135], v[152:155]
 v_mfma_f32_16x16x32_bf16 v[156:159], v[40:43], v[136:139], v[156:159]
 v_mfma_f32_16x16x32_bf16 v[160:163], v[40:43], v[140:143], v[160:163]
 v_mfma_f32_16x16x32_bf16 v[164:167], v[40:43], v[144:147], v[164:167]
 v_mfma_f32_16x16x32_bf16 v[168:171], v[40:43], v[148:151], v[168:171]
 v_mfma_f32_16x16x32_bf16 v[248:251], v[40:43], v[212:215], v[248:251]
 v_mfma_f32_16x16x32_bf16 v[220:223], v[40:43], v[40:43], v[220:223]
 v_mfma_f32_16x16x32_bf16 v[172:175], v[44:47], v[132:135], v[172:175]
 v_mfma_f32_16x16x32_bf16 v[176:179], v[44:47], v[136:139], v[176:179]
 v_mfma_f32_16x16x32_bf16 v[180:183], v[44:47], v[140:143], v[180:183]
 v_mfma_f32_16x16x32_bf16 v[184:187], v[44:47], v[144:147], v[184:187]
 v_mfma_f32_16x16x32_bf16 v[188:191], v[44:47], v[148:151], v[188:191]
 v_mfma_f32_16x16x32_bf16 v[252:255], v[44:47], v[212:215], v[252:255]
 v_mfma_f32_16x16x32_bf16 v[224:227], v[44:47], v[44:47], v[224:227]
 s_waitcnt lgkmcnt(0)
 ds_write_b128 v5, v[56:59] offset:0
 ds_write_b128 v5, v[60:63] offset:1024
 ds_read_b128 v[56:59], v7 offset:0
 ds_read_b128 v[60:63], v7 offset:1024
 ds_read_b128 v[132:135], v217 offset:0
 ds_read_b128 v[136:139], v217 offset:2048
 ds_read_b128 v[140:143], v217 offset:4096
 ds_read_b128 v[144:147], v217 offset:6144
 ds_read_b128 v[148:151], v217 offset:8192
 v_mfma_f32_16x16x32_bf16 v[152:155], v[48:51], v[112:115], v[152:155]
 v_mfma_f32_16x16x32_bf16 v[156:159], v[48:51], v[116:119], v[156:159]
 v_mfma_f32_16x16x32_bf16 v[160:163], v[48:51], v[120:123], v[160:163]
 v_mfma_f32_16x16x32_bf16 v[164:167], v[48:51], v[124:127], v[164:167]
 v_mfma_f32_16x16x32_bf16 v[168:171], v[48:51], v[128:131], v[168:171]
 v_mfma_f32_16x16x32_bf16 v[248:251], v[48:51], v[212:215], v[248:251]
 v_mfma_f32_16x16x32_bf16 v[220:223], v[48:51], v[48:51], v[220:223]
 v_mfma_f32_16x16x32_bf16 v[172:175], v[52:55], v[112:115], v[172:175]
 v_mfma_f32_16x16x32_bf16 v[176:179], v[52:55], v[116:119], v[176:179]
 v_mfma_f32_16x16x32_bf16 v[180:183], v[52:55], v[120:123], v[180:183]
 v_mfma_f32_16x16x32_bf16 v[184:187], v[52:55], v[124:127], v[184:187]
 v_mfma_f32_16x16x32_bf16 v[188:191], v[52:55], v[128:131], v[188:191]
 v_mfma_f32_16x16x32_bf16 v[252:255], v[52:55], v[212:215], v[252:255]
 v_mfma_f32_16x16x32_bf16 v[224:227], v[52:55], v[52:55], v[224:227]
 s_waitcnt lgkmcnt(0)
 v_mfma_f32_16x16x32_bf16 v[152:155], v[56:59], v[132:135], v[152:155]
 v_mfma_f32_16x16x32_bf16 v[156:159], v[56:59], v[136:139], v[156:159]
 v_mfma_f32_16x16x32_bf16 v[160:163], v[56:59], v[140:143], v[160:163]
 v_mfma_f32_16x16x32_bf16 v[164:167], v[56:59], v[144:147], v[164:167]
 v_mfma_f32_16x16x32_bf16 v[168:171], v[56:59], v[148:151], v[168:171]
 v_mfma_f32_16x16x32_bf16 v[248:251], v[56:59], v[212:215], v[248:251]
 v_mfma_f32_16x16x32_bf16 v[220:223], v[56:59], v[56:59], v[220:223]
 v_mfma_f32_16x16x32_bf16 v[172:175], v[60:63], v[132:135], v[172:175]
 v_mfma_f32_16x16x32_bf16 v[176:179], v[60:63], v[136:139], v[176:179]
 v_mfma_f32_16x16x32_bf16 v[180:183], v[60:63], v[140:143], v[180:183]
 v_mfma_f32_16x16x32_bf16 v[184:187], v[60:63], v[144:147], v[184:187]
 v_mfma_f32_16x16x32_bf16 v[188:191], v[60:63], v[148:151], v[188:191]
 v_mfma_f32_16x16x32_bf16 v[252:255], v[60:63], v[212:215], v[252:255]
 v_mfma_f32_16x16x32_bf16 v[224:227], v[60:63], v[60:63], v[224:227]
 s_lshl_b32 s50, s20, 8
 s_add_u32 s50, s50, 74752
 s_nop 7
 v_and_b32 v228, 3, v11
 v_mov_b32 v232, v248
 v_cmp_eq_u32 vcc, 1, v228
 s_nop 1
 v_cndmask_b32 v232, v232, v249, vcc
 v_cmp_eq_u32 vcc, 2, v228
 s_nop 1
 v_cndmask_b32 v232, v232, v250, vcc
 v_cmp_eq_u32 vcc, 3, v228
 s_nop 1
 v_cndmask_b32 v232, v232, v251, vcc
 v_mov_b32 v233, v220
 v_cmp_eq_u32 vcc, 1, v228
 s_nop 1
 v_cndmask_b32 v233, v233, v221, vcc
 v_cmp_eq_u32 vcc, 2, v228
 s_nop 1
 v_cndmask_b32 v233, v233, v222, vcc
 v_cmp_eq_u32 vcc, 3, v228
 s_nop 1
 v_cndmask_b32 v233, v233, v223, vcc
 v_mov_b32 v234, v252
 v_cmp_eq_u32 vcc, 1, v228
 s_nop 1
 v_cndmask_b32 v234, v234, v253, vcc
 v_cmp_eq_u32 vcc, 2, v228
 s_nop 1
 v_cndmask_b32 v234, v234, v254, vcc
 v_cmp_eq_u32 vcc, 3, v228
 s_nop 1
 v_cndmask_b32 v234, v234, v255, vcc
 v_mov_b32 v235, v224
 v_cmp_eq_u32 vcc, 1, v228
 s_nop 1
 v_cndmask_b32 v235, v235, v225, vcc
 v_cmp_eq_u32 vcc, 2, v228
 s_nop 1
 v_cndmask_b32 v235, v235, v226, vcc
 v_cmp_eq_u32 vcc, 3, v228
 s_nop 1
 v_cndmask_b32 v235, v235, v227, vcc
 v_lshrrev_b32 v229, 2, v11
 v_lshl_add_u32 v230, v11, 3, s50
 v_cmp_eq_u32 vcc, v229, v12
 s_and_saveexec_b64 s[52:53], vcc
 ds_write_b64 v230, v[232:233]
 ds_write_b64 v230, v[234:235] offset:128
 s_mov_b64 exec, -1
 v_and_b32 v224, 31, v2
 v_lshl_add_u32 v230, v224, 3, s50
 s_waitcnt lgkmcnt(0)
 ds_read_b64 v[228:229], v230
 s_waitcnt lgkmcnt(0)
 v_mov_b32 v234, 0x3ae38e39
 v_mul_f32 v235, v228, v234
 v_mul_f32 v236, v229, v234
 v_fma_f32 v236, -v235, v235, v236
 v_max_f32 v236, 0, v236
 v_cvt_pk_bf16_f32 v234, v235, v236
 v_lshlrev_b32 v232, 16, v234
 v_and_b32 v236, 0xffff0000, v234
 v_add_f32 v236, 0x3727c5ac, v236
 v_cvt_pk_bf16_f32 v234, v236, v236
 v_lshlrev_b32 v236, 16, v234
 v_sqrt_f32 v236, v236
 s_nop 0
 v_cvt_pk_bf16_f32 v234, v236, v236
 v_lshlrev_b32 v233, 16, v234
 v_rcp_f32 v233, v233
 s_nop 0
 v_mul_f32 v232, v232, v233
 v_lshl_add_u32 v226, v224, 3, s50
 ds_write_b64 v226, v[232:233]
 v_lshl_add_u32 v226, v12, 5, s50
 s_waitcnt lgkmcnt(0)
 s_barrier
 v_lshlrev_b32 v227, 2, v11
 v_add_u32 v227, 75776, v227
 ds_read_b32 v192, v227 offset:0
 ds_read_b32 v196, v227 offset:64
 ds_read_b32 v200, v227 offset:128
 ds_read_b32 v204, v227 offset:192
 ds_read_b32 v208, v227 offset:256
 ds_read_b128 v[232:235], v226
 ds_read_b128 v[236:239], v226 offset:16
 ds_read_b128 v[240:243], v226 offset:128
 ds_read_b128 v[244:247], v226 offset:144
 v_mul_u32_u24 v15, 1152, v12
 v_lshl_add_u32 v15, v11, 4, v15
 s_mul_i32 s46, s54, 294912
 s_mul_i32 s47, s21, 4608
 s_add_u32 s46, s46, s47
 s_waitcnt lgkmcnt(0)
 s_add_u32 s51, s55, s20
 s_mul_i32 s47, s54, 320
 s_cmp_eq_u32 s51, 0
 s_cselect_b32 s47, s47, 0x7f000000
 v_lshlrev_b32 v227, 2, v11
 buffer_store_dword v192, v227, s[36:39], s47 offen offset:0 sc1
 buffer_store_dword v196, v227, s[36:39], s47 offen offset:64 sc1
 buffer_store_dword v200, v227, s[36:39], s47 offen offset:128 sc1
 buffer_store_dword v204, v227, s[36:39], s47 offen offset:192 sc1
 buffer_store_dword v208, v227, s[36:39], s47 offen offset:256 sc1
 v_mul_f32 v152, v152, v233
 v_fma_f32 v152, -v232, v192, v152
 v_mul_f32 v153, v153, v235
 v_fma_f32 v153, -v234, v192, v153
 v_mul_f32 v154, v154, v237
 v_fma_f32 v154, -v236, v192, v154
 v_mul_f32 v155, v155, v239
 v_fma_f32 v155, -v238, v192, v155
 v_mul_f32 v172, v172, v241
 v_fma_f32 v172, -v240, v192, v172
 v_mul_f32 v173, v173, v243
 v_fma_f32 v173, -v242, v192, v173
 v_mul_f32 v174, v174, v245
 v_fma_f32 v174, -v244, v192, v174
 v_mul_f32 v175, v175, v247
 v_fma_f32 v175, -v246, v192, v175
 v_cvt_pk_bf16_f32 v48, v152, v153
 v_cvt_pk_bf16_f32 v49, v154, v155
 v_cvt_pk_bf16_f32 v50, v172, v173
 v_cvt_pk_bf16_f32 v51, v174, v175
 buffer_store_dwordx4 v[48:51], v15, s[40:43], s46 offen offset:0 sc1
 v_mul_f32 v156, v156, v233
 v_fma_f32 v156, -v232, v196, v156
 v_mul_f32 v157, v157, v235
 v_fma_f32 v157, -v234, v196, v157
 v_mul_f32 v158, v158, v237
 v_fma_f32 v158, -v236, v196, v158
 v_mul_f32 v159, v159, v239
 v_fma_f32 v159, -v238, v196, v159
 v_mul_f32 v176, v176, v241
 v_fma_f32 v176, -v240, v196, v176
 v_mul_f32 v177, v177, v243
 v_fma_f32 v177, -v242, v196, v177
 v_mul_f32 v178, v178, v245
 v_fma_f32 v178, -v244, v196, v178
 v_mul_f32 v179, v179, v247
 v_fma_f32 v179, -v246, v196, v179
 v_cvt_pk_bf16_f32 v52, v156, v157
 v_cvt_pk_bf16_f32 v53, v158, v159
 v_cvt_pk_bf16_f32 v54, v176, v177
 v_cvt_pk_bf16_f32 v55, v178, v179
 buffer_store_dwordx4 v[52:55], v15, s[40:43], s46 offen offset:256 sc1
 v_mul_f32 v160, v160, v233
 v_fma_f32 v160, -v232, v200, v160
 v_mul_f32 v161, v161, v235
 v_fma_f32 v161, -v234, v200, v161
 v_mul_f32 v162, v162, v237
 v_fma_f32 v162, -v236, v200, v162
 v_mul_f32 v163, v163, v239
 v_fma_f32 v163, -v238, v200, v163
 v_mul_f32 v180, v180, v241
 v_fma_f32 v180, -v240, v200, v180
 v_mul_f32 v181, v181, v243
 v_fma_f32 v181, -v242, v200, v181
 v_mul_f32 v182, v182, v245
 v_fma_f32 v182, -v244, v200, v182
 v_mul_f32 v183, v183, v247
 v_fma_f32 v183, -v246, v200, v183
 v_cvt_pk_bf16_f32 v56, v160, v161
 v_cvt_pk_bf16_f32 v57, v162, v163
 v_cvt_pk_bf16_f32 v58, v180, v181
 v_cvt_pk_bf16_f32 v59, v182, v183
 buffer_store_dwordx4 v[56:59], v15, s[40:43], s46 offen offset:512 sc1
 v_mul_f32 v164, v164, v233
 v_fma_f32 v164, -v232, v204, v164
 v_mul_f32 v165, v165, v235
 v_fma_f32 v165, -v234, v204, v165
 v_mul_f32 v166, v166, v237
 v_fma_f32 v166, -v236, v204, v166
 v_mul_f32 v167, v167, v239
 v_fma_f32 v167, -v238, v204, v167
 v_mul_f32 v184, v184, v241
 v_fma_f32 v184, -v240, v204, v184
 v_mul_f32 v185, v185, v243
 v_fma_f32 v185, -v242, v204, v185
 v_mul_f32 v186, v186, v245
 v_fma_f32 v186, -v244, v204, v186
 v_mul_f32 v187, v187, v247
 v_fma_f32 v187, -v246, v204, v187
 v_cvt_pk_bf16_f32 v60, v164, v165
 v_cvt_pk_bf16_f32 v61, v166, v167
 v_cvt_pk_bf16_f32 v62, v184, v185
 v_cvt_pk_bf16_f32 v63, v186, v187
 buffer_store_dwordx4 v[60:63], v15, s[40:43], s46 offen offset:768 sc1
 v_mul_f32 v168, v168, v233
 v_fma_f32 v168, -v232, v208, v168
 v_mul_f32 v169, v169, v235
 v_fma_f32 v169, -v234, v208, v169
 v_mul_f32 v170, v170, v237
 v_fma_f32 v170, -v236, v208, v170
 v_mul_f32 v171, v171, v239
 v_fma_f32 v171, -v238, v208, v171
 v_mul_f32 v188, v188, v241
 v_fma_f32 v188, -v240, v208, v188
 v_mul_f32 v189, v189, v243
 v_fma_f32 v189, -v242, v208, v189
 v_mul_f32 v190, v190, v245
 v_fma_f32 v190, -v244, v208, v190
 v_mul_f32 v191, v191, v247
 v_fma_f32 v191, -v246, v208, v191
 v_cvt_pk_bf16_f32 v64, v168, v169
 v_cvt_pk_bf16_f32 v65, v170, v171
 v_cvt_pk_bf16_f32 v66, v188, v189
 v_cvt_pk_bf16_f32 v67, v190, v191
 v_cmp_gt_u32 vcc, 8, v11
 s_and_saveexec_b64 s[50:51], vcc
 buffer_store_dwordx4 v[64:67], v15, s[40:43], s46 offen offset:1024 sc1
 s_mov_b64 exec, -1
 s_load_dwordx2 s[24:25], s[0:1], 80
 s_waitcnt lgkmcnt(0)
 s_and_b32 s25, s25, 0xffff
 s_mov_b32 s26, 256
 s_mov_b32 s27, 0x00020000
 s_mov_b64 exec, -1
 v_and_b32 v1, 63, v0
 v_lshlrev_b32 v1, 2, v1
 s_mov_b32 s3, 0
 s_mov_b32 s4, 0x01010101
kh1_gn1:
 buffer_load_dword v3, v1, s[24:27], 0 offen sc1
 s_add_u32 s3, s3, 1
 s_waitcnt vmcnt(0)
 v_cmp_ne_u32 vcc, s4, v3
 s_cmp_ge_u32 s3, 0x40000
 s_cbranch_scc1 kh1_gn1y
 s_cmp_eq_u64 vcc, 0
 s_cbranch_scc1 kh1_gn1y
 s_sleep 16
 s_branch kh1_gn1
kh1_gn1y:
 s_lshl_b32 s47, s54, 8
 s_lshl_b32 s3, s21, 2
 s_add_u32 s47, s47, s3
 s_add_u32 s47, s47, 319488
 s_mov_b64 exec, -1
 v_mov_b32 v1, s101
 v_mov_b32 v3, 0
 s_waitcnt vmcnt(0)
 s_mov_b64 exec, 1
 buffer_store_dword v1, v3, s[76:79], s47 offen sc1
 s_mov_b64 exec, -1
 s_branch kh1_rdone
kh1_rep:
 s_sub_u32 s20, s20, 4
 s_lshl_b32 s3, s2, 11
 s_cmp_eq_u32 s20, 0
 s_cselect_b32 s3, s3, 0x7f000000
 v_lshlrev_b32 v1, 4, v2
 v_mov_b32 v108, 0
 v_mov_b32 v109, 0
 v_mov_b32 v110, 0
 v_mov_b32 v111, 0
 buffer_store_dwordx4 v[108:111], v1, s[76:79], s3 offen sc1
 buffer_store_dwordx4 v[108:111], v1, s[76:79], s3 offen offset:1024 sc1
 s_cmp_lt_u32 s2, 72
 s_cselect_b32 s4, s12, s14
 s_cselect_b32 s5, s13, s15
 s_cselect_b32 s64, 0, 1
 s_cmp_lt_u32 s2, 144
 s_cselect_b32 s4, s4, s16
 s_cselect_b32 s5, s5, s17
 s_movk_i32 s65, 1152
 s_cselect_b32 s65, 9216, s65
 s_cselect_b32 s66, 1, 0
 s_mov_b32 s24, s4
 s_and_b32 s25, s5, 0xffff
 s_mov_b32 s26, 5308416
 s_mov_b32 s27, 0x00020000
 s_mul_i32 s67, s64, 72
 s_sub_u32 s67, s2, s67
 s_sub_u32 s68, s2, 144
 s_mul_i32 s69, s68, 7282
 s_lshr_b32 s69, s69, 16
 s_mul_i32 s75, s69, 9
 s_sub_u32 s68, s68, s75
 s_mul_i32 s75, s69, 442368
 s_lshl_b32 s58, s68, 7
 s_add_u32 s75, s75, s58
 s_lshl_b32 s58, s67, 7
 s_cmp_eq_u32 s66, 1
 s_cselect_b32 s75, s58, s75
 s_cselect_b32 s58, 18, 12
 s_lshl_b32 s59, s65, 3
 s_mul_i32 s56, s20, s59
 s_mul_i32 s56, s56, s58
 s_add_u32 s75, s75, s56
 s_cmp_ge_u32 s2, 252
 s_cselect_b32 s58, 0, s58
 v_lshrrev_b32 v3, 3, v2
 v_and_b32 v4, 7, v2
 v_mul_lo_u32 v6, v3, s65
 v_lshl_add_u32 v6, v4, 4, v6
 s_mul_i32 s56, s20, 18432
 s_add_u32 s56, s56, 77824
 s_mov_b32 s28, s6
 s_and_b32 s29, s7, 0xffff
 s_mov_b32 s30, 2359296
 s_mov_b32 s31, 0x00020000
 s_add_u32 s32, s18, 0
 s_addc_u32 s33, s19, 0
 s_and_b32 s33, s33, 0xffff
 s_mov_b32 s34, 2359296
 s_mov_b32 s35, 0x00020000
 v_and_b32 v8, 31, v2
 v_and_b32 v9, 3, v8
 v_bfe_u32 v10, v8, 2, 2
 v_lshl_or_b32 v9, v10, 3, v9
 v_bfe_u32 v10, v8, 4, 1
 v_lshl_or_b32 v9, v10, 2, v9
 v_mul_u32_u24 v9, 1152, v9
 v_lshrrev_b32 v10, 5, v2
 v_lshl_add_u32 v9, v10, 4, v9
 v_lshlrev_b32 v8, 4, v8
 v_lshl_add_u32 v8, v10, 9, v8
 s_lshr_b32 s36, s2, 2
 s_mul_i32 s36, s36, 36864
 s_and_b32 s37, s2, 3
 s_mul_i32 s37, s37, 18
 s_lshl_b32 s38, s20, 1
 s_add_u32 s37, s37, s38
 s_lshl_b32 s38, s37, 4
 s_add_u32 s38, s38, s36
 s_lshl_b32 s39, s37, 9
 s_add_u32 s39, s39, s36
 s_add_u32 s40, s38, 256
 s_add_u32 s41, s39, 8192
 s_cmp_eq_u32 s20, 0
 s_cselect_b32 s40, s40, 0x7f000000
 s_cselect_b32 s41, s41, 0x7f000000
 buffer_load_dwordx4 v[16:19], v9, s[28:31], s38 offen
 buffer_load_dwordx4 v[20:23], v9, s[28:31], s38 offen offset:128
 buffer_load_dwordx4 v[24:27], v9, s[28:31], s40 offen
 s_cmp_gt_u32 s58, 0
 s_cselect_b32 s51, s75, 0x7f000000
 s_add_u32 m0, s56, 0
 s_add_u32 s75, s75, s59
 buffer_load_dwordx4 v6, s[24:27], s51 offen lds
 s_cmp_gt_u32 s58, 1
 s_cselect_b32 s51, s75, 0x7f000000
 s_add_u32 m0, s56, 1024
 s_add_u32 s75, s75, s59
 buffer_load_dwordx4 v6, s[24:27], s51 offen lds
 s_cmp_gt_u32 s58, 2
 s_cselect_b32 s51, s75, 0x7f000000
 s_add_u32 m0, s56, 2048
 s_add_u32 s75, s75, s59
 buffer_load_dwordx4 v6, s[24:27], s51 offen lds
 s_cmp_gt_u32 s58, 3
 s_cselect_b32 s51, s75, 0x7f000000
 s_add_u32 m0, s56, 3072
 s_add_u32 s75, s75, s59
 buffer_load_dwordx4 v6, s[24:27], s51 offen lds
 s_cmp_gt_u32 s58, 4
 s_cselect_b32 s51, s75, 0x7f000000
 s_add_u32 m0, s56, 4096
 s_add_u32 s75, s75, s59
 buffer_load_dwordx4 v6, s[24:27], s51 offen lds
 s_cmp_gt_u32 s58, 5
 s_cselect_b32 s51, s75, 0x7f000000
 s_add_u32 m0, s56, 5120
 s_add_u32 s75, s75, s59
 buffer_load_dwordx4 v6, s[24:27], s51 offen lds
 v_lshrrev_b32 v3, 4, v2
 v_and_b32 v4, 15, v2
 v_bfe_u32 v10, v2, 2, 2
 v_lshlrev_b32 v7, 7, v10
 v_lshl_add_u32 v7, v3, 5, v7
 v_add_u32 v7, s56, v7
 v_and_b32 v10, 1, v2
 v_lshlrev_b32 v10, 4, v10
 v_bfe_u32 v11, v2, 1, 1
 v_lshl_add_u32 v10, v11, 3, v10
 v_and_b32 v11, 3, v2
 v_lshlrev_b32 v11, 3, v11
 s_cmp_eq_u32 s66, 1
 s_cselect_b64 s[42:43], -1, 0
 s_nop 1
 v_cndmask_b32 v10, v11, v10, s[42:43]
 v_add_u32 v7, v7, v10
 s_lshl_b32 s36, s67, 2
 v_add_u32 v12, s36, v3
 v_mul_u32_u24 v13, 7282, v12
 v_lshrrev_b32 v13, 16, v13
 v_mul_u32_u24 v14, 9, v13
 v_sub_u32 v14, v12, v14
 s_mov_b32 s36, 340992
 v_mul_lo_u32 v13, v13, s36
 v_lshl_add_u32 v13, v14, 10, v13
 v_lshl_add_u32 v13, v4, 4, v13
 s_lshl_b32 s36, s68, 6
 v_add_u32 v12, s36, v2
 v_mul_u32_u24 v14, 911, v12
 v_lshrrev_b32 v14, 16, v14
 v_mul_u32_u24 v15, 72, v14
 v_sub_u32 v15, v12, v15
 v_and_b32 v12, 0x23, v15
 v_bfe_u32 v10, v15, 2, 1
 v_lshl_or_b32 v12, v10, 4, v12
 v_bfe_u32 v10, v15, 3, 2
 v_lshl_or_b32 v12, v10, 2, v12
 v_cmp_gt_u32 vcc, 64, v15
 s_nop 1
 v_cndmask_b32 v12, v15, v12, vcc
 s_mov_b32 s36, 663552
 v_mul_lo_u32 v14, v14, s36
 v_lshl_add_u32 v14, v12, 4, v14
 v_cndmask_b32 v5, v14, v13, s[42:43]
 s_mov_b32 s36, 45035520
 s_mov_b32 s37, 5308416
 s_cmp_eq_u32 s66, 1
 s_cselect_b32 s36, 34119680, s36
 s_cselect_b32 s46, 10911744, s37
 s_add_u32 s44, s18, s36
 s_addc_u32 s45, s19, 0
 s_and_b32 s45, s45, 0xffff
 s_mov_b32 s47, 0x00020000
 s_lshl_b32 s48, s64, 8
 s_mul_i32 s49, s20, 82944
 s_add_u32 s49, s49, s48
 s_mul_i32 s36, s69, 55296
 s_mul_i32 s37, s20, 13824
 s_add_u32 s36, s36, s37
 s_cmp_eq_u32 s66, 1
 s_cselect_b32 s49, s49, s36
 s_movk_i32 s52, 1152
 s_cselect_b32 s52, 512, s52
 s_movk_i32 s53, 1152
 s_cselect_b32 s53, 8704, s53
 v_mov_b32 v14, 0
 v_mov_b32 v15, 0
 v_and_b32 v11, 15, v2
 v_lshrrev_b32 v12, 4, v2
 v_lshrrev_b32 v1, 1, v11
 v_xor_b32 v1, v1, v12
 v_lshlrev_b32 v1, 4, v1
 v_lshl_add_u32 v28, v11, 7, v1
 v_xor_b32 v29, 64, v28
 s_lshl_b32 s36, s20, 11
 v_add_u32 v30, s36, v28
 v_add_u32 v31, s36, v29
 v_mov_b32 v32, 0x3f803f80
 v_mov_b32 v33, 0x3f803f80
 v_mov_b32 v34, 0x3f803f80
 v_mov_b32 v35, 0x3f803f80
 v_mov_b32 v36, 0
 v_mov_b32 v37, 0
 v_mov_b32 v38, 0
 v_mov_b32 v39, 0
 v_mov_b32 v40, 0
 v_mov_b32 v41, 0
 v_mov_b32 v42, 0
 v_mov_b32 v43, 0
 s_barrier
 ds_read_b128 v[44:47], v30 offset:0
 ds_read_b128 v[48:51], v28 offset:8192
 ds_read_b128 v[52:55], v31 offset:0
 ds_read_b128 v[56:59], v29 offset:8192
 ds_read_b128 v[60:63], v30 offset:9216
 ds_read_b128 v[64:67], v28 offset:17408
 ds_read_b128 v[68:71], v31 offset:9216
 ds_read_b128 v[72:75], v29 offset:17408
 ds_read_b128 v[76:79], v30 offset:18432
 ds_read_b128 v[80:83], v28 offset:26624
 ds_read_b128 v[84:87], v31 offset:18432
 ds_read_b128 v[88:91], v29 offset:26624
 ds_read_b128 v[92:95], v30 offset:27648
 ds_read_b128 v[96:99], v28 offset:35840
 ds_read_b128 v[100:103], v31 offset:27648
 ds_read_b128 v[104:107], v29 offset:35840
 s_waitcnt lgkmcnt(0)
 v_mfma_f32_16x16x32_bf16 v[36:39], v[32:35], v[44:47], v[36:39]
 v_mfma_f32_16x16x32_bf16 v[40:43], v[32:35], v[48:51], v[40:43]
 v_mfma_f32_16x16x32_bf16 v[36:39], v[32:35], v[52:55], v[36:39]
 v_mfma_f32_16x16x32_bf16 v[40:43], v[32:35], v[56:59], v[40:43]
 v_mfma_f32_16x16x32_bf16 v[36:39], v[32:35], v[60:63], v[36:39]
 v_mfma_f32_16x16x32_bf16 v[40:43], v[32:35], v[64:67], v[40:43]
 v_mfma_f32_16x16x32_bf16 v[36:39], v[32:35], v[68:71], v[36:39]
 v_mfma_f32_16x16x32_bf16 v[40:43], v[32:35], v[72:75], v[40:43]
 v_mfma_f32_16x16x32_bf16 v[36:39], v[32:35], v[76:79], v[36:39]
 v_mfma_f32_16x16x32_bf16 v[40:43], v[32:35], v[80:83], v[40:43]
 v_mfma_f32_16x16x32_bf16 v[36:39], v[32:35], v[84:87], v[36:39]
 v_mfma_f32_16x16x32_bf16 v[40:43], v[32:35], v[88:91], v[40:43]
 v_mfma_f32_16x16x32_bf16 v[36:39], v[32:35], v[92:95], v[36:39]
 v_mfma_f32_16x16x32_bf16 v[40:43], v[32:35], v[96:99], v[40:43]
 v_mfma_f32_16x16x32_bf16 v[36:39], v[32:35], v[100:103], v[36:39]
 v_mfma_f32_16x16x32_bf16 v[40:43], v[32:35], v[104:107], v[40:43]
 s_cmp_gt_u32 s58, 6
 s_cselect_b32 s51, s75, 0x7f000000
 s_add_u32 m0, s56, 6144
 s_add_u32 s75, s75, s59
 buffer_load_dwordx4 v6, s[24:27], s51 offen lds
 s_cmp_gt_u32 s58, 7
 s_cselect_b32 s51, s75, 0x7f000000
 s_add_u32 m0, s56, 7168
 s_add_u32 s75, s75, s59
 buffer_load_dwordx4 v6, s[24:27], s51 offen lds
 s_cmp_gt_u32 s58, 8
 s_cselect_b32 s51, s75, 0x7f000000
 s_add_u32 m0, s56, 8192
 s_add_u32 s75, s75, s59
 buffer_load_dwordx4 v6, s[24:27], s51 offen lds
 s_cmp_gt_u32 s58, 9
 s_cselect_b32 s51, s75, 0x7f000000
 s_add_u32 m0, s56, 9216
 s_add_u32 s75, s75, s59
 buffer_load_dwordx4 v6, s[24:27], s51 offen lds
 s_cmp_gt_u32 s58, 10
 s_cselect_b32 s51, s75, 0x7f000000
 s_add_u32 m0, s56, 10240
 s_add_u32 s75, s75, s59
 buffer_load_dwordx4 v6, s[24:27], s51 offen lds
 s_cmp_gt_u32 s58, 11
 s_cselect_b32 s51, s75, 0x7f000000
 s_add_u32 m0, s56, 11264
 s_add_u32 s75, s75, s59
 buffer_load_dwordx4 v6, s[24:27], s51 offen lds
 s_waitcnt vmcnt(12)
 s_load_dwordx2 s[60:61], s[0:1], 80
 s_waitcnt lgkmcnt(0)
 s_and_b32 s61, s61, 0xffff
 s_mov_b32 s62, 256
 s_mov_b32 s63, 0x00020000
 s_cmp_eq_u32 s20, 0
 s_cselect_b32 s3, s2, 0x7f000000
 v_mov_b32 v108, 1
 s_mov_b64 exec, 1
 buffer_store_byte v108, v109, s[60:63], s3 offen sc1
 s_mov_b64 exec, -1
 buffer_store_dwordx4 v[16:19], v8, s[32:35], s39 offen sc1
 s_add_u32 s39, s39, 4096
 buffer_store_dwordx4 v[20:23], v8, s[32:35], s39 offen sc1
 buffer_store_dwordx4 v[24:27], v8, s[32:35], s41 offen sc1
 s_barrier
 ds_read_b128 v[44:47], v30 offset:36864
 ds_read_b128 v[48:51], v28 offset:45056
 ds_read_b128 v[52:55], v31 offset:36864
 ds_read_b128 v[56:59], v29 offset:45056
 ds_read_b128 v[60:63], v30 offset:46080
 ds_read_b128 v[64:67], v28 offset:54272
 ds_read_b128 v[68:71], v31 offset:46080
 ds_read_b128 v[72:75], v29 offset:54272
 ds_read_b128 v[76:79], v30 offset:55296
 ds_read_b128 v[80:83], v28 offset:63488
 ds_read_b128 v[84:87], v31 offset:55296
 ds_read_b128 v[88:91], v29 offset:63488
 v_add_u32 v1, 64512, v30
 ds_read_b128 v[92:95], v1
 v_add_u32 v1, 72704, v28
 ds_read_b128 v[96:99], v1
 v_add_u32 v1, 64512, v31
 ds_read_b128 v[100:103], v1
 v_add_u32 v1, 72704, v29
 ds_read_b128 v[104:107], v1
 s_waitcnt lgkmcnt(0)
 v_mfma_f32_16x16x32_bf16 v[36:39], v[32:35], v[44:47], v[36:39]
 v_mfma_f32_16x16x32_bf16 v[40:43], v[32:35], v[48:51], v[40:43]
 v_mfma_f32_16x16x32_bf16 v[36:39], v[32:35], v[52:55], v[36:39]
 v_mfma_f32_16x16x32_bf16 v[40:43], v[32:35], v[56:59], v[40:43]
 v_mfma_f32_16x16x32_bf16 v[36:39], v[32:35], v[60:63], v[36:39]
 v_mfma_f32_16x16x32_bf16 v[40:43], v[32:35], v[64:67], v[40:43]
 v_mfma_f32_16x16x32_bf16 v[36:39], v[32:35], v[68:71], v[36:39]
 v_mfma_f32_16x16x32_bf16 v[40:43], v[32:35], v[72:75], v[40:43]
 v_mfma_f32_16x16x32_bf16 v[36:39], v[32:35], v[76:79], v[36:39]
 v_mfma_f32_16x16x32_bf16 v[40:43], v[32:35], v[80:83], v[40:43]
 v_mfma_f32_16x16x32_bf16 v[36:39], v[32:35], v[84:87], v[36:39]
 v_mfma_f32_16x16x32_bf16 v[40:43], v[32:35], v[88:91], v[40:43]
 v_mfma_f32_16x16x32_bf16 v[36:39], v[32:35], v[92:95], v[36:39]
 v_mfma_f32_16x16x32_bf16 v[40:43], v[32:35], v[96:99], v[40:43]
 v_mfma_f32_16x16x32_bf16 v[36:39], v[32:35], v[100:103], v[36:39]
 v_mfma_f32_16x16x32_bf16 v[40:43], v[32:35], v[104:107], v[40:43]
 s_cmp_gt_u32 s58, 12
 s_cselect_b32 s51, s75, 0x7f000000
 s_add_u32 m0, s56, 12288
 s_add_u32 s75, s75, s59
 buffer_load_dwordx4 v6, s[24:27], s51 offen lds
 s_cmp_gt_u32 s58, 13
 s_cselect_b32 s51, s75, 0x7f000000
 s_add_u32 m0, s56, 13312
 s_add_u32 s75, s75, s59
 buffer_load_dwordx4 v6, s[24:27], s51 offen lds
 s_cmp_gt_u32 s58, 14
 s_cselect_b32 s51, s75, 0x7f000000
 s_add_u32 m0, s56, 14336
 s_add_u32 s75, s75, s59
 buffer_load_dwordx4 v6, s[24:27], s51 offen lds
 s_cmp_gt_u32 s58, 15
 s_cselect_b32 s51, s75, 0x7f000000
 s_add_u32 m0, s56, 15360
 s_add_u32 s75, s75, s59
 buffer_load_dwordx4 v6, s[24:27], s51 offen lds
 s_cmp_gt_u32 s58, 16
 s_cselect_b32 s51, s75, 0x7f000000
 s_add_u32 m0, s56, 16384
 s_add_u32 s75, s75, s59
 buffer_load_dwordx4 v6, s[24:27], s51 offen lds
 s_cmp_gt_u32 s58, 17
 s_cselect_b32 s51, s75, 0x7f000000
 s_add_u32 m0, s56, 17408
 s_add_u32 s75, s75, s59
 buffer_load_dwordx4 v6, s[24:27], s51 offen lds
 s_waitcnt vmcnt(16)
 ds_read_b64_tr_b16 v[112:113], v7 offset:0
 ds_read_b64_tr_b16 v[114:115], v7 offset:512
 ds_read_b64_tr_b16 v[116:117], v7 offset:1024
 ds_read_b64_tr_b16 v[118:119], v7 offset:1536
 ds_read_b64_tr_b16 v[120:121], v7 offset:2048
 ds_read_b64_tr_b16 v[122:123], v7 offset:2560
 ds_read_b64_tr_b16 v[124:125], v7 offset:3072
 ds_read_b64_tr_b16 v[126:127], v7 offset:3584
 ds_read_b64_tr_b16 v[128:129], v7 offset:4096
 ds_read_b64_tr_b16 v[130:131], v7 offset:4608
 ds_read_b64_tr_b16 v[132:133], v7 offset:5120
 ds_read_b64_tr_b16 v[134:135], v7 offset:5632
 s_cmp_gt_u32 s58, 0
 s_cselect_b32 s51, s49, 0x7f000000
 s_waitcnt lgkmcnt(10)
 buffer_store_dwordx4 v[112:115], v5, s[44:47], s51 offen sc1
 s_add_u32 s49, s49, s52
 v_dot2_f32_bf16 v14, v112, v32, v14
 v_dot2_f32_bf16 v15, v113, v32, v15
 v_dot2_f32_bf16 v14, v114, v32, v14
 v_dot2_f32_bf16 v15, v115, v32, v15
 s_cmp_gt_u32 s58, 1
 s_cselect_b32 s51, s49, 0x7f000000
 s_waitcnt lgkmcnt(8)
 buffer_store_dwordx4 v[116:119], v5, s[44:47], s51 offen sc1
 s_add_u32 s49, s49, s53
 v_dot2_f32_bf16 v14, v116, v32, v14
 v_dot2_f32_bf16 v15, v117, v32, v15
 v_dot2_f32_bf16 v14, v118, v32, v14
 v_dot2_f32_bf16 v15, v119, v32, v15
 s_cmp_gt_u32 s58, 2
 s_cselect_b32 s51, s49, 0x7f000000
 s_waitcnt lgkmcnt(6)
 buffer_store_dwordx4 v[120:123], v5, s[44:47], s51 offen sc1
 s_add_u32 s49, s49, s52
 v_dot2_f32_bf16 v14, v120, v32, v14
 v_dot2_f32_bf16 v15, v121, v32, v15
 v_dot2_f32_bf16 v14, v122, v32, v14
 v_dot2_f32_bf16 v15, v123, v32, v15
 s_cmp_gt_u32 s58, 3
 s_cselect_b32 s51, s49, 0x7f000000
 s_waitcnt lgkmcnt(4)
 buffer_store_dwordx4 v[124:127], v5, s[44:47], s51 offen sc1
 s_add_u32 s49, s49, s53
 v_dot2_f32_bf16 v14, v124, v32, v14
 v_dot2_f32_bf16 v15, v125, v32, v15
 v_dot2_f32_bf16 v14, v126, v32, v14
 v_dot2_f32_bf16 v15, v127, v32, v15
 s_cmp_gt_u32 s58, 4
 s_cselect_b32 s51, s49, 0x7f000000
 s_waitcnt lgkmcnt(2)
 buffer_store_dwordx4 v[128:131], v5, s[44:47], s51 offen sc1
 s_add_u32 s49, s49, s52
 v_dot2_f32_bf16 v14, v128, v32, v14
 v_dot2_f32_bf16 v15, v129, v32, v15
 v_dot2_f32_bf16 v14, v130, v32, v14
 v_dot2_f32_bf16 v15, v131, v32, v15
 s_cmp_gt_u32 s58, 5
 s_cselect_b32 s51, s49, 0x7f000000
 s_waitcnt lgkmcnt(0)
 buffer_store_dwordx4 v[132:135], v5, s[44:47], s51 offen sc1
 s_add_u32 s49, s49, s53
 v_dot2_f32_bf16 v14, v132, v32, v14
 v_dot2_f32_bf16 v15, v133, v32, v15
 v_dot2_f32_bf16 v14, v134, v32, v14
 v_dot2_f32_bf16 v15, v135, v32, v15
 s_barrier
 ds_read_b128 v[44:47], v30 offset:0
 ds_read_b128 v[48:51], v28 offset:8192
 ds_read_b128 v[52:55], v31 offset:0
 ds_read_b128 v[56:59], v29 offset:8192
 s_waitcnt lgkmcnt(0)
 v_mfma_f32_16x16x32_bf16 v[36:39], v[32:35], v[44:47], v[36:39]
 v_mfma_f32_16x16x32_bf16 v[40:43], v[32:35], v[48:51], v[40:43]
 v_mfma_f32_16x16x32_bf16 v[36:39], v[32:35], v[52:55], v[36:39]
 v_mfma_f32_16x16x32_bf16 v[40:43], v[32:35], v[56:59], v[40:43]
 s_lshl_b32 s36, s20, 6
 s_add_u32 s36, s36, 75776
 v_lshl_add_u32 v1, v11, 2, s36
 v_lshlrev_b32 v28, 2, v11
 v_add_u32 v28, 76032, v28
 s_nop 7
 ds_write_b32 v1, v36
 ds_write_b32 v28, v40
 s_waitcnt lgkmcnt(0)
 s_barrier
 s_waitcnt vmcnt(16)
 ds_read_b64_tr_b16 v[136:137], v7 offset:6144
 ds_read_b64_tr_b16 v[138:139], v7 offset:6656
 ds_read_b64_tr_b16 v[140:141], v7 offset:7168
 ds_read_b64_tr_b16 v[142:143], v7 offset:7680
 ds_read_b64_tr_b16 v[144:145], v7 offset:8192
 ds_read_b64_tr_b16 v[146:147], v7 offset:8704
 ds_read_b64_tr_b16 v[148:149], v7 offset:9216
 ds_read_b64_tr_b16 v[150:151], v7 offset:9728
 ds_read_b64_tr_b16 v[152:153], v7 offset:10240
 ds_read_b64_tr_b16 v[154:155], v7 offset:10752
 ds_read_b64_tr_b16 v[156:157], v7 offset:11264
 ds_read_b64_tr_b16 v[158:159], v7 offset:11776
 s_cmp_gt_u32 s58, 6
 s_cselect_b32 s51, s49, 0x7f000000
 s_waitcnt lgkmcnt(10)
 buffer_store_dwordx4 v[136:139], v5, s[44:47], s51 offen sc1
 s_add_u32 s49, s49, s52
 v_dot2_f32_bf16 v14, v136, v32, v14
 v_dot2_f32_bf16 v15, v137, v32, v15
 v_dot2_f32_bf16 v14, v138, v32, v14
 v_dot2_f32_bf16 v15, v139, v32, v15
 s_cmp_gt_u32 s58, 7
 s_cselect_b32 s51, s49, 0x7f000000
 s_waitcnt lgkmcnt(8)
 buffer_store_dwordx4 v[140:143], v5, s[44:47], s51 offen sc1
 s_add_u32 s49, s49, s53
 v_dot2_f32_bf16 v14, v140, v32, v14
 v_dot2_f32_bf16 v15, v141, v32, v15
 v_dot2_f32_bf16 v14, v142, v32, v14
 v_dot2_f32_bf16 v15, v143, v32, v15
 s_cmp_gt_u32 s58, 8
 s_cselect_b32 s51, s49, 0x7f000000
 s_waitcnt lgkmcnt(6)
 buffer_store_dwordx4 v[144:147], v5, s[44:47], s51 offen sc1
 s_add_u32 s49, s49, s52
 v_dot2_f32_bf16 v14, v144, v32, v14
 v_dot2_f32_bf16 v15, v145, v32, v15
 v_dot2_f32_bf16 v14, v146, v32, v14
 v_dot2_f32_bf16 v15, v147, v32, v15
 s_cmp_gt_u32 s58, 9
 s_cselect_b32 s51, s49, 0x7f000000
 s_waitcnt lgkmcnt(4)
 buffer_store_dwordx4 v[148:151], v5, s[44:47], s51 offen sc1
 s_add_u32 s49, s49, s53
 v_dot2_f32_bf16 v14, v148, v32, v14
 v_dot2_f32_bf16 v15, v149, v32, v15
 v_dot2_f32_bf16 v14, v150, v32, v14
 v_dot2_f32_bf16 v15, v151, v32, v15
 s_cmp_gt_u32 s58, 10
 s_cselect_b32 s51, s49, 0x7f000000
 s_waitcnt lgkmcnt(2)
 buffer_store_dwordx4 v[152:155], v5, s[44:47], s51 offen sc1
 s_add_u32 s49, s49, s52
 v_dot2_f32_bf16 v14, v152, v32, v14
 v_dot2_f32_bf16 v15, v153, v32, v15
 v_dot2_f32_bf16 v14, v154, v32, v14
 v_dot2_f32_bf16 v15, v155, v32, v15
 s_cmp_gt_u32 s58, 11
 s_cselect_b32 s51, s49, 0x7f000000
 s_waitcnt lgkmcnt(0)
 buffer_store_dwordx4 v[156:159], v5, s[44:47], s51 offen sc1
 s_add_u32 s49, s49, s53
 v_dot2_f32_bf16 v14, v156, v32, v14
 v_dot2_f32_bf16 v15, v157, v32, v15
 v_dot2_f32_bf16 v14, v158, v32, v14
 v_dot2_f32_bf16 v15, v159, v32, v15
 s_waitcnt vmcnt(12)
 ds_read_b64_tr_b16 v[160:161], v7 offset:12288
 ds_read_b64_tr_b16 v[162:163], v7 offset:12800
 ds_read_b64_tr_b16 v[164:165], v7 offset:13312
 ds_read_b64_tr_b16 v[166:167], v7 offset:13824
 ds_read_b64_tr_b16 v[168:169], v7 offset:14336
 ds_read_b64_tr_b16 v[170:171], v7 offset:14848
 ds_read_b64_tr_b16 v[172:173], v7 offset:15360
 ds_read_b64_tr_b16 v[174:175], v7 offset:15872
 ds_read_b64_tr_b16 v[176:177], v7 offset:16384
 ds_read_b64_tr_b16 v[178:179], v7 offset:16896
 ds_read_b64_tr_b16 v[180:181], v7 offset:17408
 ds_read_b64_tr_b16 v[182:183], v7 offset:17920
 s_cmp_gt_u32 s58, 12
 s_cselect_b32 s51, s49, 0x7f000000
 s_waitcnt lgkmcnt(10)
 buffer_store_dwordx4 v[160:163], v5, s[44:47], s51 offen sc1
 s_add_u32 s49, s49, s52
 v_dot2_f32_bf16 v14, v160, v32, v14
 v_dot2_f32_bf16 v15, v161, v32, v15
 v_dot2_f32_bf16 v14, v162, v32, v14
 v_dot2_f32_bf16 v15, v163, v32, v15
 s_cmp_gt_u32 s58, 13
 s_cselect_b32 s51, s49, 0x7f000000
 s_waitcnt lgkmcnt(8)
 buffer_store_dwordx4 v[164:167], v5, s[44:47], s51 offen sc1
 s_add_u32 s49, s49, s53
 v_dot2_f32_bf16 v14, v164, v32, v14
 v_dot2_f32_bf16 v15, v165, v32, v15
 v_dot2_f32_bf16 v14, v166, v32, v14
 v_dot2_f32_bf16 v15, v167, v32, v15
 s_cmp_gt_u32 s58, 14
 s_cselect_b32 s51, s49, 0x7f000000
 s_waitcnt lgkmcnt(6)
 buffer_store_dwordx4 v[168:171], v5, s[44:47], s51 offen sc1
 s_add_u32 s49, s49, s52
 v_dot2_f32_bf16 v14, v168, v32, v14
 v_dot2_f32_bf16 v15, v169, v32, v15
 v_dot2_f32_bf16 v14, v170, v32, v14
 v_dot2_f32_bf16 v15, v171, v32, v15
 s_cmp_gt_u32 s58, 15
 s_cselect_b32 s51, s49, 0x7f000000
 s_waitcnt lgkmcnt(4)
 buffer_store_dwordx4 v[172:175], v5, s[44:47], s51 offen sc1
 s_add_u32 s49, s49, s53
 v_dot2_f32_bf16 v14, v172, v32, v14
 v_dot2_f32_bf16 v15, v173, v32, v15
 v_dot2_f32_bf16 v14, v174, v32, v14
 v_dot2_f32_bf16 v15, v175, v32, v15
 s_cmp_gt_u32 s58, 16
 s_cselect_b32 s51, s49, 0x7f000000
 s_waitcnt lgkmcnt(2)
 buffer_store_dwordx4 v[176:179], v5, s[44:47], s51 offen sc1
 s_add_u32 s49, s49, s52
 v_dot2_f32_bf16 v14, v176, v32, v14
 v_dot2_f32_bf16 v15, v177, v32, v15
 v_dot2_f32_bf16 v14, v178, v32, v14
 v_dot2_f32_bf16 v15, v179, v32, v15
 s_cmp_gt_u32 s58, 17
 s_cselect_b32 s51, s49, 0x7f000000
 s_waitcnt lgkmcnt(0)
 buffer_store_dwordx4 v[180:183], v5, s[44:47], s51 offen sc1
 s_add_u32 s49, s49, s53
 v_dot2_f32_bf16 v14, v180, v32, v14
 v_dot2_f32_bf16 v15, v181, v32, v15
 v_dot2_f32_bf16 v14, v182, v32, v14
 v_dot2_f32_bf16 v15, v183, v32, v15
 s_nop 3
 v_add_f32 v10, v14, v15
 v_cvt_pk_bf16_f32 v11, v10, v10
 v_lshlrev_b32 v12, 16, v11
 v_sub_f32 v13, v10, v12
 v_cvt_pk_bf16_f32 v14, v13, v13
 v_lshlrev_b32 v15, 16, v14
 v_sub_f32 v13, v13, v15
 v_cvt_pk_bf16_f32 v201, v13, v13
 v_and_b32 v201, 0xffff, v201
 v_and_b32 v200, 0xffff, v11
 v_or_b32 v200, v200, v15
 s_lshr_b32 s39, s20, 1
 s_lshl_b32 s39, s39, 9
 s_and_b32 s37, s20, 1
 s_lshl_b32 s37, s37, 3
 s_add_u32 s39, s39, s37
 s_add_u32 s39, s39, s48
 s_add_u32 s39, s39, 331776
 s_cmp_eq_u32 s66, 1
 s_cselect_b32 s39, s39, 0x7f000000
 buffer_store_dwordx2 v[200:201], v5, s[44:47], s39 offen sc1
 s_load_dwordx2 s[24:25], s[0:1], 80
 s_waitcnt lgkmcnt(0)
 s_and_b32 s25, s25, 0xffff
 s_mov_b32 s26, 256
 s_mov_b32 s27, 0x00020000
 s_mov_b64 exec, -1
 v_and_b32 v1, 63, v0
 v_lshlrev_b32 v1, 2, v1
 s_mov_b32 s3, 0
 s_mov_b32 s4, 0x01010101
kh1_gn2:
 buffer_load_dword v3, v1, s[24:27], 0 offen sc1
 s_add_u32 s3, s3, 1
 s_waitcnt vmcnt(0)
 v_cmp_ne_u32 vcc, s4, v3
 s_cmp_ge_u32 s3, 0x40000
 s_cbranch_scc1 kh1_gn2y
 s_cmp_eq_u64 vcc, 0
 s_cbranch_scc1 kh1_gn2y
 s_sleep 16
 s_branch kh1_gn2
kh1_gn2y:
 s_lshl_b32 s47, s2, 4
 s_lshl_b32 s3, s20, 2
 s_add_u32 s47, s47, s3
 s_add_u32 s47, s47, 327680
 s_mov_b64 exec, -1
 v_mov_b32 v1, s101
 v_mov_b32 v3, 0
 s_waitcnt vmcnt(0)
 s_mov_b64 exec, 1
 buffer_store_dword v1, v3, s[76:79], s47 offen sc1
 s_mov_b64 exec, -1
kh1_rdone:
kh1_end:
 s_cmp_eq_u32 s100, 0
 s_cbranch_scc1 mega_p1
 s_endpgm
.p2align 6
kh_body:
 s_mov_b64 exec, -1
 s_barrier
 s_load_dwordx4 s[8:11], s[0:1], 24
 s_load_dwordx2 s[18:19], s[0:1], 88
 v_lshrrev_b32 v1, 6, v0
 v_and_b32 v2, 63, v0
 v_readfirstlane_b32 s20, v1
 s_and_b32 s21, s2, 7
 s_lshr_b32 s22, s2, 3
 s_lshl_b32 s21, s21, 1
 s_and_b32 s23, s22, 1
 s_add_u32 s21, s21, s23
 s_mov_b32 s55, s21
 s_lshr_b32 s22, s22, 1
 s_mov_b32 s54, s22
 s_and_b32 s23, s22, 7
 s_lshr_b32 s22, s22, 3
 s_lshl_b32 s21, s21, 2
 s_add_u32 s21, s21, s20
 s_waitcnt lgkmcnt(0)
 s_add_u32 s76, s18, 90517504
 s_addc_u32 s77, s19, 0
 s_and_b32 s77, s77, 0xffff
 s_mov_b32 s78, 524288
 s_mov_b32 s79, 0x00020000
 s_cmp_ge_u32 s20, 4
 s_cbranch_scc1 kh_idle
 s_cmp_eq_u32 s22, 1
 s_cselect_b32 s4, s10, s8
 s_cselect_b32 s5, s11, s9
 s_mov_b32 s24, s4
 s_and_b32 s25, s5, 0xffff
 s_mov_b32 s26, 663552
 s_mov_b32 s27, 0x00020000
 s_add_u32 s28, s18, s70
 s_addc_u32 s29, s19, 0
 s_and_b32 s29, s29, 0xffff
 s_mov_b32 s30, 2359296
 s_mov_b32 s31, 0x00020000
 s_add_u32 s32, s18, s71
 s_addc_u32 s33, s19, 0
 s_and_b32 s33, s33, 0xffff
 s_mov_b32 s34, 262144
 s_mov_b32 s35, 0x00020000
 s_add_u32 s36, s18, 50388992
 s_addc_u32 s37, s19, 0
 s_and_b32 s37, s37, 0xffff
 s_mov_b32 s38, 5120
 s_mov_b32 s39, 0x00020000
 s_add_u32 s40, s18, s72
 s_addc_u32 s41, s19, 0
 s_and_b32 s41, s41, 0xffff
 s_mov_b32 s42, 4718592
 s_mov_b32 s43, 0x00020000
 v_lshrrev_b32 v3, 3, v2
 v_and_b32 v4, 7, v2
 v_lshrrev_b32 v5, 1, v3
 v_xor_b32 v5, v5, v4
 v_lshlrev_b32 v5, 4, v5
 v_lshrrev_b32 v6, 2, v3
 v_and_b32 v7, 3, v3
 v_lshl_add_u32 v6, v6, 3, v7
 v_mul_u32_u24 v6, 1152, v6
 v_add_u32 v8, v6, v5
 v_xor_b32 v7, 64, v5
 v_add_u32 v9, v6, v7
 v_mul_u32_u24 v6, 1152, v3
 v_add_u32 v10, v6, v5
 v_and_b32 v11, 15, v2
 v_lshrrev_b32 v12, 4, v2
 v_lshlrev_b32 v13, 9, v12
 v_lshl_add_u32 v13, v11, 4, v13
 s_mul_i32 s48, s23, 82944
 s_lshl_b32 s49, s20, 7
 s_add_u32 s48, s48, s49
 s_mul_i32 s49, s20, 9216
 s_mul_i32 s44, s21, 36864
 s_mov_b32 s45, s44
 s_mov_b32 s46, s44
 v_lshlrev_b32 v1, 2, v2
 s_lshl_b32 s47, s21, 7
 s_add_u32 s47, s47, s64
 s_mov_b32 s3, 0
 s_mov_b64 exec, 4294967295
 s_mov_b32 exec_hi, 0
kh_pl1:
 buffer_load_dword v230, v1, s[76:79], s47 offen sc1
 s_add_u32 s3, s3, 1
 s_waitcnt vmcnt(0)
 v_cmp_ne_u32 vcc, s101, v230
 s_cmp_ge_u32 s3, 0x40000
 s_cbranch_scc1 kh_pl1y
 s_cmp_eq_u64 vcc, 0
 s_cbranch_scc1 kh_pl1y
 s_sleep 3
 s_branch kh_pl1
kh_pl1y:
 s_mov_b64 exec, -1
kh_pl1x:
 buffer_load_dwordx4 v[16:19], v13, s[28:31], s45 offen offset:0 sc1
 buffer_load_dwordx4 v[20:23], v13, s[28:31], s45 offen offset:256 sc1
 buffer_load_dwordx4 v[24:27], v13, s[28:31], s45 offen offset:2048 sc1
 buffer_load_dwordx4 v[28:31], v13, s[28:31], s45 offen offset:2304 sc1
 s_add_u32 s45, s45, 4096
 buffer_load_dwordx4 v[32:35], v13, s[28:31], s45 offen offset:0 sc1
 buffer_load_dwordx4 v[36:39], v13, s[28:31], s45 offen offset:256 sc1
 buffer_load_dwordx4 v[40:43], v13, s[28:31], s45 offen offset:2048 sc1
 buffer_load_dwordx4 v[44:47], v13, s[28:31], s45 offen offset:2304 sc1
 s_add_u32 s45, s45, 4096
 buffer_load_dwordx4 v[48:51], v13, s[28:31], s45 offen offset:0 sc1
 buffer_load_dwordx4 v[52:55], v13, s[28:31], s45 offen offset:256 sc1
 buffer_load_dwordx4 v[56:59], v13, s[28:31], s45 offen offset:2048 sc1
 buffer_load_dwordx4 v[60:63], v13, s[28:31], s45 offen offset:2304 sc1
 v_mov_b32 v152, 0
 v_mov_b32 v153, 0
 v_mov_b32 v154, 0
 v_mov_b32 v155, 0
 v_mov_b32 v156, 0
 v_mov_b32 v157, 0
 v_mov_b32 v158, 0
 v_mov_b32 v159, 0
 v_mov_b32 v160, 0
 v_mov_b32 v161, 0
 v_mov_b32 v162, 0
 v_mov_b32 v163, 0
 v_mov_b32 v164, 0
 v_mov_b32 v165, 0
 v_mov_b32 v166, 0
 v_mov_b32 v167, 0
 v_mov_b32 v168, 0
 v_mov_b32 v169, 0
 v_mov_b32 v170, 0
 v_mov_b32 v171, 0
 v_mov_b32 v172, 0
 v_mov_b32 v173, 0
 v_mov_b32 v174, 0
 v_mov_b32 v175, 0
 v_mov_b32 v176, 0
 v_mov_b32 v177, 0
 v_mov_b32 v178, 0
 v_mov_b32 v179, 0
 v_mov_b32 v180, 0
 v_mov_b32 v181, 0
 v_mov_b32 v182, 0
 v_mov_b32 v183, 0
 v_mov_b32 v184, 0
 v_mov_b32 v185, 0
 v_mov_b32 v186, 0
 v_mov_b32 v187, 0
 v_mov_b32 v188, 0
 v_mov_b32 v189, 0
 v_mov_b32 v190, 0
 v_mov_b32 v191, 0
 v_lshrrev_b32 v1, 1, v11
 v_xor_b32 v1, v1, v12
 v_lshlrev_b32 v1, 4, v1
 v_lshl_add_u32 v216, v11, 7, v1
 v_add_u32 v216, 73728, v216
 v_xor_b32 v217, 64, v216
 v_add_u32 v218, 46080, v216
 v_add_u32 v219, 46080, v217
 v_and_b32 v224, 31, v2
 v_lshrrev_b32 v225, 5, v2
 v_lshlrev_b32 v225, 17, v225
 v_lshl_add_u32 v225, v224, 3, v225
 s_lshl_b32 s53, s21, 8
 s_mul_i32 s47, s54, 320
 v_lshlrev_b32 v226, 2, v11
 s_barrier
 ds_read_b128 v[112:115], v216 offset:0
 ds_read_b128 v[116:119], v216 offset:2048
 ds_read_b128 v[120:123], v216 offset:4096
 ds_read_b128 v[124:127], v216 offset:6144
 ds_read_b128 v[128:131], v216 offset:8192
 s_add_u32 s45, s45, 4096
 buffer_load_dwordx4 v[64:67], v13, s[28:31], s45 offen offset:0 sc1
 buffer_load_dwordx4 v[68:71], v13, s[28:31], s45 offen offset:256 sc1
 s_waitcnt lgkmcnt(0)
 ds_read_b128 v[132:135], v217 offset:0
 ds_read_b128 v[136:139], v217 offset:2048
 ds_read_b128 v[140:143], v217 offset:4096
 ds_read_b128 v[144:147], v217 offset:6144
 ds_read_b128 v[148:151], v217 offset:8192
 s_waitcnt vmcnt(12)
 v_mfma_f32_16x16x32_bf16 v[152:155], v[16:19], v[112:115], v[152:155]
 v_mfma_f32_16x16x32_bf16 v[156:159], v[16:19], v[116:119], v[156:159]
 v_mfma_f32_16x16x32_bf16 v[160:163], v[16:19], v[120:123], v[160:163]
 v_mfma_f32_16x16x32_bf16 v[164:167], v[16:19], v[124:127], v[164:167]
 v_mfma_f32_16x16x32_bf16 v[168:171], v[16:19], v[128:131], v[168:171]
 v_mfma_f32_16x16x32_bf16 v[172:175], v[20:23], v[112:115], v[172:175]
 v_mfma_f32_16x16x32_bf16 v[176:179], v[20:23], v[116:119], v[176:179]
 v_mfma_f32_16x16x32_bf16 v[180:183], v[20:23], v[120:123], v[180:183]
 v_mfma_f32_16x16x32_bf16 v[184:187], v[20:23], v[124:127], v[184:187]
 v_mfma_f32_16x16x32_bf16 v[188:191], v[20:23], v[128:131], v[188:191]
 buffer_load_dwordx4 v[72:75], v13, s[28:31], s45 offen offset:2048 sc1
 buffer_load_dwordx4 v[76:79], v13, s[28:31], s45 offen offset:2304 sc1
 s_waitcnt lgkmcnt(0)
 ds_read_b128 v[112:115], v216 offset:9216
 ds_read_b128 v[116:119], v216 offset:11264
 ds_read_b128 v[120:123], v216 offset:13312
 ds_read_b128 v[124:127], v216 offset:15360
 ds_read_b128 v[128:131], v216 offset:17408
 s_waitcnt vmcnt(12)
 v_mfma_f32_16x16x32_bf16 v[152:155], v[24:27], v[132:135], v[152:155]
 v_mfma_f32_16x16x32_bf16 v[156:159], v[24:27], v[136:139], v[156:159]
 v_mfma_f32_16x16x32_bf16 v[160:163], v[24:27], v[140:143], v[160:163]
 v_mfma_f32_16x16x32_bf16 v[164:167], v[24:27], v[144:147], v[164:167]
 v_mfma_f32_16x16x32_bf16 v[168:171], v[24:27], v[148:151], v[168:171]
 v_mfma_f32_16x16x32_bf16 v[172:175], v[28:31], v[132:135], v[172:175]
 v_mfma_f32_16x16x32_bf16 v[176:179], v[28:31], v[136:139], v[176:179]
 v_mfma_f32_16x16x32_bf16 v[180:183], v[28:31], v[140:143], v[180:183]
 v_mfma_f32_16x16x32_bf16 v[184:187], v[28:31], v[144:147], v[184:187]
 v_mfma_f32_16x16x32_bf16 v[188:191], v[28:31], v[148:151], v[188:191]
 s_add_u32 s45, s45, 4096
 buffer_load_dwordx4 v[80:83], v13, s[28:31], s45 offen offset:0 sc1
 buffer_load_dwordx4 v[84:87], v13, s[28:31], s45 offen offset:256 sc1
 s_waitcnt lgkmcnt(0)
 ds_read_b128 v[132:135], v217 offset:9216
 ds_read_b128 v[136:139], v217 offset:11264
 ds_read_b128 v[140:143], v217 offset:13312
 ds_read_b128 v[144:147], v217 offset:15360
 ds_read_b128 v[148:151], v217 offset:17408
 s_waitcnt vmcnt(12)
 v_mfma_f32_16x16x32_bf16 v[152:155], v[32:35], v[112:115], v[152:155]
 v_mfma_f32_16x16x32_bf16 v[156:159], v[32:35], v[116:119], v[156:159]
 v_mfma_f32_16x16x32_bf16 v[160:163], v[32:35], v[120:123], v[160:163]
 v_mfma_f32_16x16x32_bf16 v[164:167], v[32:35], v[124:127], v[164:167]
 v_mfma_f32_16x16x32_bf16 v[168:171], v[32:35], v[128:131], v[168:171]
 v_mfma_f32_16x16x32_bf16 v[172:175], v[36:39], v[112:115], v[172:175]
 v_mfma_f32_16x16x32_bf16 v[176:179], v[36:39], v[116:119], v[176:179]
 v_mfma_f32_16x16x32_bf16 v[180:183], v[36:39], v[120:123], v[180:183]
 v_mfma_f32_16x16x32_bf16 v[184:187], v[36:39], v[124:127], v[184:187]
 v_mfma_f32_16x16x32_bf16 v[188:191], v[36:39], v[128:131], v[188:191]
 buffer_load_dwordx4 v[88:91], v13, s[28:31], s45 offen offset:2048 sc1
 buffer_load_dwordx4 v[92:95], v13, s[28:31], s45 offen offset:2304 sc1
 s_waitcnt lgkmcnt(0)
 ds_read_b128 v[112:115], v216 offset:18432
 ds_read_b128 v[116:119], v216 offset:20480
 ds_read_b128 v[120:123], v216 offset:22528
 ds_read_b128 v[124:127], v216 offset:24576
 ds_read_b128 v[128:131], v216 offset:26624
 s_waitcnt vmcnt(12)
 v_mfma_f32_16x16x32_bf16 v[152:155], v[40:43], v[132:135], v[152:155]
 v_mfma_f32_16x16x32_bf16 v[156:159], v[40:43], v[136:139], v[156:159]
 v_mfma_f32_16x16x32_bf16 v[160:163], v[40:43], v[140:143], v[160:163]
 v_mfma_f32_16x16x32_bf16 v[164:167], v[40:43], v[144:147], v[164:167]
 v_mfma_f32_16x16x32_bf16 v[168:171], v[40:43], v[148:151], v[168:171]
 v_mfma_f32_16x16x32_bf16 v[172:175], v[44:47], v[132:135], v[172:175]
 v_mfma_f32_16x16x32_bf16 v[176:179], v[44:47], v[136:139], v[176:179]
 v_mfma_f32_16x16x32_bf16 v[180:183], v[44:47], v[140:143], v[180:183]
 v_mfma_f32_16x16x32_bf16 v[184:187], v[44:47], v[144:147], v[184:187]
 v_mfma_f32_16x16x32_bf16 v[188:191], v[44:47], v[148:151], v[188:191]
 s_add_u32 s45, s45, 4096
 buffer_load_dwordx4 v[96:99], v13, s[28:31], s45 offen offset:0 sc1
 buffer_load_dwordx4 v[100:103], v13, s[28:31], s45 offen offset:256 sc1
 s_waitcnt lgkmcnt(0)
 ds_read_b128 v[132:135], v217 offset:18432
 ds_read_b128 v[136:139], v217 offset:20480
 ds_read_b128 v[140:143], v217 offset:22528
 ds_read_b128 v[144:147], v217 offset:24576
 ds_read_b128 v[148:151], v217 offset:26624
 s_waitcnt vmcnt(12)
 v_mfma_f32_16x16x32_bf16 v[152:155], v[48:51], v[112:115], v[152:155]
 v_mfma_f32_16x16x32_bf16 v[156:159], v[48:51], v[116:119], v[156:159]
 v_mfma_f32_16x16x32_bf16 v[160:163], v[48:51], v[120:123], v[160:163]
 v_mfma_f32_16x16x32_bf16 v[164:167], v[48:51], v[124:127], v[164:167]
 v_mfma_f32_16x16x32_bf16 v[168:171], v[48:51], v[128:131], v[168:171]
 v_mfma_f32_16x16x32_bf16 v[172:175], v[52:55], v[112:115], v[172:175]
 v_mfma_f32_16x16x32_bf16 v[176:179], v[52:55], v[116:119], v[176:179]
 v_mfma_f32_16x16x32_bf16 v[180:183], v[52:55], v[120:123], v[180:183]
 v_mfma_f32_16x16x32_bf16 v[184:187], v[52:55], v[124:127], v[184:187]
 v_mfma_f32_16x16x32_bf16 v[188:191], v[52:55], v[128:131], v[188:191]
 buffer_load_dwordx4 v[104:107], v13, s[28:31], s45 offen offset:2048 sc1
 buffer_load_dwordx4 v[108:111], v13, s[28:31], s45 offen offset:2304 sc1
 s_waitcnt lgkmcnt(0)
 ds_read_b128 v[112:115], v216 offset:27648
 ds_read_b128 v[116:119], v216 offset:29696
 ds_read_b128 v[120:123], v216 offset:31744
 ds_read_b128 v[124:127], v216 offset:33792
 ds_read_b128 v[128:131], v216 offset:35840
 s_waitcnt vmcnt(12)
 v_mfma_f32_16x16x32_bf16 v[152:155], v[56:59], v[132:135], v[152:155]
 v_mfma_f32_16x16x32_bf16 v[156:159], v[56:59], v[136:139], v[156:159]
 v_mfma_f32_16x16x32_bf16 v[160:163], v[56:59], v[140:143], v[160:163]
 v_mfma_f32_16x16x32_bf16 v[164:167], v[56:59], v[144:147], v[164:167]
 v_mfma_f32_16x16x32_bf16 v[168:171], v[56:59], v[148:151], v[168:171]
 v_mfma_f32_16x16x32_bf16 v[172:175], v[60:63], v[132:135], v[172:175]
 v_mfma_f32_16x16x32_bf16 v[176:179], v[60:63], v[136:139], v[176:179]
 v_mfma_f32_16x16x32_bf16 v[180:183], v[60:63], v[140:143], v[180:183]
 v_mfma_f32_16x16x32_bf16 v[184:187], v[60:63], v[144:147], v[184:187]
 v_mfma_f32_16x16x32_bf16 v[188:191], v[60:63], v[148:151], v[188:191]
 s_add_u32 s45, s45, 4096
 buffer_load_dwordx4 v[16:19], v13, s[28:31], s45 offen offset:0 sc1
 buffer_load_dwordx4 v[20:23], v13, s[28:31], s45 offen offset:256 sc1
 s_waitcnt lgkmcnt(0)
 ds_read_b128 v[132:135], v217 offset:27648
 ds_read_b128 v[136:139], v217 offset:29696
 ds_read_b128 v[140:143], v217 offset:31744
 ds_read_b128 v[144:147], v217 offset:33792
 ds_read_b128 v[148:151], v217 offset:35840
 s_waitcnt vmcnt(12)
 v_mfma_f32_16x16x32_bf16 v[152:155], v[64:67], v[112:115], v[152:155]
 v_mfma_f32_16x16x32_bf16 v[156:159], v[64:67], v[116:119], v[156:159]
 v_mfma_f32_16x16x32_bf16 v[160:163], v[64:67], v[120:123], v[160:163]
 v_mfma_f32_16x16x32_bf16 v[164:167], v[64:67], v[124:127], v[164:167]
 v_mfma_f32_16x16x32_bf16 v[168:171], v[64:67], v[128:131], v[168:171]
 v_mfma_f32_16x16x32_bf16 v[172:175], v[68:71], v[112:115], v[172:175]
 v_mfma_f32_16x16x32_bf16 v[176:179], v[68:71], v[116:119], v[176:179]
 v_mfma_f32_16x16x32_bf16 v[180:183], v[68:71], v[120:123], v[180:183]
 v_mfma_f32_16x16x32_bf16 v[184:187], v[68:71], v[124:127], v[184:187]
 v_mfma_f32_16x16x32_bf16 v[188:191], v[68:71], v[128:131], v[188:191]
 s_barrier
 s_and_b32 s50, s20, 1
 s_cmp_eq_u32 s50, 1
 s_cselect_b64 vcc, -1, 0
 v_cndmask_b32 v1, v8, v9, vcc
 s_lshl_b32 s50, s50, 4
 s_lshr_b32 s51, s20, 1
 s_lshl_b32 s51, s51, 2
 s_add_u32 s50, s50, s51
 s_mul_i32 s50, s50, 1152
 s_mul_i32 s48, s23, 82944
 s_add_u32 s48, s48, 1024
 s_add_u32 s50, s50, s48
 s_lshl_b32 s51, s20, 10
 s_add_u32 s51, s51, 73728
 s_mov_b32 m0, s51
 s_nop 0
 buffer_load_dwordx4 v1, s[24:27], s50 offen lds
 s_add_u32 m0, s51, 4096
 s_add_u32 s50, s50, 36864
 buffer_load_dwordx4 v1, s[24:27], s50 offen lds
 s_mov_b32 m0, 81920
 s_add_u32 s50, s48, 73728
 s_lshl_b32 s51, s20, 4
 s_mov_b64 exec, 0xffff
 s_lshl_b64 exec, exec, s51
 buffer_load_dwordx4 v10, s[24:27], s50 offen lds
 s_mov_b64 exec, -1
 buffer_load_dwordx4 v[24:27], v13, s[28:31], s45 offen offset:2048 sc1
 buffer_load_dwordx4 v[28:31], v13, s[28:31], s45 offen offset:2304 sc1
 s_waitcnt lgkmcnt(0)
 ds_read_b128 v[112:115], v216 offset:36864
 ds_read_b128 v[116:119], v216 offset:38912
 ds_read_b128 v[120:123], v216 offset:40960
 ds_read_b128 v[124:127], v216 offset:43008
 ds_read_b128 v[128:131], v216 offset:45056
 s_waitcnt vmcnt(15)
 v_mfma_f32_16x16x32_bf16 v[152:155], v[72:75], v[132:135], v[152:155]
 v_mfma_f32_16x16x32_bf16 v[156:159], v[72:75], v[136:139], v[156:159]
 v_mfma_f32_16x16x32_bf16 v[160:163], v[72:75], v[140:143], v[160:163]
 v_mfma_f32_16x16x32_bf16 v[164:167], v[72:75], v[144:147], v[164:167]
 v_mfma_f32_16x16x32_bf16 v[168:171], v[72:75], v[148:151], v[168:171]
 v_mfma_f32_16x16x32_bf16 v[172:175], v[76:79], v[132:135], v[172:175]
 v_mfma_f32_16x16x32_bf16 v[176:179], v[76:79], v[136:139], v[176:179]
 v_mfma_f32_16x16x32_bf16 v[180:183], v[76:79], v[140:143], v[180:183]
 v_mfma_f32_16x16x32_bf16 v[184:187], v[76:79], v[144:147], v[184:187]
 v_mfma_f32_16x16x32_bf16 v[188:191], v[76:79], v[148:151], v[188:191]
 s_add_u32 s45, s45, 4096
 buffer_load_dwordx4 v[32:35], v13, s[28:31], s45 offen offset:0 sc1
 buffer_load_dwordx4 v[36:39], v13, s[28:31], s45 offen offset:256 sc1
 s_waitcnt lgkmcnt(0)
 ds_read_b128 v[132:135], v217 offset:36864
 ds_read_b128 v[136:139], v217 offset:38912
 ds_read_b128 v[140:143], v217 offset:40960
 ds_read_b128 v[144:147], v217 offset:43008
 ds_read_b128 v[148:151], v217 offset:45056
 s_waitcnt vmcnt(15)
 v_mfma_f32_16x16x32_bf16 v[152:155], v[80:83], v[112:115], v[152:155]
 v_mfma_f32_16x16x32_bf16 v[156:159], v[80:83], v[116:119], v[156:159]
 v_mfma_f32_16x16x32_bf16 v[160:163], v[80:83], v[120:123], v[160:163]
 v_mfma_f32_16x16x32_bf16 v[164:167], v[80:83], v[124:127], v[164:167]
 v_mfma_f32_16x16x32_bf16 v[168:171], v[80:83], v[128:131], v[168:171]
 v_mfma_f32_16x16x32_bf16 v[172:175], v[84:87], v[112:115], v[172:175]
 v_mfma_f32_16x16x32_bf16 v[176:179], v[84:87], v[116:119], v[176:179]
 v_mfma_f32_16x16x32_bf16 v[180:183], v[84:87], v[120:123], v[180:183]
 v_mfma_f32_16x16x32_bf16 v[184:187], v[84:87], v[124:127], v[184:187]
 v_mfma_f32_16x16x32_bf16 v[188:191], v[84:87], v[128:131], v[188:191]
 buffer_load_dwordx4 v[40:43], v13, s[28:31], s45 offen offset:2048 sc1
 buffer_load_dwordx4 v[44:47], v13, s[28:31], s45 offen offset:2304 sc1
 s_waitcnt lgkmcnt(0)
 ds_read_b128 v[112:115], v218 offset:0
 ds_read_b128 v[116:119], v218 offset:2048
 ds_read_b128 v[120:123], v218 offset:4096
 ds_read_b128 v[124:127], v218 offset:6144
 ds_read_b128 v[128:131], v218 offset:8192
 s_waitcnt vmcnt(15)
 v_mfma_f32_16x16x32_bf16 v[152:155], v[88:91], v[132:135], v[152:155]
 v_mfma_f32_16x16x32_bf16 v[156:159], v[88:91], v[136:139], v[156:159]
 v_mfma_f32_16x16x32_bf16 v[160:163], v[88:91], v[140:143], v[160:163]
 v_mfma_f32_16x16x32_bf16 v[164:167], v[88:91], v[144:147], v[164:167]
 v_mfma_f32_16x16x32_bf16 v[168:171], v[88:91], v[148:151], v[168:171]
 v_mfma_f32_16x16x32_bf16 v[172:175], v[92:95], v[132:135], v[172:175]
 v_mfma_f32_16x16x32_bf16 v[176:179], v[92:95], v[136:139], v[176:179]
 v_mfma_f32_16x16x32_bf16 v[180:183], v[92:95], v[140:143], v[180:183]
 v_mfma_f32_16x16x32_bf16 v[184:187], v[92:95], v[144:147], v[184:187]
 v_mfma_f32_16x16x32_bf16 v[188:191], v[92:95], v[148:151], v[188:191]
 s_add_u32 s45, s45, 4096
 buffer_load_dwordx4 v[48:51], v13, s[28:31], s45 offen offset:0 sc1
 buffer_load_dwordx4 v[52:55], v13, s[28:31], s45 offen offset:256 sc1
 s_waitcnt lgkmcnt(0)
 ds_read_b128 v[132:135], v219 offset:0
 ds_read_b128 v[136:139], v219 offset:2048
 ds_read_b128 v[140:143], v219 offset:4096
 ds_read_b128 v[144:147], v219 offset:6144
 ds_read_b128 v[148:151], v219 offset:8192
 s_waitcnt vmcnt(15)
 v_mfma_f32_16x16x32_bf16 v[152:155], v[96:99], v[112:115], v[152:155]
 v_mfma_f32_16x16x32_bf16 v[156:159], v[96:99], v[116:119], v[156:159]
 v_mfma_f32_16x16x32_bf16 v[160:163], v[96:99], v[120:123], v[160:163]
 v_mfma_f32_16x16x32_bf16 v[164:167], v[96:99], v[124:127], v[164:167]
 v_mfma_f32_16x16x32_bf16 v[168:171], v[96:99], v[128:131], v[168:171]
 v_mfma_f32_16x16x32_bf16 v[172:175], v[100:103], v[112:115], v[172:175]
 v_mfma_f32_16x16x32_bf16 v[176:179], v[100:103], v[116:119], v[176:179]
 v_mfma_f32_16x16x32_bf16 v[180:183], v[100:103], v[120:123], v[180:183]
 v_mfma_f32_16x16x32_bf16 v[184:187], v[100:103], v[124:127], v[184:187]
 v_mfma_f32_16x16x32_bf16 v[188:191], v[100:103], v[128:131], v[188:191]
 buffer_load_dwordx4 v[56:59], v13, s[28:31], s45 offen offset:2048 sc1
 buffer_load_dwordx4 v[60:63], v13, s[28:31], s45 offen offset:2304 sc1
 s_waitcnt lgkmcnt(0)
 ds_read_b128 v[112:115], v218 offset:9216
 ds_read_b128 v[116:119], v218 offset:11264
 ds_read_b128 v[120:123], v218 offset:13312
 ds_read_b128 v[124:127], v218 offset:15360
 ds_read_b128 v[128:131], v218 offset:17408
 s_waitcnt vmcnt(15)
 v_mfma_f32_16x16x32_bf16 v[152:155], v[104:107], v[132:135], v[152:155]
 v_mfma_f32_16x16x32_bf16 v[156:159], v[104:107], v[136:139], v[156:159]
 v_mfma_f32_16x16x32_bf16 v[160:163], v[104:107], v[140:143], v[160:163]
 v_mfma_f32_16x16x32_bf16 v[164:167], v[104:107], v[144:147], v[164:167]
 v_mfma_f32_16x16x32_bf16 v[168:171], v[104:107], v[148:151], v[168:171]
 v_mfma_f32_16x16x32_bf16 v[172:175], v[108:111], v[132:135], v[172:175]
 v_mfma_f32_16x16x32_bf16 v[176:179], v[108:111], v[136:139], v[176:179]
 v_mfma_f32_16x16x32_bf16 v[180:183], v[108:111], v[140:143], v[180:183]
 v_mfma_f32_16x16x32_bf16 v[184:187], v[108:111], v[144:147], v[184:187]
 v_mfma_f32_16x16x32_bf16 v[188:191], v[108:111], v[148:151], v[188:191]
 s_waitcnt lgkmcnt(0)
 ds_read_b128 v[132:135], v219 offset:9216
 ds_read_b128 v[136:139], v219 offset:11264
 ds_read_b128 v[140:143], v219 offset:13312
 ds_read_b128 v[144:147], v219 offset:15360
 ds_read_b128 v[148:151], v219 offset:17408
 s_waitcnt vmcnt(13)
 v_mfma_f32_16x16x32_bf16 v[152:155], v[16:19], v[112:115], v[152:155]
 v_mfma_f32_16x16x32_bf16 v[156:159], v[16:19], v[116:119], v[156:159]
 v_mfma_f32_16x16x32_bf16 v[160:163], v[16:19], v[120:123], v[160:163]
 v_mfma_f32_16x16x32_bf16 v[164:167], v[16:19], v[124:127], v[164:167]
 v_mfma_f32_16x16x32_bf16 v[168:171], v[16:19], v[128:131], v[168:171]
 v_mfma_f32_16x16x32_bf16 v[172:175], v[20:23], v[112:115], v[172:175]
 v_mfma_f32_16x16x32_bf16 v[176:179], v[20:23], v[116:119], v[176:179]
 v_mfma_f32_16x16x32_bf16 v[180:183], v[20:23], v[120:123], v[180:183]
 v_mfma_f32_16x16x32_bf16 v[184:187], v[20:23], v[124:127], v[184:187]
 v_mfma_f32_16x16x32_bf16 v[188:191], v[20:23], v[128:131], v[188:191]
 s_waitcnt lgkmcnt(0)
 ds_read_b128 v[112:115], v218 offset:18432
 ds_read_b128 v[116:119], v218 offset:20480
 ds_read_b128 v[120:123], v218 offset:22528
 ds_read_b128 v[124:127], v218 offset:24576
 ds_read_b128 v[128:131], v218 offset:26624
 s_waitcnt vmcnt(8)
 v_mfma_f32_16x16x32_bf16 v[152:155], v[24:27], v[132:135], v[152:155]
 v_mfma_f32_16x16x32_bf16 v[156:159], v[24:27], v[136:139], v[156:159]
 v_mfma_f32_16x16x32_bf16 v[160:163], v[24:27], v[140:143], v[160:163]
 v_mfma_f32_16x16x32_bf16 v[164:167], v[24:27], v[144:147], v[164:167]
 v_mfma_f32_16x16x32_bf16 v[168:171], v[24:27], v[148:151], v[168:171]
 v_mfma_f32_16x16x32_bf16 v[172:175], v[28:31], v[132:135], v[172:175]
 v_mfma_f32_16x16x32_bf16 v[176:179], v[28:31], v[136:139], v[176:179]
 v_mfma_f32_16x16x32_bf16 v[180:183], v[28:31], v[140:143], v[180:183]
 v_mfma_f32_16x16x32_bf16 v[184:187], v[28:31], v[144:147], v[184:187]
 v_mfma_f32_16x16x32_bf16 v[188:191], v[28:31], v[148:151], v[188:191]
 s_waitcnt lgkmcnt(0)
 ds_read_b128 v[132:135], v219 offset:18432
 ds_read_b128 v[136:139], v219 offset:20480
 ds_read_b128 v[140:143], v219 offset:22528
 ds_read_b128 v[144:147], v219 offset:24576
 ds_read_b128 v[148:151], v219 offset:26624
 s_add_u32 s57, s53, 0
 buffer_load_dwordx2 v[16:17], v225, s[32:35], s57 offen sc1
 s_add_u32 s57, s53, 16384
 buffer_load_dwordx2 v[18:19], v225, s[32:35], s57 offen sc1
 s_add_u32 s57, s53, 32768
 buffer_load_dwordx2 v[20:21], v225, s[32:35], s57 offen sc1
 s_add_u32 s57, s53, 49152
 buffer_load_dwordx2 v[22:23], v225, s[32:35], s57 offen sc1
 s_add_u32 s57, s53, 65536
 buffer_load_dwordx2 v[24:25], v225, s[32:35], s57 offen sc1
 s_add_u32 s57, s53, 81920
 buffer_load_dwordx2 v[26:27], v225, s[32:35], s57 offen sc1
 s_add_u32 s57, s53, 98304
 buffer_load_dwordx2 v[28:29], v225, s[32:35], s57 offen sc1
 s_add_u32 s57, s53, 114688
 buffer_load_dwordx2 v[30:31], v225, s[32:35], s57 offen sc1
 buffer_load_dword v192, v226, s[36:39], s47 offen offset:0 sc1
 buffer_load_dword v196, v226, s[36:39], s47 offen offset:64 sc1
 buffer_load_dword v200, v226, s[36:39], s47 offen offset:128 sc1
 buffer_load_dword v204, v226, s[36:39], s47 offen offset:192 sc1
 buffer_load_dword v208, v226, s[36:39], s47 offen offset:256 sc1
 s_waitcnt vmcnt(19)
 v_mfma_f32_16x16x32_bf16 v[152:155], v[32:35], v[112:115], v[152:155]
 v_mfma_f32_16x16x32_bf16 v[156:159], v[32:35], v[116:119], v[156:159]
 v_mfma_f32_16x16x32_bf16 v[160:163], v[32:35], v[120:123], v[160:163]
 v_mfma_f32_16x16x32_bf16 v[164:167], v[32:35], v[124:127], v[164:167]
 v_mfma_f32_16x16x32_bf16 v[168:171], v[32:35], v[128:131], v[168:171]
 v_mfma_f32_16x16x32_bf16 v[172:175], v[36:39], v[112:115], v[172:175]
 v_mfma_f32_16x16x32_bf16 v[176:179], v[36:39], v[116:119], v[176:179]
 v_mfma_f32_16x16x32_bf16 v[180:183], v[36:39], v[120:123], v[180:183]
 v_mfma_f32_16x16x32_bf16 v[184:187], v[36:39], v[124:127], v[184:187]
 v_mfma_f32_16x16x32_bf16 v[188:191], v[36:39], v[128:131], v[188:191]
 s_barrier
 s_waitcnt lgkmcnt(0)
 ds_read_b128 v[112:115], v216 offset:0
 ds_read_b128 v[116:119], v216 offset:2048
 ds_read_b128 v[120:123], v216 offset:4096
 ds_read_b128 v[124:127], v216 offset:6144
 ds_read_b128 v[128:131], v216 offset:8192
 s_waitcnt vmcnt(17)
 v_mfma_f32_16x16x32_bf16 v[152:155], v[40:43], v[132:135], v[152:155]
 v_mfma_f32_16x16x32_bf16 v[156:159], v[40:43], v[136:139], v[156:159]
 v_mfma_f32_16x16x32_bf16 v[160:163], v[40:43], v[140:143], v[160:163]
 v_mfma_f32_16x16x32_bf16 v[164:167], v[40:43], v[144:147], v[164:167]
 v_mfma_f32_16x16x32_bf16 v[168:171], v[40:43], v[148:151], v[168:171]
 v_mfma_f32_16x16x32_bf16 v[172:175], v[44:47], v[132:135], v[172:175]
 v_mfma_f32_16x16x32_bf16 v[176:179], v[44:47], v[136:139], v[176:179]
 v_mfma_f32_16x16x32_bf16 v[180:183], v[44:47], v[140:143], v[180:183]
 v_mfma_f32_16x16x32_bf16 v[184:187], v[44:47], v[144:147], v[184:187]
 v_mfma_f32_16x16x32_bf16 v[188:191], v[44:47], v[148:151], v[188:191]
 s_waitcnt lgkmcnt(0)
 ds_read_b128 v[132:135], v217 offset:0
 ds_read_b128 v[136:139], v217 offset:2048
 ds_read_b128 v[140:143], v217 offset:4096
 ds_read_b128 v[144:147], v217 offset:6144
 ds_read_b128 v[148:151], v217 offset:8192
 s_waitcnt vmcnt(15)
 v_mfma_f32_16x16x32_bf16 v[152:155], v[48:51], v[112:115], v[152:155]
 v_mfma_f32_16x16x32_bf16 v[156:159], v[48:51], v[116:119], v[156:159]
 v_mfma_f32_16x16x32_bf16 v[160:163], v[48:51], v[120:123], v[160:163]
 v_mfma_f32_16x16x32_bf16 v[164:167], v[48:51], v[124:127], v[164:167]
 v_mfma_f32_16x16x32_bf16 v[168:171], v[48:51], v[128:131], v[168:171]
 v_mfma_f32_16x16x32_bf16 v[172:175], v[52:55], v[112:115], v[172:175]
 v_mfma_f32_16x16x32_bf16 v[176:179], v[52:55], v[116:119], v[176:179]
 v_mfma_f32_16x16x32_bf16 v[180:183], v[52:55], v[120:123], v[180:183]
 v_mfma_f32_16x16x32_bf16 v[184:187], v[52:55], v[124:127], v[184:187]
 v_mfma_f32_16x16x32_bf16 v[188:191], v[52:55], v[128:131], v[188:191]
 s_waitcnt lgkmcnt(0)
 s_waitcnt vmcnt(13)
 v_mfma_f32_16x16x32_bf16 v[152:155], v[56:59], v[132:135], v[152:155]
 v_mfma_f32_16x16x32_bf16 v[156:159], v[56:59], v[136:139], v[156:159]
 v_mfma_f32_16x16x32_bf16 v[160:163], v[56:59], v[140:143], v[160:163]
 v_mfma_f32_16x16x32_bf16 v[164:167], v[56:59], v[144:147], v[164:167]
 v_mfma_f32_16x16x32_bf16 v[168:171], v[56:59], v[148:151], v[168:171]
 v_mfma_f32_16x16x32_bf16 v[172:175], v[60:63], v[132:135], v[172:175]
 v_mfma_f32_16x16x32_bf16 v[176:179], v[60:63], v[136:139], v[176:179]
 v_mfma_f32_16x16x32_bf16 v[180:183], v[60:63], v[140:143], v[180:183]
 v_mfma_f32_16x16x32_bf16 v[184:187], v[60:63], v[144:147], v[184:187]
 v_mfma_f32_16x16x32_bf16 v[188:191], v[60:63], v[148:151], v[188:191]
 s_lshl_b32 s50, s20, 8
 s_add_u32 s50, s50, 148480
 s_waitcnt vmcnt(0)
 v_add_f32 v16, v16, v18
 v_add_f32 v17, v17, v19
 v_add_f32 v16, v16, v20
 v_add_f32 v17, v17, v21
 v_add_f32 v16, v16, v22
 v_add_f32 v17, v17, v23
 v_add_f32 v16, v16, v24
 v_add_f32 v17, v17, v25
 v_add_f32 v16, v16, v26
 v_add_f32 v17, v17, v27
 v_add_f32 v16, v16, v28
 v_add_f32 v17, v17, v29
 v_add_f32 v16, v16, v30
 v_add_f32 v17, v17, v31
 v_mov_b32 v18, v16
 v_mov_b32 v19, v17
 s_nop 1
 v_permlane32_swap_b32 v16, v18
 v_permlane32_swap_b32 v17, v19
 s_nop 1
 v_add_f32 v16, v16, v18
 v_add_f32 v17, v17, v19
 v_mov_b32 v234, 0x3ae38e39
 v_mul_f32 v235, v16, v234
 v_mul_f32 v236, v17, v234
 v_fma_f32 v236, -v235, v235, v236
 v_max_f32 v236, 0, v236
 v_cvt_pk_bf16_f32 v234, v235, v236
 v_lshlrev_b32 v232, 16, v234
 v_and_b32 v236, 0xffff0000, v234
 v_add_f32 v236, 0x3727c5ac, v236
 v_cvt_pk_bf16_f32 v234, v236, v236
 v_lshlrev_b32 v236, 16, v234
 v_sqrt_f32 v236, v236
 s_nop 0
 v_cvt_pk_bf16_f32 v234, v236, v236
 v_lshlrev_b32 v233, 16, v234
 v_rcp_f32 v233, v233
 s_nop 0
 v_mul_f32 v232, v232, v233
 v_lshl_add_u32 v226, v224, 3, s50
 ds_write_b64 v226, v[232:233]
 v_lshl_add_u32 v226, v12, 5, s50
 s_waitcnt lgkmcnt(0)
 ds_read_b128 v[232:235], v226
 ds_read_b128 v[236:239], v226 offset:16
 ds_read_b128 v[240:243], v226 offset:128
 ds_read_b128 v[244:247], v226 offset:144
 v_mul_u32_u24 v15, 1152, v12
 v_lshl_add_u32 v15, v11, 4, v15
 s_mul_i32 s46, s54, 294912
 s_mul_i32 s47, s21, 4608
 s_add_u32 s46, s46, s47
 s_waitcnt lgkmcnt(0)
 v_mul_f32 v152, v152, v233
 v_fma_f32 v152, -v232, v192, v152
 v_mul_f32 v153, v153, v235
 v_fma_f32 v153, -v234, v192, v153
 v_mul_f32 v154, v154, v237
 v_fma_f32 v154, -v236, v192, v154
 v_mul_f32 v155, v155, v239
 v_fma_f32 v155, -v238, v192, v155
 v_mul_f32 v172, v172, v241
 v_fma_f32 v172, -v240, v192, v172
 v_mul_f32 v173, v173, v243
 v_fma_f32 v173, -v242, v192, v173
 v_mul_f32 v174, v174, v245
 v_fma_f32 v174, -v244, v192, v174
 v_mul_f32 v175, v175, v247
 v_fma_f32 v175, -v246, v192, v175
 v_cvt_pk_bf16_f32 v48, v152, v153
 v_cvt_pk_bf16_f32 v49, v154, v155
 v_cvt_pk_bf16_f32 v50, v172, v173
 v_cvt_pk_bf16_f32 v51, v174, v175
 buffer_store_dwordx4 v[48:51], v15, s[40:43], s46 offen offset:0 sc1
 v_mul_f32 v156, v156, v233
 v_fma_f32 v156, -v232, v196, v156
 v_mul_f32 v157, v157, v235
 v_fma_f32 v157, -v234, v196, v157
 v_mul_f32 v158, v158, v237
 v_fma_f32 v158, -v236, v196, v158
 v_mul_f32 v159, v159, v239
 v_fma_f32 v159, -v238, v196, v159
 v_mul_f32 v176, v176, v241
 v_fma_f32 v176, -v240, v196, v176
 v_mul_f32 v177, v177, v243
 v_fma_f32 v177, -v242, v196, v177
 v_mul_f32 v178, v178, v245
 v_fma_f32 v178, -v244, v196, v178
 v_mul_f32 v179, v179, v247
 v_fma_f32 v179, -v246, v196, v179
 v_cvt_pk_bf16_f32 v52, v156, v157
 v_cvt_pk_bf16_f32 v53, v158, v159
 v_cvt_pk_bf16_f32 v54, v176, v177
 v_cvt_pk_bf16_f32 v55, v178, v179
 buffer_store_dwordx4 v[52:55], v15, s[40:43], s46 offen offset:256 sc1
 v_mul_f32 v160, v160, v233
 v_fma_f32 v160, -v232, v200, v160
 v_mul_f32 v161, v161, v235
 v_fma_f32 v161, -v234, v200, v161
 v_mul_f32 v162, v162, v237
 v_fma_f32 v162, -v236, v200, v162
 v_mul_f32 v163, v163, v239
 v_fma_f32 v163, -v238, v200, v163
 v_mul_f32 v180, v180, v241
 v_fma_f32 v180, -v240, v200, v180
 v_mul_f32 v181, v181, v243
 v_fma_f32 v181, -v242, v200, v181
 v_mul_f32 v182, v182, v245
 v_fma_f32 v182, -v244, v200, v182
 v_mul_f32 v183, v183, v247
 v_fma_f32 v183, -v246, v200, v183
 v_cvt_pk_bf16_f32 v56, v160, v161
 v_cvt_pk_bf16_f32 v57, v162, v163
 v_cvt_pk_bf16_f32 v58, v180, v181
 v_cvt_pk_bf16_f32 v59, v182, v183
 buffer_store_dwordx4 v[56:59], v15, s[40:43], s46 offen offset:512 sc1
 v_mul_f32 v164, v164, v233
 v_fma_f32 v164, -v232, v204, v164
 v_mul_f32 v165, v165, v235
 v_fma_f32 v165, -v234, v204, v165
 v_mul_f32 v166, v166, v237
 v_fma_f32 v166, -v236, v204, v166
 v_mul_f32 v167, v167, v239
 v_fma_f32 v167, -v238, v204, v167
 v_mul_f32 v184, v184, v241
 v_fma_f32 v184, -v240, v204, v184
 v_mul_f32 v185, v185, v243
 v_fma_f32 v185, -v242, v204, v185
 v_mul_f32 v186, v186, v245
 v_fma_f32 v186, -v244, v204, v186
 v_mul_f32 v187, v187, v247
 v_fma_f32 v187, -v246, v204, v187
 v_cvt_pk_bf16_f32 v60, v164, v165
 v_cvt_pk_bf16_f32 v61, v166, v167
 v_cvt_pk_bf16_f32 v62, v184, v185
 v_cvt_pk_bf16_f32 v63, v186, v187
 buffer_store_dwordx4 v[60:63], v15, s[40:43], s46 offen offset:768 sc1
 v_mul_f32 v168, v168, v233
 v_fma_f32 v168, -v232, v208, v168
 v_mul_f32 v169, v169, v235
 v_fma_f32 v169, -v234, v208, v169
 v_mul_f32 v170, v170, v237
 v_fma_f32 v170, -v236, v208, v170
 v_mul_f32 v171, v171, v239
 v_fma_f32 v171, -v238, v208, v171
 v_mul_f32 v188, v188, v241
 v_fma_f32 v188, -v240, v208, v188
 v_mul_f32 v189, v189, v243
 v_fma_f32 v189, -v242, v208, v189
 v_mul_f32 v190, v190, v245
 v_fma_f32 v190, -v244, v208, v190
 v_mul_f32 v191, v191, v247
 v_fma_f32 v191, -v246, v208, v191
 v_cvt_pk_bf16_f32 v64, v168, v169
 v_cvt_pk_bf16_f32 v65, v170, v171
 v_cvt_pk_bf16_f32 v66, v188, v189
 v_cvt_pk_bf16_f32 v67, v190, v191
 v_cmp_gt_u32 vcc, 8, v11
 s_and_saveexec_b64 s[50:51], vcc
 buffer_store_dwordx4 v[64:67], v15, s[40:43], s46 offen offset:1024 sc1
 s_lshl_b32 s47, s54, 8
 s_lshl_b32 s3, s21, 2
 s_add_u32 s47, s47, s3
 s_add_u32 s47, s47, s65
 s_mov_b64 exec, -1
 v_mov_b32 v1, s101
 v_mov_b32 v3, 0
 s_waitcnt vmcnt(0)
 s_mov_b64 exec, 1
 buffer_store_dword v1, v3, s[76:79], s47 offen sc1
 s_mov_b64 exec, -1
 s_branch kh_end
kh_idle:
 s_waitcnt vmcnt(0)
 s_barrier
 s_barrier
 s_barrier
kh_end:
 s_cmp_eq_u32 s100, 4
 s_cbranch_scc1 mega_p5
 s_endpgm
.p2align 6
ks_body:
 s_mov_b64 exec, -1
 s_barrier
 s_load_dwordx4 s[8:11], s[0:1], 8
 s_load_dwordx2 s[18:19], s[0:1], 88
 s_load_dwordx4 s[12:15], s[0:1], 72
 v_lshrrev_b32 v1, 6, v0
 v_and_b32 v2, 63, v0
 v_readfirstlane_b32 s20, v1
 s_and_b32 s22, s2, 7
 s_lshr_b32 s23, s2, 3
 s_lshr_b32 s44, s22, 1
 s_and_b32 s21, s22, 1
 s_lshl_b32 s21, s21, 3
 s_and_b32 s45, s23, 7
 s_add_u32 s21, s21, s45
 s_lshr_b32 s23, s23, 3
 s_and_b32 s45, s20, 3
 s_lshr_b32 s46, s20, 2
 s_waitcnt lgkmcnt(0)
 s_cmp_ge_u32 s44, 2
 s_cselect_b32 s4, s10, s8
 s_cselect_b32 s5, s11, s9
 s_mov_b32 s24, s4
 s_and_b32 s25, s5, 0xffff
 s_mov_b32 s26, 8388608
 s_mov_b32 s27, 0x00020000
 s_add_u32 s28, s18, s68
 s_addc_u32 s29, s19, 0
 s_and_b32 s29, s29, 0xffff
 s_mov_b32 s30, 4718592
 s_mov_b32 s31, 0x00020000
 s_add_u32 s32, s18, s75
 s_addc_u32 s33, s19, 0
 s_and_b32 s33, s33, 0xffff
 s_mov_b32 s34, 9437184
 s_mov_b32 s35, 0x00020000
 s_add_u32 s76, s18, 90517504
 s_addc_u32 s77, s19, 0
 s_and_b32 s77, s77, 0xffff
 s_mov_b32 s78, 524288
 s_mov_b32 s79, 0x00020000
 s_mov_b32 s66, s69
 v_and_b32 v11, 15, v2
 v_lshrrev_b32 v12, 4, v2
 v_mul_u32_u24 v13, 1152, v12
 v_lshl_add_u32 v14, v11, 4, v13
 v_and_b32 v15, 7, v11
 v_lshl_add_u32 v15, v15, 4, v13
 v_add_u32 v15, 1024, v15
 v_lshrrev_b32 v16, 3, v11
 s_mov_b32 s47, 294912
 v_mul_lo_u32 v16, v16, s47
 v_add_u32 v15, v15, v16
 s_lshl_b32 s47, s45, 8
 v_add_u32 v3, s47, v14
 s_mul_i32 s47, s45, 4608
 v_add_u32 v4, s47, v15
 s_lshr_b32 s47, s44, 1
 s_lshl_b32 s47, s47, 3
 s_lshl_b32 s48, s23, 1
 s_add_u32 s47, s47, s48
 s_mul_i32 s48, s47, 294912
 s_and_b32 s47, s44, 1
 s_lshl_b32 s47, s47, 4
 s_add_u32 s47, s47, s46
 s_mul_i32 s49, s47, 9216
 s_add_u32 s48, s48, s49
 s_mul_i32 s50, s46, 18432
 s_lshl_b32 s51, s45, 10
 s_add_u32 s50, s50, s51
 s_lshl_b32 s51, s45, 13
 s_add_u32 s5, s50, s51
 s_add_u32 s5, s5, 8192
 s_cmp_lt_u32 s45, 2
 s_cselect_b64 s[52:53], -1, 0
 s_mul_i32 s51, s46, 18432
 v_lshl_add_u32 v8, v2, 4, s51
 v_add_u32 v9, 73728, v8
 s_mov_b32 s4, s47
 v_lshlrev_b32 v1, 2, v2
 v_lshrrev_b32 v248, 3, v2
 v_and_b32 v249, 7, v2
 v_lshrrev_b32 v250, 1, v248
 v_xor_b32 v250, v250, v249
 v_lshlrev_b32 v250, 4, v250
 v_lshrrev_b32 v251, 2, v248
 v_and_b32 v252, 3, v248
 v_lshl_add_u32 v251, v251, 3, v252
 v_lshlrev_b32 v251, 12, v251
 v_add_u32 v253, v251, v250
 v_xor_b32 v252, 64, v250
 v_add_u32 v254, v251, v252
 v_add_u32 v240, 0, v253
 v_add_u32 v241, 65536, v254
 v_add_u32 v242, 16384, v253
 v_add_u32 v243, 81920, v254
 s_mul_i32 s54, s20, 6144
 s_add_u32 s54, s54, 110592
 v_lshrrev_b32 v250, 1, v11
 v_xor_b32 v250, v250, v12
 v_lshlrev_b32 v250, 4, v250
 v_lshl_add_u32 v250, v11, 7, v250
 v_add_u32 v244, s54, v250
 v_xor_b32 v250, 64, v250
 v_add_u32 v245, s54, v250
 s_lshl_b32 s51, s21, 2
 s_add_u32 s51, s51, s45
 s_lshl_b32 s49, s51, 17
 s_lshl_b32 s51, s4, 7
 s_add_u32 s49, s49, s51
 s_add_u32 m0, s54, 0
 s_add_u32 s47, s49, 0
 buffer_load_dwordx4 v240, s[24:27], s47 offen lds
 s_add_u32 m0, s54, 1024
 s_add_u32 s47, s49, 0
 buffer_load_dwordx4 v241, s[24:27], s47 offen lds
 s_add_u32 m0, s54, 2048
 s_add_u32 s47, s49, 0
 buffer_load_dwordx4 v242, s[24:27], s47 offen lds
 s_add_u32 m0, s54, 3072
 s_add_u32 s47, s49, 0
 buffer_load_dwordx4 v243, s[24:27], s47 offen lds
 s_add_u32 m0, s54, 4096
 s_add_u32 s47, s49, 256
 buffer_load_dwordx4 v240, s[24:27], s47 offen lds
 s_add_u32 m0, s54, 5120
 s_add_u32 s47, s49, 256
 buffer_load_dwordx4 v241, s[24:27], s47 offen lds
 v_and_b32 v153, 31, v2
 v_lshrrev_b32 v154, 5, v2
 v_lshlrev_b32 v153, 2, v153
 v_lshl_add_u32 v153, v154, 8, v153
 s_lshr_b32 s47, s44, 1
 s_lshl_b32 s47, s47, 3
 s_lshl_b32 s3, s23, 1
 s_add_u32 s47, s47, s3
 s_lshl_b32 s47, s47, 8
 s_and_b32 s3, s44, 1
 s_lshl_b32 s3, s3, 7
 s_add_u32 s47, s47, s3
 s_add_u32 s47, s47, s64
 s_mov_b32 s3, 0
ks_pl1:
 buffer_load_dword v152, v153, s[76:79], s47 offen sc1
 s_add_u32 s3, s3, 1
 s_waitcnt vmcnt(0)
 v_cmp_ne_u32 vcc, s101, v152
 s_cmp_ge_u32 s3, 0x40000
 s_cbranch_scc1 ks_pl1y
 s_cmp_eq_u64 vcc, 0
 s_cbranch_scc1 ks_pl1y
 s_sleep 3
 s_branch ks_pl1
ks_pl1y:
 s_mov_b64 exec, -1
ks_pl1x:
 s_add_u32 m0, s50, 0
 s_add_u32 s47, s48, 0
 buffer_load_dwordx4 v3, s[28:31], s47 offen sc1 lds
 s_add_u32 m0, s50, 4096
 s_add_u32 s47, s48, 294912
 buffer_load_dwordx4 v3, s[28:31], s47 offen sc1 lds
 s_add_u32 m0, s50, 9216
 s_add_u32 s47, s48, 4608
 buffer_load_dwordx4 v3, s[28:31], s47 offen sc1 lds
 s_add_u32 m0, s50, 13312
 s_add_u32 s47, s48, 299520
 buffer_load_dwordx4 v3, s[28:31], s47 offen sc1 lds
 s_add_u32 m0, s5, 0
 s_add_u32 s47, s48, 0
 s_mov_b64 exec, s[52:53]
 buffer_load_dwordx4 v4, s[28:31], s47 offen sc1 lds
 s_mov_b64 exec, -1
 s_add_u32 m0, s50, 36864
 s_add_u32 s47, s48, 18432
 buffer_load_dwordx4 v3, s[28:31], s47 offen sc1 lds
 s_add_u32 m0, s50, 40960
 s_add_u32 s47, s48, 313344
 buffer_load_dwordx4 v3, s[28:31], s47 offen sc1 lds
 s_add_u32 m0, s50, 46080
 s_add_u32 s47, s48, 23040
 buffer_load_dwordx4 v3, s[28:31], s47 offen sc1 lds
 s_add_u32 m0, s50, 50176
 s_add_u32 s47, s48, 317952
 buffer_load_dwordx4 v3, s[28:31], s47 offen sc1 lds
 s_add_u32 m0, s5, 36864
 s_add_u32 s47, s48, 18432
 s_mov_b64 exec, s[52:53]
 buffer_load_dwordx4 v4, s[28:31], s47 offen sc1 lds
 s_mov_b64 exec, -1
 v_mov_b32 v160, 0
 v_mov_b32 v161, 0
 v_mov_b32 v162, 0
 v_mov_b32 v163, 0
 v_mov_b32 v164, 0
 v_mov_b32 v165, 0
 v_mov_b32 v166, 0
 v_mov_b32 v167, 0
 v_mov_b32 v168, 0
 v_mov_b32 v169, 0
 v_mov_b32 v170, 0
 v_mov_b32 v171, 0
 v_mov_b32 v172, 0
 v_mov_b32 v173, 0
 v_mov_b32 v174, 0
 v_mov_b32 v175, 0
 v_mov_b32 v176, 0
 v_mov_b32 v177, 0
 v_mov_b32 v178, 0
 v_mov_b32 v179, 0
 v_mov_b32 v180, 0
 v_mov_b32 v181, 0
 v_mov_b32 v182, 0
 v_mov_b32 v183, 0
 v_mov_b32 v184, 0
 v_mov_b32 v185, 0
 v_mov_b32 v186, 0
 v_mov_b32 v187, 0
 v_mov_b32 v188, 0
 v_mov_b32 v189, 0
 v_mov_b32 v190, 0
 v_mov_b32 v191, 0
 v_mov_b32 v192, 0
 v_mov_b32 v193, 0
 v_mov_b32 v194, 0
 v_mov_b32 v195, 0
 v_mov_b32 v196, 0
 v_mov_b32 v197, 0
 v_mov_b32 v198, 0
 v_mov_b32 v199, 0
 v_mov_b32 v200, 0
 v_mov_b32 v201, 0
 v_mov_b32 v202, 0
 v_mov_b32 v203, 0
 v_mov_b32 v204, 0
 v_mov_b32 v205, 0
 v_mov_b32 v206, 0
 v_mov_b32 v207, 0
 v_mov_b32 v208, 0
 v_mov_b32 v209, 0
 v_mov_b32 v210, 0
 v_mov_b32 v211, 0
 v_mov_b32 v212, 0
 v_mov_b32 v213, 0
 v_mov_b32 v214, 0
 v_mov_b32 v215, 0
 v_mov_b32 v216, 0
 v_mov_b32 v217, 0
 v_mov_b32 v218, 0
 v_mov_b32 v219, 0
 v_mov_b32 v220, 0
 v_mov_b32 v221, 0
 v_mov_b32 v222, 0
 v_mov_b32 v223, 0
 v_mov_b32 v224, 0
 v_mov_b32 v225, 0
 v_mov_b32 v226, 0
 v_mov_b32 v227, 0
 v_mov_b32 v228, 0
 v_mov_b32 v229, 0
 v_mov_b32 v230, 0
 v_mov_b32 v231, 0
 s_mul_i32 s51, s20, 9216
 s_add_u32 s51, s51, 0
 v_lshl_add_u32 v232, v2, 4, s51
 s_xor_b32 s51, s20, 4
 s_mul_i32 s51, s51, 9216
 s_add_u32 s51, s51, 0
 v_lshl_add_u32 v233, v2, 4, s51
 s_lshl_b32 s55, s21, 2
 s_add_u32 s55, s55, s23
 s_lshl_b32 s51, s55, 2
 s_add_u32 s51, s51, s44
 s_lshl_b32 s51, s51, 3
 s_lshl_b32 s3, s45, 1
 s_add_u32 s51, s51, s3
 s_add_u32 s51, s51, s46
 s_mul_i32 s75, s51, 4608
 v_lshlrev_b32 v234, 4, v2
 v_lshlrev_b32 v235, 3, v2
 v_add_u32 v235, 4096, v235
 s_add_u32 s36, s18, s70
 s_addc_u32 s37, s19, 0
 s_and_b32 s37, s37, 0xffff
 s_mov_b32 s38, 2359296
 s_mov_b32 s39, 0x00020000
 s_add_u32 s40, s18, s71
 s_addc_u32 s41, s19, 0
 s_and_b32 s41, s41, 0xffff
 s_mov_b32 s42, 2359296
 s_mov_b32 s43, 0x00020000
 s_add_u32 s60, s18, s72
 s_addc_u32 s61, s19, 0
 s_and_b32 s61, s61, 0xffff
 s_mov_b32 s62, 262144
 s_mov_b32 s63, 0x00020000
 s_cmp_lg_u32 s73, 0
 s_cselect_b32 s40, s12, s40
 s_cselect_b32 s41, s13, s41
 s_and_b32 s41, s41, 0xffff
 s_and_b32 s56, s20, 1
 s_lshr_b32 s57, s20, 1
 s_lshl_b32 s58, s21, 2
 s_add_u32 s58, s58, s44
 s_mul_i32 s59, s58, 36864
 s_mul_i32 s3, s23, 9216
 s_add_u32 s59, s59, s3
 s_lshl_b32 s3, s56, 8
 s_add_u32 s59, s59, s3
 s_lshr_b32 s3, s57, 1
 s_mul_i32 s3, s3, 4608
 s_and_b32 s51, s57, 1
 s_lshl_b32 s51, s51, 11
 s_add_u32 s3, s3, s51
 s_add_u32 s68, s59, s3
 v_lshlrev_b32 v236, 9, v12
 v_lshl_add_u32 v236, v11, 4, v236
 v_lshrrev_b32 v237, 1, v12
 v_mul_u32_u24 v237, 4608, v237
 v_and_b32 v238, 1, v12
 v_lshl_add_u32 v237, v238, 3, v237
 v_lshl_add_u32 v237, v11, 4, v237
 v_add_u32 v237, 4096, v237
 s_cmp_eq_u32 s57, 0
 s_cselect_b32 s69, s59, 0x7f000000
 s_lshl_b32 s51, s55, 5
 s_lshl_b32 s3, s44, 1
 s_add_u32 s51, s51, s3
 s_add_u32 s51, s51, s56
 s_mul_i32 s51, s51, 4608
 s_lshl_b32 s3, s57, 10
 s_add_u32 s6, s3, s51
 s_cmp_eq_u32 s57, 0
 s_cselect_b32 s7, s51, 0x7f000000
 v_lshrrev_b32 v238, 2, v11
 v_and_b32 v239, 3, v11
 v_lshl_add_u32 v238, v238, 3, v239
 v_mul_u32_u24 v238, 1152, v238
 v_lshl_add_u32 v239, v12, 4, v238
 v_lshrrev_b32 v246, 1, v12
 v_mul_u32_u24 v246, 144, v246
 v_add_u32 v238, v238, v246
 v_and_b32 v246, 1, v12
 v_lshl_add_u32 v238, v246, 3, v238
 v_add_u32 v238, 128, v238
 s_lshl_b32 s51, s58, 5
 s_lshl_b32 s3, s56, 2
 s_add_u32 s51, s51, s3
 s_mul_i32 s51, s51, 1152
 s_mul_i32 s3, s23, 288
 s_add_u32 s51, s51, s3
 s_lshr_b32 s3, s57, 1
 s_mul_i32 s3, s3, 144
 s_and_b32 s16, s57, 1
 s_lshl_b32 s16, s16, 6
 s_add_u32 s3, s3, s16
 s_add_u32 s3, s3, s51
 s_cmp_eq_u32 s57, 0
 s_cselect_b32 s51, s51, 0x7f000000
 s_cmp_lg_u32 s73, 0
 s_cselect_b32 s16, s3, s68
 s_cselect_b32 s17, s51, s69
 s_cselect_b64 vcc, -1, 0
 v_cndmask_b32 v246, v236, v239, vcc
 v_cndmask_b32 v247, v237, v238, vcc
 s_lshl_b32 s51, s23, 2
 s_add_u32 s51, s51, s57
 s_lshl_b32 s51, s51, 14
 s_lshl_b32 s3, s58, 8
 s_add_u32 s51, s51, s3
 s_lshl_b32 s3, s56, 7
 s_add_u32 s51, s51, s3
 s_cmp_lg_u32 s73, 0
 s_cselect_b32 s59, 0x7f000000, s51
 v_lshlrev_b32 v238, 3, v11
 s_lshl_b32 s3, s55, 3
 s_lshl_b32 s51, s44, 1
 s_add_u32 s51, s51, s3
 s_add_u32 s51, s51, s56
 s_lshl_b32 s56, s51, 7
 s_add_u32 s56, s56, s66
 s_lshl_b32 s51, s45, 1
 s_add_u32 s51, s51, s3
 s_add_u32 s51, s51, s46
 s_lshl_b32 s51, s51, 7
 s_lshl_b32 s57, s44, 2
 s_add_u32 s57, s57, s51
 s_add_u32 s57, s57, s66
 s_lshl_b32 s67, s58, 7
 s_lshl_b32 s3, s23, 5
 s_add_u32 s67, s67, s3
 s_lshl_b32 s3, s20, 2
 s_add_u32 s67, s67, s3
 s_add_u32 s67, s67, s65
 s_mov_b32 s58, 0xffff0000
 ds_read_b128 v[88:91], v244 offset:0
 ds_read_b128 v[96:99], v245 offset:0
 ds_read_b128 v[92:95], v244 offset:2048
 ds_read_b128 v[100:103], v245 offset:2048
 s_waitcnt lgkmcnt(0)
 s_add_u32 m0, s54, 0
 s_add_u32 s47, s49, 256
 buffer_load_dwordx4 v242, s[24:27], s47 offen lds
 s_add_u32 m0, s54, 1024
 s_add_u32 s47, s49, 256
 buffer_load_dwordx4 v243, s[24:27], s47 offen lds
 s_add_u32 m0, s54, 2048
 s_add_u32 s47, s49, 512
 buffer_load_dwordx4 v240, s[24:27], s47 offen lds
 s_add_u32 m0, s54, 3072
 s_add_u32 s47, s49, 512
 buffer_load_dwordx4 v241, s[24:27], s47 offen lds
 s_waitcnt vmcnt(9)
 s_barrier
 ds_read_b128 v[16:19], v8 offset:0
 ds_read_b128 v[20:23], v8 offset:1024
 ds_read_b128 v[24:27], v8 offset:2048
 ds_read_b128 v[28:31], v8 offset:3072
 ds_read_b128 v[32:35], v8 offset:4096
 ds_read_b128 v[36:39], v8 offset:5120
 ds_read_b128 v[40:43], v8 offset:6144
 ds_read_b128 v[44:47], v8 offset:7168
 ds_read_b128 v[48:51], v8 offset:8192
 s_waitcnt lgkmcnt(8)
 v_mfma_f32_16x16x32_bf16 v[160:163], v[16:19], v[88:91], v[160:163]
 s_add_u32 m0, s50, 73728
 s_add_u32 s47, s48, 36864
 buffer_load_dwordx4 v3, s[28:31], s47 offen sc1 lds
 v_mfma_f32_16x16x32_bf16 v[196:199], v[16:19], v[92:95], v[196:199]
 s_add_u32 m0, s50, 77824
 s_add_u32 s47, s48, 331776
 buffer_load_dwordx4 v3, s[28:31], s47 offen sc1 lds
 ds_read_b128 v[52:55], v8 offset:9216
 s_waitcnt lgkmcnt(8)
 v_mfma_f32_16x16x32_bf16 v[164:167], v[20:23], v[88:91], v[164:167]
 s_add_u32 m0, s50, 82944
 s_add_u32 s47, s48, 41472
 buffer_load_dwordx4 v3, s[28:31], s47 offen sc1 lds
 v_mfma_f32_16x16x32_bf16 v[200:203], v[20:23], v[92:95], v[200:203]
 s_add_u32 m0, s50, 87040
 s_add_u32 s47, s48, 336384
 buffer_load_dwordx4 v3, s[28:31], s47 offen sc1 lds
 ds_read_b128 v[56:59], v8 offset:10240
 s_waitcnt lgkmcnt(8)
 v_mfma_f32_16x16x32_bf16 v[168:171], v[24:27], v[88:91], v[168:171]
 s_add_u32 m0, s5, 73728
 s_add_u32 s47, s48, 36864
 s_mov_b64 exec, s[52:53]
 buffer_load_dwordx4 v4, s[28:31], s47 offen sc1 lds
 s_mov_b64 exec, -1
 v_mfma_f32_16x16x32_bf16 v[204:207], v[24:27], v[92:95], v[204:207]
 ds_read_b128 v[60:63], v8 offset:11264
 ds_read_b128 v[104:107], v244 offset:4096
 ds_read_b128 v[112:115], v245 offset:4096
 s_waitcnt lgkmcnt(10)
 v_mfma_f32_16x16x32_bf16 v[172:175], v[28:31], v[88:91], v[172:175]
 v_mfma_f32_16x16x32_bf16 v[208:211], v[28:31], v[92:95], v[208:211]
 ds_read_b128 v[16:19], v8 offset:12288
 s_waitcnt lgkmcnt(10)
 v_mfma_f32_16x16x32_bf16 v[176:179], v[32:35], v[88:91], v[176:179]
 v_mfma_f32_16x16x32_bf16 v[212:215], v[32:35], v[92:95], v[212:215]
 ds_read_b128 v[20:23], v8 offset:13312
 s_waitcnt lgkmcnt(2)
 v_mfma_f32_16x16x32_bf16 v[180:183], v[36:39], v[88:91], v[180:183]
 s_add_u32 m0, s54, 4096
 s_add_u32 s47, s49, 512
 buffer_load_dwordx4 v242, s[24:27], s47 offen lds
 v_mfma_f32_16x16x32_bf16 v[216:219], v[36:39], v[92:95], v[216:219]
 s_add_u32 m0, s54, 5120
 s_add_u32 s47, s49, 512
 buffer_load_dwordx4 v243, s[24:27], s47 offen lds
 ds_read_b128 v[24:27], v8 offset:14336
 v_mfma_f32_16x16x32_bf16 v[184:187], v[40:43], v[88:91], v[184:187]
 v_mfma_f32_16x16x32_bf16 v[220:223], v[40:43], v[92:95], v[220:223]
 ds_read_b128 v[28:31], v8 offset:15360
 s_waitcnt vmcnt(9)
 ds_read_b128 v[108:111], v244 offset:0
 ds_read_b128 v[116:119], v245 offset:0
 v_mfma_f32_16x16x32_bf16 v[188:191], v[44:47], v[88:91], v[188:191]
 v_mfma_f32_16x16x32_bf16 v[224:227], v[44:47], v[92:95], v[224:227]
 ds_read_b128 v[32:35], v8 offset:16384
 v_mfma_f32_16x16x32_bf16 v[192:195], v[48:51], v[88:91], v[192:195]
 v_mfma_f32_16x16x32_bf16 v[228:231], v[48:51], v[92:95], v[228:231]
 ds_read_b128 v[36:39], v8 offset:17408
 s_waitcnt lgkmcnt(2)
 v_mfma_f32_16x16x32_bf16 v[160:163], v[52:55], v[96:99], v[160:163]
 s_add_u32 m0, s54, 0
 s_add_u32 s47, s49, 768
 buffer_load_dwordx4 v240, s[24:27], s47 offen lds
 v_mfma_f32_16x16x32_bf16 v[196:199], v[52:55], v[100:103], v[196:199]
 s_add_u32 m0, s54, 1024
 s_add_u32 s47, s49, 768
 buffer_load_dwordx4 v241, s[24:27], s47 offen lds
 s_barrier
 ds_read_b128 v[40:43], v8 offset:36864
 v_mfma_f32_16x16x32_bf16 v[164:167], v[56:59], v[96:99], v[164:167]
 v_mfma_f32_16x16x32_bf16 v[200:203], v[56:59], v[100:103], v[200:203]
 ds_read_b128 v[44:47], v8 offset:37888
 v_mfma_f32_16x16x32_bf16 v[168:171], v[60:63], v[96:99], v[168:171]
 v_mfma_f32_16x16x32_bf16 v[204:207], v[60:63], v[100:103], v[204:207]
 ds_read_b128 v[48:51], v8 offset:38912
 v_mfma_f32_16x16x32_bf16 v[172:175], v[16:19], v[96:99], v[172:175]
 v_mfma_f32_16x16x32_bf16 v[208:211], v[16:19], v[100:103], v[208:211]
 ds_read_b128 v[52:55], v8 offset:39936
 v_mfma_f32_16x16x32_bf16 v[176:179], v[20:23], v[96:99], v[176:179]
 v_mfma_f32_16x16x32_bf16 v[212:215], v[20:23], v[100:103], v[212:215]
 ds_read_b128 v[56:59], v8 offset:40960
 v_mfma_f32_16x16x32_bf16 v[180:183], v[24:27], v[96:99], v[180:183]
 v_mfma_f32_16x16x32_bf16 v[216:219], v[24:27], v[100:103], v[216:219]
 ds_read_b128 v[60:63], v8 offset:41984
 v_mfma_f32_16x16x32_bf16 v[184:187], v[28:31], v[96:99], v[184:187]
 v_mfma_f32_16x16x32_bf16 v[220:223], v[28:31], v[100:103], v[220:223]
 ds_read_b128 v[16:19], v8 offset:43008
 s_waitcnt lgkmcnt(8)
 v_mfma_f32_16x16x32_bf16 v[188:191], v[32:35], v[96:99], v[188:191]
 v_mfma_f32_16x16x32_bf16 v[224:227], v[32:35], v[100:103], v[224:227]
 ds_read_b128 v[20:23], v8 offset:44032
 s_waitcnt lgkmcnt(8)
 v_mfma_f32_16x16x32_bf16 v[192:195], v[36:39], v[96:99], v[192:195]
 v_mfma_f32_16x16x32_bf16 v[228:231], v[36:39], v[100:103], v[228:231]
 ds_read_b128 v[24:27], v8 offset:45056
 s_waitcnt lgkmcnt(8)
 v_mfma_f32_16x16x32_bf16 v[160:163], v[40:43], v[104:107], v[160:163]
 v_mfma_f32_16x16x32_bf16 v[196:199], v[40:43], v[108:111], v[196:199]
 ds_read_b128 v[28:31], v8 offset:46080
 s_waitcnt lgkmcnt(8)
 v_mfma_f32_16x16x32_bf16 v[164:167], v[44:47], v[104:107], v[164:167]
 v_mfma_f32_16x16x32_bf16 v[200:203], v[44:47], v[108:111], v[200:203]
 ds_read_b128 v[32:35], v8 offset:47104
 s_waitcnt lgkmcnt(8)
 v_mfma_f32_16x16x32_bf16 v[168:171], v[48:51], v[104:107], v[168:171]
 v_mfma_f32_16x16x32_bf16 v[204:207], v[48:51], v[108:111], v[204:207]
 ds_read_b128 v[36:39], v8 offset:48128
 s_waitcnt vmcnt(9)
 ds_read_b128 v[88:91], v244 offset:2048
 ds_read_b128 v[96:99], v245 offset:2048
 s_waitcnt lgkmcnt(10)
 v_mfma_f32_16x16x32_bf16 v[172:175], v[52:55], v[104:107], v[172:175]
 v_mfma_f32_16x16x32_bf16 v[208:211], v[52:55], v[108:111], v[208:211]
 ds_read_b128 v[40:43], v8 offset:49152
 s_waitcnt lgkmcnt(10)
 v_mfma_f32_16x16x32_bf16 v[176:179], v[56:59], v[104:107], v[176:179]
 v_mfma_f32_16x16x32_bf16 v[212:215], v[56:59], v[108:111], v[212:215]
 ds_read_b128 v[44:47], v8 offset:50176
 s_waitcnt lgkmcnt(2)
 v_mfma_f32_16x16x32_bf16 v[180:183], v[60:63], v[104:107], v[180:183]
 v_mfma_f32_16x16x32_bf16 v[216:219], v[60:63], v[108:111], v[216:219]
 s_add_u32 m0, s54, 2048
 s_add_u32 s47, s49, 768
 buffer_load_dwordx4 v242, s[24:27], s47 offen lds
 ds_read_b128 v[48:51], v8 offset:51200
 v_mfma_f32_16x16x32_bf16 v[184:187], v[16:19], v[104:107], v[184:187]
 v_mfma_f32_16x16x32_bf16 v[220:223], v[16:19], v[108:111], v[220:223]
 ds_read_b128 v[52:55], v8 offset:52224
 s_waitcnt vmcnt(3)
 ds_read_b128 v[92:95], v244 offset:4096
 ds_read_b128 v[100:103], v245 offset:4096
 v_mfma_f32_16x16x32_bf16 v[188:191], v[20:23], v[104:107], v[188:191]
 s_add_u32 m0, s54, 3072
 s_add_u32 s47, s49, 768
 buffer_load_dwordx4 v243, s[24:27], s47 offen lds
 v_mfma_f32_16x16x32_bf16 v[224:227], v[20:23], v[108:111], v[224:227]
 ds_read_b128 v[56:59], v8 offset:53248
 v_mfma_f32_16x16x32_bf16 v[192:195], v[24:27], v[104:107], v[192:195]
 v_mfma_f32_16x16x32_bf16 v[228:231], v[24:27], v[108:111], v[228:231]
 ds_read_b128 v[60:63], v8 offset:54272
 s_waitcnt lgkmcnt(2)
 v_mfma_f32_16x16x32_bf16 v[160:163], v[28:31], v[112:115], v[160:163]
 v_mfma_f32_16x16x32_bf16 v[196:199], v[28:31], v[116:119], v[196:199]
 s_add_u32 m0, s54, 4096
 s_add_u32 s47, s49, 1024
 buffer_load_dwordx4 v240, s[24:27], s47 offen lds
 s_add_u32 m0, s54, 5120
 s_add_u32 s47, s49, 1024
 buffer_load_dwordx4 v241, s[24:27], s47 offen lds
 s_barrier
 ds_read_b128 v[16:19], v9 offset:0
 v_mfma_f32_16x16x32_bf16 v[164:167], v[32:35], v[112:115], v[164:167]
 s_add_u32 m0, s50, 0
 s_add_u32 s47, s48, 55296
 buffer_load_dwordx4 v3, s[28:31], s47 offen sc1 lds
 v_mfma_f32_16x16x32_bf16 v[200:203], v[32:35], v[116:119], v[200:203]
 ds_read_b128 v[20:23], v9 offset:1024
 v_mfma_f32_16x16x32_bf16 v[168:171], v[36:39], v[112:115], v[168:171]
 v_mfma_f32_16x16x32_bf16 v[204:207], v[36:39], v[116:119], v[204:207]
 s_add_u32 m0, s50, 4096
 s_add_u32 s47, s48, 350208
 buffer_load_dwordx4 v3, s[28:31], s47 offen sc1 lds
 ds_read_b128 v[24:27], v9 offset:2048
 v_mfma_f32_16x16x32_bf16 v[172:175], v[40:43], v[112:115], v[172:175]
 v_mfma_f32_16x16x32_bf16 v[208:211], v[40:43], v[116:119], v[208:211]
 ds_read_b128 v[28:31], v9 offset:3072
 v_mfma_f32_16x16x32_bf16 v[176:179], v[44:47], v[112:115], v[176:179]
 s_add_u32 m0, s50, 9216
 s_add_u32 s47, s48, 59904
 buffer_load_dwordx4 v3, s[28:31], s47 offen sc1 lds
 v_mfma_f32_16x16x32_bf16 v[212:215], v[44:47], v[116:119], v[212:215]
 ds_read_b128 v[32:35], v9 offset:4096
 v_mfma_f32_16x16x32_bf16 v[180:183], v[48:51], v[112:115], v[180:183]
 v_mfma_f32_16x16x32_bf16 v[216:219], v[48:51], v[116:119], v[216:219]
 s_add_u32 m0, s50, 13312
 s_add_u32 s47, s48, 354816
 buffer_load_dwordx4 v3, s[28:31], s47 offen sc1 lds
 ds_read_b128 v[36:39], v9 offset:5120
 v_mfma_f32_16x16x32_bf16 v[184:187], v[52:55], v[112:115], v[184:187]
 v_mfma_f32_16x16x32_bf16 v[220:223], v[52:55], v[116:119], v[220:223]
 ds_read_b128 v[40:43], v9 offset:6144
 s_waitcnt lgkmcnt(8)
 v_mfma_f32_16x16x32_bf16 v[188:191], v[56:59], v[112:115], v[188:191]
 s_add_u32 m0, s5, 0
 s_add_u32 s47, s48, 55296
 s_mov_b64 exec, s[52:53]
 buffer_load_dwordx4 v4, s[28:31], s47 offen sc1 lds
 s_mov_b64 exec, -1
 v_mfma_f32_16x16x32_bf16 v[224:227], v[56:59], v[116:119], v[224:227]
 ds_read_b128 v[44:47], v9 offset:7168
 s_waitcnt lgkmcnt(8)
 v_mfma_f32_16x16x32_bf16 v[192:195], v[60:63], v[112:115], v[192:195]
 v_mfma_f32_16x16x32_bf16 v[228:231], v[60:63], v[116:119], v[228:231]
 ds_read_b128 v[48:51], v9 offset:8192
 s_waitcnt lgkmcnt(8)
 v_mfma_f32_16x16x32_bf16 v[160:163], v[16:19], v[88:91], v[160:163]
 v_mfma_f32_16x16x32_bf16 v[196:199], v[16:19], v[92:95], v[196:199]
 ds_read_b128 v[52:55], v9 offset:9216
 s_waitcnt lgkmcnt(8)
 v_mfma_f32_16x16x32_bf16 v[164:167], v[20:23], v[88:91], v[164:167]
 v_mfma_f32_16x16x32_bf16 v[200:203], v[20:23], v[92:95], v[200:203]
 ds_read_b128 v[56:59], v9 offset:10240
 s_waitcnt lgkmcnt(8)
 v_mfma_f32_16x16x32_bf16 v[168:171], v[24:27], v[88:91], v[168:171]
 v_mfma_f32_16x16x32_bf16 v[204:207], v[24:27], v[92:95], v[204:207]
 ds_read_b128 v[60:63], v9 offset:11264
 s_waitcnt vmcnt(9)
 ds_read_b128 v[104:107], v244 offset:0
 ds_read_b128 v[112:115], v245 offset:0
 s_waitcnt lgkmcnt(10)
 v_mfma_f32_16x16x32_bf16 v[172:175], v[28:31], v[88:91], v[172:175]
 v_mfma_f32_16x16x32_bf16 v[208:211], v[28:31], v[92:95], v[208:211]
 ds_read_b128 v[16:19], v9 offset:12288
 s_waitcnt lgkmcnt(10)
 v_mfma_f32_16x16x32_bf16 v[176:179], v[32:35], v[88:91], v[176:179]
 v_mfma_f32_16x16x32_bf16 v[212:215], v[32:35], v[92:95], v[212:215]
 ds_read_b128 v[20:23], v9 offset:13312
 s_waitcnt lgkmcnt(2)
 v_mfma_f32_16x16x32_bf16 v[180:183], v[36:39], v[88:91], v[180:183]
 v_mfma_f32_16x16x32_bf16 v[216:219], v[36:39], v[92:95], v[216:219]
 s_add_u32 m0, s54, 0
 s_add_u32 s47, s49, 1024
 buffer_load_dwordx4 v242, s[24:27], s47 offen lds
 ds_read_b128 v[24:27], v9 offset:14336
 v_mfma_f32_16x16x32_bf16 v[184:187], v[40:43], v[88:91], v[184:187]
 v_mfma_f32_16x16x32_bf16 v[220:223], v[40:43], v[92:95], v[220:223]
 ds_read_b128 v[28:31], v9 offset:15360
 s_waitcnt vmcnt(8)
 ds_read_b128 v[108:111], v244 offset:2048
 ds_read_b128 v[116:119], v245 offset:2048
 v_mfma_f32_16x16x32_bf16 v[188:191], v[44:47], v[88:91], v[188:191]
 s_add_u32 m0, s54, 1024
 s_add_u32 s47, s49, 1024
 buffer_load_dwordx4 v243, s[24:27], s47 offen lds
 v_mfma_f32_16x16x32_bf16 v[224:227], v[44:47], v[92:95], v[224:227]
 ds_read_b128 v[32:35], v9 offset:16384
 v_mfma_f32_16x16x32_bf16 v[192:195], v[48:51], v[88:91], v[192:195]
 v_mfma_f32_16x16x32_bf16 v[228:231], v[48:51], v[92:95], v[228:231]
 ds_read_b128 v[36:39], v9 offset:17408
 s_waitcnt lgkmcnt(2)
 v_mfma_f32_16x16x32_bf16 v[160:163], v[52:55], v[96:99], v[160:163]
 v_mfma_f32_16x16x32_bf16 v[196:199], v[52:55], v[100:103], v[196:199]
 s_add_u32 m0, s54, 2048
 s_add_u32 s47, s49, 1280
 buffer_load_dwordx4 v240, s[24:27], s47 offen lds
 s_add_u32 m0, s54, 3072
 s_add_u32 s47, s49, 1280
 buffer_load_dwordx4 v241, s[24:27], s47 offen lds
 s_waitcnt vmcnt(4)
 s_barrier
 ds_read_b128 v[40:43], v8 offset:0
 v_mfma_f32_16x16x32_bf16 v[164:167], v[56:59], v[96:99], v[164:167]
 s_add_u32 m0, s50, 36864
 s_add_u32 s47, s48, 73728
 buffer_load_dwordx4 v3, s[28:31], s47 offen sc1 lds
 v_mfma_f32_16x16x32_bf16 v[200:203], v[56:59], v[100:103], v[200:203]
 ds_read_b128 v[44:47], v8 offset:1024
 v_mfma_f32_16x16x32_bf16 v[168:171], v[60:63], v[96:99], v[168:171]
 v_mfma_f32_16x16x32_bf16 v[204:207], v[60:63], v[100:103], v[204:207]
 s_add_u32 m0, s50, 40960
 s_add_u32 s47, s48, 368640
 buffer_load_dwordx4 v3, s[28:31], s47 offen sc1 lds
 ds_read_b128 v[48:51], v8 offset:2048
 v_mfma_f32_16x16x32_bf16 v[172:175], v[16:19], v[96:99], v[172:175]
 v_mfma_f32_16x16x32_bf16 v[208:211], v[16:19], v[100:103], v[208:211]
 ds_read_b128 v[52:55], v8 offset:3072
 v_mfma_f32_16x16x32_bf16 v[176:179], v[20:23], v[96:99], v[176:179]
 s_add_u32 m0, s50, 46080
 s_add_u32 s47, s48, 78336
 buffer_load_dwordx4 v3, s[28:31], s47 offen sc1 lds
 v_mfma_f32_16x16x32_bf16 v[212:215], v[20:23], v[100:103], v[212:215]
 ds_read_b128 v[56:59], v8 offset:4096
 v_mfma_f32_16x16x32_bf16 v[180:183], v[24:27], v[96:99], v[180:183]
 v_mfma_f32_16x16x32_bf16 v[216:219], v[24:27], v[100:103], v[216:219]
 s_add_u32 m0, s50, 50176
 s_add_u32 s47, s48, 373248
 buffer_load_dwordx4 v3, s[28:31], s47 offen sc1 lds
 ds_read_b128 v[60:63], v8 offset:5120
 v_mfma_f32_16x16x32_bf16 v[184:187], v[28:31], v[96:99], v[184:187]
 v_mfma_f32_16x16x32_bf16 v[220:223], v[28:31], v[100:103], v[220:223]
 ds_read_b128 v[16:19], v8 offset:6144
 s_waitcnt lgkmcnt(8)
 v_mfma_f32_16x16x32_bf16 v[188:191], v[32:35], v[96:99], v[188:191]
 s_add_u32 m0, s5, 36864
 s_add_u32 s47, s48, 73728
 s_mov_b64 exec, s[52:53]
 buffer_load_dwordx4 v4, s[28:31], s47 offen sc1 lds
 s_mov_b64 exec, -1
 v_mfma_f32_16x16x32_bf16 v[224:227], v[32:35], v[100:103], v[224:227]
 ds_read_b128 v[20:23], v8 offset:7168
 s_waitcnt lgkmcnt(8)
 v_mfma_f32_16x16x32_bf16 v[192:195], v[36:39], v[96:99], v[192:195]
 v_mfma_f32_16x16x32_bf16 v[228:231], v[36:39], v[100:103], v[228:231]
 ds_read_b128 v[24:27], v8 offset:8192
 s_waitcnt lgkmcnt(8)
 v_mfma_f32_16x16x32_bf16 v[160:163], v[40:43], v[104:107], v[160:163]
 v_mfma_f32_16x16x32_bf16 v[196:199], v[40:43], v[108:111], v[196:199]
 ds_read_b128 v[28:31], v8 offset:9216
 s_waitcnt lgkmcnt(8)
 v_mfma_f32_16x16x32_bf16 v[164:167], v[44:47], v[104:107], v[164:167]
 v_mfma_f32_16x16x32_bf16 v[200:203], v[44:47], v[108:111], v[200:203]
 ds_read_b128 v[32:35], v8 offset:10240
 s_waitcnt lgkmcnt(8)
 v_mfma_f32_16x16x32_bf16 v[168:171], v[48:51], v[104:107], v[168:171]
 v_mfma_f32_16x16x32_bf16 v[204:207], v[48:51], v[108:111], v[204:207]
 ds_read_b128 v[36:39], v8 offset:11264
 ds_read_b128 v[88:91], v244 offset:4096
 ds_read_b128 v[96:99], v245 offset:4096
 s_waitcnt lgkmcnt(10)
 v_mfma_f32_16x16x32_bf16 v[172:175], v[52:55], v[104:107], v[172:175]
 v_mfma_f32_16x16x32_bf16 v[208:211], v[52:55], v[108:111], v[208:211]
 ds_read_b128 v[40:43], v8 offset:12288
 s_waitcnt lgkmcnt(10)
 v_mfma_f32_16x16x32_bf16 v[176:179], v[56:59], v[104:107], v[176:179]
 v_mfma_f32_16x16x32_bf16 v[212:215], v[56:59], v[108:111], v[212:215]
 ds_read_b128 v[44:47], v8 offset:13312
 s_waitcnt lgkmcnt(2)
 v_mfma_f32_16x16x32_bf16 v[180:183], v[60:63], v[104:107], v[180:183]
 v_mfma_f32_16x16x32_bf16 v[216:219], v[60:63], v[108:111], v[216:219]
 s_add_u32 m0, s54, 4096
 s_add_u32 s47, s49, 1280
 buffer_load_dwordx4 v242, s[24:27], s47 offen lds
 ds_read_b128 v[48:51], v8 offset:14336
 v_mfma_f32_16x16x32_bf16 v[184:187], v[16:19], v[104:107], v[184:187]
 v_mfma_f32_16x16x32_bf16 v[220:223], v[16:19], v[108:111], v[220:223]
 ds_read_b128 v[52:55], v8 offset:15360
 s_waitcnt vmcnt(8)
 ds_read_b128 v[92:95], v244 offset:0
 ds_read_b128 v[100:103], v245 offset:0
 v_mfma_f32_16x16x32_bf16 v[188:191], v[20:23], v[104:107], v[188:191]
 s_add_u32 m0, s54, 5120
 s_add_u32 s47, s49, 1280
 buffer_load_dwordx4 v243, s[24:27], s47 offen lds
 v_mfma_f32_16x16x32_bf16 v[224:227], v[20:23], v[108:111], v[224:227]
 ds_read_b128 v[56:59], v8 offset:16384
 v_mfma_f32_16x16x32_bf16 v[192:195], v[24:27], v[104:107], v[192:195]
 v_mfma_f32_16x16x32_bf16 v[228:231], v[24:27], v[108:111], v[228:231]
 ds_read_b128 v[60:63], v8 offset:17408
 s_waitcnt lgkmcnt(2)
 v_mfma_f32_16x16x32_bf16 v[160:163], v[28:31], v[112:115], v[160:163]
 v_mfma_f32_16x16x32_bf16 v[196:199], v[28:31], v[116:119], v[196:199]
 s_add_u32 m0, s54, 0
 s_add_u32 s47, s49, 1536
 buffer_load_dwordx4 v240, s[24:27], s47 offen lds
 s_add_u32 m0, s54, 1024
 s_add_u32 s47, s49, 1536
 buffer_load_dwordx4 v241, s[24:27], s47 offen lds
 s_waitcnt vmcnt(4)
 s_barrier
 ds_read_b128 v[16:19], v8 offset:36864
 v_mfma_f32_16x16x32_bf16 v[164:167], v[32:35], v[112:115], v[164:167]
 s_add_u32 m0, s50, 73728
 s_add_u32 s47, s48, 92160
 buffer_load_dwordx4 v3, s[28:31], s47 offen sc1 lds
 v_mfma_f32_16x16x32_bf16 v[200:203], v[32:35], v[116:119], v[200:203]
 ds_read_b128 v[20:23], v8 offset:37888
 v_mfma_f32_16x16x32_bf16 v[168:171], v[36:39], v[112:115], v[168:171]
 v_mfma_f32_16x16x32_bf16 v[204:207], v[36:39], v[116:119], v[204:207]
 s_add_u32 m0, s50, 77824
 s_add_u32 s47, s48, 387072
 buffer_load_dwordx4 v3, s[28:31], s47 offen sc1 lds
 ds_read_b128 v[24:27], v8 offset:38912
 v_mfma_f32_16x16x32_bf16 v[172:175], v[40:43], v[112:115], v[172:175]
 v_mfma_f32_16x16x32_bf16 v[208:211], v[40:43], v[116:119], v[208:211]
 ds_read_b128 v[28:31], v8 offset:39936
 v_mfma_f32_16x16x32_bf16 v[176:179], v[44:47], v[112:115], v[176:179]
 s_add_u32 m0, s50, 82944
 s_add_u32 s47, s48, 96768
 buffer_load_dwordx4 v3, s[28:31], s47 offen sc1 lds
 v_mfma_f32_16x16x32_bf16 v[212:215], v[44:47], v[116:119], v[212:215]
 ds_read_b128 v[32:35], v8 offset:40960
 v_mfma_f32_16x16x32_bf16 v[180:183], v[48:51], v[112:115], v[180:183]
 v_mfma_f32_16x16x32_bf16 v[216:219], v[48:51], v[116:119], v[216:219]
 s_add_u32 m0, s50, 87040
 s_add_u32 s47, s48, 391680
 buffer_load_dwordx4 v3, s[28:31], s47 offen sc1 lds
 ds_read_b128 v[36:39], v8 offset:41984
 v_mfma_f32_16x16x32_bf16 v[184:187], v[52:55], v[112:115], v[184:187]
 v_mfma_f32_16x16x32_bf16 v[220:223], v[52:55], v[116:119], v[220:223]
 ds_read_b128 v[40:43], v8 offset:43008
 s_waitcnt lgkmcnt(8)
 v_mfma_f32_16x16x32_bf16 v[188:191], v[56:59], v[112:115], v[188:191]
 s_add_u32 m0, s5, 73728
 s_add_u32 s47, s48, 92160
 s_mov_b64 exec, s[52:53]
 buffer_load_dwordx4 v4, s[28:31], s47 offen sc1 lds
 s_mov_b64 exec, -1
 v_mfma_f32_16x16x32_bf16 v[224:227], v[56:59], v[116:119], v[224:227]
 ds_read_b128 v[44:47], v8 offset:44032
 s_waitcnt lgkmcnt(8)
 v_mfma_f32_16x16x32_bf16 v[192:195], v[60:63], v[112:115], v[192:195]
 v_mfma_f32_16x16x32_bf16 v[228:231], v[60:63], v[116:119], v[228:231]
 ds_read_b128 v[48:51], v8 offset:45056
 s_waitcnt lgkmcnt(8)
 v_mfma_f32_16x16x32_bf16 v[160:163], v[16:19], v[88:91], v[160:163]
 v_mfma_f32_16x16x32_bf16 v[196:199], v[16:19], v[92:95], v[196:199]
 ds_read_b128 v[52:55], v8 offset:46080
 s_waitcnt lgkmcnt(8)
 v_mfma_f32_16x16x32_bf16 v[164:167], v[20:23], v[88:91], v[164:167]
 v_mfma_f32_16x16x32_bf16 v[200:203], v[20:23], v[92:95], v[200:203]
 ds_read_b128 v[56:59], v8 offset:47104
 s_waitcnt lgkmcnt(8)
 v_mfma_f32_16x16x32_bf16 v[168:171], v[24:27], v[88:91], v[168:171]
 v_mfma_f32_16x16x32_bf16 v[204:207], v[24:27], v[92:95], v[204:207]
 ds_read_b128 v[60:63], v8 offset:48128
 ds_read_b128 v[104:107], v244 offset:2048
 ds_read_b128 v[112:115], v245 offset:2048
 s_waitcnt lgkmcnt(10)
 v_mfma_f32_16x16x32_bf16 v[172:175], v[28:31], v[88:91], v[172:175]
 v_mfma_f32_16x16x32_bf16 v[208:211], v[28:31], v[92:95], v[208:211]
 ds_read_b128 v[16:19], v8 offset:49152
 s_waitcnt lgkmcnt(10)
 v_mfma_f32_16x16x32_bf16 v[176:179], v[32:35], v[88:91], v[176:179]
 v_mfma_f32_16x16x32_bf16 v[212:215], v[32:35], v[92:95], v[212:215]
 ds_read_b128 v[20:23], v8 offset:50176
 s_waitcnt lgkmcnt(2)
 v_mfma_f32_16x16x32_bf16 v[180:183], v[36:39], v[88:91], v[180:183]
 v_mfma_f32_16x16x32_bf16 v[216:219], v[36:39], v[92:95], v[216:219]
 s_add_u32 m0, s54, 2048
 s_add_u32 s47, s49, 1536
 buffer_load_dwordx4 v242, s[24:27], s47 offen lds
 ds_read_b128 v[24:27], v8 offset:51200
 v_mfma_f32_16x16x32_bf16 v[184:187], v[40:43], v[88:91], v[184:187]
 v_mfma_f32_16x16x32_bf16 v[220:223], v[40:43], v[92:95], v[220:223]
 ds_read_b128 v[28:31], v8 offset:52224
 s_waitcnt vmcnt(8)
 ds_read_b128 v[108:111], v244 offset:4096
 ds_read_b128 v[116:119], v245 offset:4096
 v_mfma_f32_16x16x32_bf16 v[188:191], v[44:47], v[88:91], v[188:191]
 s_add_u32 m0, s54, 3072
 s_add_u32 s47, s49, 1536
 buffer_load_dwordx4 v243, s[24:27], s47 offen lds
 v_mfma_f32_16x16x32_bf16 v[224:227], v[44:47], v[92:95], v[224:227]
 ds_read_b128 v[32:35], v8 offset:53248
 v_mfma_f32_16x16x32_bf16 v[192:195], v[48:51], v[88:91], v[192:195]
 v_mfma_f32_16x16x32_bf16 v[228:231], v[48:51], v[92:95], v[228:231]
 ds_read_b128 v[36:39], v8 offset:54272
 s_waitcnt lgkmcnt(2)
 v_mfma_f32_16x16x32_bf16 v[160:163], v[52:55], v[96:99], v[160:163]
 v_mfma_f32_16x16x32_bf16 v[196:199], v[52:55], v[100:103], v[196:199]
 s_add_u32 m0, s54, 4096
 s_add_u32 s47, s49, 1792
 buffer_load_dwordx4 v240, s[24:27], s47 offen lds
 s_add_u32 m0, s54, 5120
 s_add_u32 s47, s49, 1792
 buffer_load_dwordx4 v241, s[24:27], s47 offen lds
 s_waitcnt vmcnt(4)
 s_barrier
 ds_read_b128 v[40:43], v9 offset:0
 v_mfma_f32_16x16x32_bf16 v[164:167], v[56:59], v[96:99], v[164:167]
 s_add_u32 m0, s50, 0
 s_add_u32 s47, s48, 110592
 buffer_load_dwordx4 v3, s[28:31], s47 offen sc1 lds
 v_mfma_f32_16x16x32_bf16 v[200:203], v[56:59], v[100:103], v[200:203]
 ds_read_b128 v[44:47], v9 offset:1024
 v_mfma_f32_16x16x32_bf16 v[168:171], v[60:63], v[96:99], v[168:171]
 v_mfma_f32_16x16x32_bf16 v[204:207], v[60:63], v[100:103], v[204:207]
 s_add_u32 m0, s50, 4096
 s_add_u32 s47, s48, 405504
 buffer_load_dwordx4 v3, s[28:31], s47 offen sc1 lds
 ds_read_b128 v[48:51], v9 offset:2048
 v_mfma_f32_16x16x32_bf16 v[172:175], v[16:19], v[96:99], v[172:175]
 v_mfma_f32_16x16x32_bf16 v[208:211], v[16:19], v[100:103], v[208:211]
 ds_read_b128 v[52:55], v9 offset:3072
 v_mfma_f32_16x16x32_bf16 v[176:179], v[20:23], v[96:99], v[176:179]
 s_add_u32 m0, s50, 9216
 s_add_u32 s47, s48, 115200
 buffer_load_dwordx4 v3, s[28:31], s47 offen sc1 lds
 v_mfma_f32_16x16x32_bf16 v[212:215], v[20:23], v[100:103], v[212:215]
 ds_read_b128 v[56:59], v9 offset:4096
 v_mfma_f32_16x16x32_bf16 v[180:183], v[24:27], v[96:99], v[180:183]
 v_mfma_f32_16x16x32_bf16 v[216:219], v[24:27], v[100:103], v[216:219]
 s_add_u32 m0, s50, 13312
 s_add_u32 s47, s48, 410112
 buffer_load_dwordx4 v3, s[28:31], s47 offen sc1 lds
 ds_read_b128 v[60:63], v9 offset:5120
 v_mfma_f32_16x16x32_bf16 v[184:187], v[28:31], v[96:99], v[184:187]
 v_mfma_f32_16x16x32_bf16 v[220:223], v[28:31], v[100:103], v[220:223]
 ds_read_b128 v[16:19], v9 offset:6144
 s_waitcnt lgkmcnt(8)
 v_mfma_f32_16x16x32_bf16 v[188:191], v[32:35], v[96:99], v[188:191]
 s_add_u32 m0, s5, 0
 s_add_u32 s47, s48, 110592
 s_mov_b64 exec, s[52:53]
 buffer_load_dwordx4 v4, s[28:31], s47 offen sc1 lds
 s_mov_b64 exec, -1
 v_mfma_f32_16x16x32_bf16 v[224:227], v[32:35], v[100:103], v[224:227]
 ds_read_b128 v[20:23], v9 offset:7168
 s_waitcnt lgkmcnt(8)
 v_mfma_f32_16x16x32_bf16 v[192:195], v[36:39], v[96:99], v[192:195]
 v_mfma_f32_16x16x32_bf16 v[228:231], v[36:39], v[100:103], v[228:231]
 ds_read_b128 v[24:27], v9 offset:8192
 s_waitcnt lgkmcnt(8)
 v_mfma_f32_16x16x32_bf16 v[160:163], v[40:43], v[104:107], v[160:163]
 v_mfma_f32_16x16x32_bf16 v[196:199], v[40:43], v[108:111], v[196:199]
 ds_read_b128 v[28:31], v9 offset:9216
 s_waitcnt lgkmcnt(8)
 v_mfma_f32_16x16x32_bf16 v[164:167], v[44:47], v[104:107], v[164:167]
 v_mfma_f32_16x16x32_bf16 v[200:203], v[44:47], v[108:111], v[200:203]
 ds_read_b128 v[32:35], v9 offset:10240
 s_waitcnt lgkmcnt(8)
 v_mfma_f32_16x16x32_bf16 v[168:171], v[48:51], v[104:107], v[168:171]
 v_mfma_f32_16x16x32_bf16 v[204:207], v[48:51], v[108:111], v[204:207]
 ds_read_b128 v[36:39], v9 offset:11264
 ds_read_b128 v[88:91], v244 offset:0
 ds_read_b128 v[96:99], v245 offset:0
 s_waitcnt lgkmcnt(10)
 v_mfma_f32_16x16x32_bf16 v[172:175], v[52:55], v[104:107], v[172:175]
 v_mfma_f32_16x16x32_bf16 v[208:211], v[52:55], v[108:111], v[208:211]
 ds_read_b128 v[40:43], v9 offset:12288
 s_waitcnt lgkmcnt(10)
 v_mfma_f32_16x16x32_bf16 v[176:179], v[56:59], v[104:107], v[176:179]
 v_mfma_f32_16x16x32_bf16 v[212:215], v[56:59], v[108:111], v[212:215]
 ds_read_b128 v[44:47], v9 offset:13312
 s_waitcnt lgkmcnt(2)
 v_mfma_f32_16x16x32_bf16 v[180:183], v[60:63], v[104:107], v[180:183]
 v_mfma_f32_16x16x32_bf16 v[216:219], v[60:63], v[108:111], v[216:219]
 s_add_u32 m0, s54, 0
 s_add_u32 s47, s49, 1792
 buffer_load_dwordx4 v242, s[24:27], s47 offen lds
 ds_read_b128 v[48:51], v9 offset:14336
 v_mfma_f32_16x16x32_bf16 v[184:187], v[16:19], v[104:107], v[184:187]
 v_mfma_f32_16x16x32_bf16 v[220:223], v[16:19], v[108:111], v[220:223]
 ds_read_b128 v[52:55], v9 offset:15360
 s_waitcnt vmcnt(8)
 ds_read_b128 v[92:95], v244 offset:2048
 ds_read_b128 v[100:103], v245 offset:2048
 v_mfma_f32_16x16x32_bf16 v[188:191], v[20:23], v[104:107], v[188:191]
 s_add_u32 m0, s54, 1024
 s_add_u32 s47, s49, 1792
 buffer_load_dwordx4 v243, s[24:27], s47 offen lds
 v_mfma_f32_16x16x32_bf16 v[224:227], v[20:23], v[108:111], v[224:227]
 ds_read_b128 v[56:59], v9 offset:16384
 v_mfma_f32_16x16x32_bf16 v[192:195], v[24:27], v[104:107], v[192:195]
 v_mfma_f32_16x16x32_bf16 v[228:231], v[24:27], v[108:111], v[228:231]
 ds_read_b128 v[60:63], v9 offset:17408
 v_mfma_f32_16x16x32_bf16 v[160:163], v[28:31], v[112:115], v[160:163]
 v_mfma_f32_16x16x32_bf16 v[196:199], v[28:31], v[116:119], v[196:199]
 s_waitcnt vmcnt(2)
 s_barrier
 ds_read_b128 v[16:19], v8 offset:0
 v_mfma_f32_16x16x32_bf16 v[164:167], v[32:35], v[112:115], v[164:167]
 s_add_u32 m0, s50, 36864
 s_add_u32 s47, s48, 129024
 buffer_load_dwordx4 v3, s[28:31], s47 offen sc1 lds
 v_mfma_f32_16x16x32_bf16 v[200:203], v[32:35], v[116:119], v[200:203]
 ds_read_b128 v[20:23], v8 offset:1024
 v_mfma_f32_16x16x32_bf16 v[168:171], v[36:39], v[112:115], v[168:171]
 v_mfma_f32_16x16x32_bf16 v[204:207], v[36:39], v[116:119], v[204:207]
 s_add_u32 m0, s50, 40960
 s_add_u32 s47, s48, 423936
 buffer_load_dwordx4 v3, s[28:31], s47 offen sc1 lds
 ds_read_b128 v[24:27], v8 offset:2048
 s_waitcnt lgkmcnt(10)
 v_mfma_f32_16x16x32_bf16 v[172:175], v[40:43], v[112:115], v[172:175]
 v_mfma_f32_16x16x32_bf16 v[208:211], v[40:43], v[116:119], v[208:211]
 ds_read_b128 v[28:31], v8 offset:3072
 s_waitcnt lgkmcnt(10)
 v_mfma_f32_16x16x32_bf16 v[176:179], v[44:47], v[112:115], v[176:179]
 s_add_u32 m0, s50, 46080
 s_add_u32 s47, s48, 133632
 buffer_load_dwordx4 v3, s[28:31], s47 offen sc1 lds
 v_mfma_f32_16x16x32_bf16 v[212:215], v[44:47], v[116:119], v[212:215]
 ds_read_b128 v[32:35], v8 offset:4096
 s_waitcnt lgkmcnt(10)
 v_mfma_f32_16x16x32_bf16 v[180:183], v[48:51], v[112:115], v[180:183]
 v_mfma_f32_16x16x32_bf16 v[216:219], v[48:51], v[116:119], v[216:219]
 s_add_u32 m0, s50, 50176
 s_add_u32 s47, s48, 428544
 buffer_load_dwordx4 v3, s[28:31], s47 offen sc1 lds
 ds_read_b128 v[36:39], v8 offset:5120
 s_waitcnt lgkmcnt(10)
 v_mfma_f32_16x16x32_bf16 v[184:187], v[52:55], v[112:115], v[184:187]
 v_mfma_f32_16x16x32_bf16 v[220:223], v[52:55], v[116:119], v[220:223]
 ds_read_b128 v[40:43], v8 offset:6144
 s_waitcnt lgkmcnt(8)
 v_mfma_f32_16x16x32_bf16 v[188:191], v[56:59], v[112:115], v[188:191]
 s_add_u32 m0, s5, 36864
 s_add_u32 s47, s48, 129024
 s_mov_b64 exec, s[52:53]
 buffer_load_dwordx4 v4, s[28:31], s47 offen sc1 lds
 s_mov_b64 exec, -1
 v_mfma_f32_16x16x32_bf16 v[224:227], v[56:59], v[116:119], v[224:227]
 ds_read_b128 v[44:47], v8 offset:7168
 s_waitcnt lgkmcnt(8)
 v_mfma_f32_16x16x32_bf16 v[192:195], v[60:63], v[112:115], v[192:195]
 v_mfma_f32_16x16x32_bf16 v[228:231], v[60:63], v[116:119], v[228:231]
 ds_read_b128 v[48:51], v8 offset:8192
 s_waitcnt lgkmcnt(8)
 v_mfma_f32_16x16x32_bf16 v[160:163], v[16:19], v[88:91], v[160:163]
 v_mfma_f32_16x16x32_bf16 v[196:199], v[16:19], v[92:95], v[196:199]
 ds_read_b128 v[52:55], v8 offset:9216
 s_waitcnt lgkmcnt(8)
 v_mfma_f32_16x16x32_bf16 v[164:167], v[20:23], v[88:91], v[164:167]
 v_mfma_f32_16x16x32_bf16 v[200:203], v[20:23], v[92:95], v[200:203]
 ds_read_b128 v[56:59], v8 offset:10240
 s_waitcnt lgkmcnt(8)
 v_mfma_f32_16x16x32_bf16 v[168:171], v[24:27], v[88:91], v[168:171]
 v_mfma_f32_16x16x32_bf16 v[204:207], v[24:27], v[92:95], v[204:207]
 ds_read_b128 v[60:63], v8 offset:11264
 ds_read_b128 v[104:107], v244 offset:4096
 ds_read_b128 v[112:115], v245 offset:4096
 s_waitcnt lgkmcnt(10)
 v_mfma_f32_16x16x32_bf16 v[172:175], v[28:31], v[88:91], v[172:175]
 v_mfma_f32_16x16x32_bf16 v[208:211], v[28:31], v[92:95], v[208:211]
 ds_read_b128 v[16:19], v8 offset:12288
 s_waitcnt lgkmcnt(10)
 v_mfma_f32_16x16x32_bf16 v[176:179], v[32:35], v[88:91], v[176:179]
 v_mfma_f32_16x16x32_bf16 v[212:215], v[32:35], v[92:95], v[212:215]
 ds_read_b128 v[20:23], v8 offset:13312
 s_waitcnt lgkmcnt(10)
 v_mfma_f32_16x16x32_bf16 v[180:183], v[36:39], v[88:91], v[180:183]
 v_mfma_f32_16x16x32_bf16 v[216:219], v[36:39], v[92:95], v[216:219]
 ds_read_b128 v[24:27], v8 offset:14336
 s_waitcnt lgkmcnt(10)
 v_mfma_f32_16x16x32_bf16 v[184:187], v[40:43], v[88:91], v[184:187]
 v_mfma_f32_16x16x32_bf16 v[220:223], v[40:43], v[92:95], v[220:223]
 ds_read_b128 v[28:31], v8 offset:15360
 s_waitcnt vmcnt(5)
 ds_read_b128 v[108:111], v244 offset:0
 ds_read_b128 v[116:119], v245 offset:0
 s_waitcnt lgkmcnt(12)
 v_mfma_f32_16x16x32_bf16 v[188:191], v[44:47], v[88:91], v[188:191]
 v_mfma_f32_16x16x32_bf16 v[224:227], v[44:47], v[92:95], v[224:227]
 ds_read_b128 v[32:35], v8 offset:16384
 s_waitcnt lgkmcnt(12)
 v_mfma_f32_16x16x32_bf16 v[192:195], v[48:51], v[88:91], v[192:195]
 v_mfma_f32_16x16x32_bf16 v[228:231], v[48:51], v[92:95], v[228:231]
 ds_read_b128 v[36:39], v8 offset:17408
 s_waitcnt lgkmcnt(12)
 v_mfma_f32_16x16x32_bf16 v[160:163], v[52:55], v[96:99], v[160:163]
 v_mfma_f32_16x16x32_bf16 v[196:199], v[52:55], v[100:103], v[196:199]
 s_waitcnt vmcnt(0)
 s_barrier
 ds_read_b128 v[40:43], v8 offset:36864
 s_waitcnt lgkmcnt(12)
 v_mfma_f32_16x16x32_bf16 v[164:167], v[56:59], v[96:99], v[164:167]
 v_mfma_f32_16x16x32_bf16 v[200:203], v[56:59], v[100:103], v[200:203]
 ds_read_b128 v[44:47], v8 offset:37888
 s_waitcnt lgkmcnt(12)
 v_mfma_f32_16x16x32_bf16 v[168:171], v[60:63], v[96:99], v[168:171]
 v_mfma_f32_16x16x32_bf16 v[204:207], v[60:63], v[100:103], v[204:207]
 ds_read_b128 v[48:51], v8 offset:38912
 s_waitcnt lgkmcnt(10)
 v_mfma_f32_16x16x32_bf16 v[172:175], v[16:19], v[96:99], v[172:175]
 v_mfma_f32_16x16x32_bf16 v[208:211], v[16:19], v[100:103], v[208:211]
 ds_read_b128 v[52:55], v8 offset:39936
 s_waitcnt lgkmcnt(10)
 v_mfma_f32_16x16x32_bf16 v[176:179], v[20:23], v[96:99], v[176:179]
 v_mfma_f32_16x16x32_bf16 v[212:215], v[20:23], v[100:103], v[212:215]
 ds_read_b128 v[56:59], v8 offset:40960
 s_waitcnt lgkmcnt(10)
 v_mfma_f32_16x16x32_bf16 v[180:183], v[24:27], v[96:99], v[180:183]
 v_mfma_f32_16x16x32_bf16 v[216:219], v[24:27], v[100:103], v[216:219]
 ds_read_b128 v[60:63], v8 offset:41984
 s_waitcnt lgkmcnt(10)
 v_mfma_f32_16x16x32_bf16 v[184:187], v[28:31], v[96:99], v[184:187]
 v_mfma_f32_16x16x32_bf16 v[220:223], v[28:31], v[100:103], v[220:223]
 ds_read_b128 v[16:19], v8 offset:43008
 s_waitcnt lgkmcnt(8)
 v_mfma_f32_16x16x32_bf16 v[188:191], v[32:35], v[96:99], v[188:191]
 v_mfma_f32_16x16x32_bf16 v[224:227], v[32:35], v[100:103], v[224:227]
 ds_read_b128 v[20:23], v8 offset:44032
 s_waitcnt lgkmcnt(8)
 v_mfma_f32_16x16x32_bf16 v[192:195], v[36:39], v[96:99], v[192:195]
 v_mfma_f32_16x16x32_bf16 v[228:231], v[36:39], v[100:103], v[228:231]
 ds_read_b128 v[24:27], v8 offset:45056
 s_waitcnt lgkmcnt(8)
 v_mfma_f32_16x16x32_bf16 v[160:163], v[40:43], v[104:107], v[160:163]
 v_mfma_f32_16x16x32_bf16 v[196:199], v[40:43], v[108:111], v[196:199]
 ds_read_b128 v[28:31], v8 offset:46080
 s_waitcnt lgkmcnt(8)
 v_mfma_f32_16x16x32_bf16 v[164:167], v[44:47], v[104:107], v[164:167]
 v_mfma_f32_16x16x32_bf16 v[200:203], v[44:47], v[108:111], v[200:203]
 ds_read_b128 v[32:35], v8 offset:47104
 s_waitcnt lgkmcnt(8)
 v_mfma_f32_16x16x32_bf16 v[168:171], v[48:51], v[104:107], v[168:171]
 v_mfma_f32_16x16x32_bf16 v[204:207], v[48:51], v[108:111], v[204:207]
 ds_read_b128 v[36:39], v8 offset:48128
 s_waitcnt lgkmcnt(8)
 v_mfma_f32_16x16x32_bf16 v[172:175], v[52:55], v[104:107], v[172:175]
 v_mfma_f32_16x16x32_bf16 v[208:211], v[52:55], v[108:111], v[208:211]
 ds_read_b128 v[40:43], v8 offset:49152
 s_waitcnt lgkmcnt(8)
 v_mfma_f32_16x16x32_bf16 v[176:179], v[56:59], v[104:107], v[176:179]
 v_mfma_f32_16x16x32_bf16 v[212:215], v[56:59], v[108:111], v[212:215]
 ds_read_b128 v[44:47], v8 offset:50176
 s_waitcnt lgkmcnt(8)
 v_mfma_f32_16x16x32_bf16 v[180:183], v[60:63], v[104:107], v[180:183]
 v_mfma_f32_16x16x32_bf16 v[216:219], v[60:63], v[108:111], v[216:219]
 ds_read_b128 v[48:51], v8 offset:51200
 s_waitcnt lgkmcnt(8)
 v_mfma_f32_16x16x32_bf16 v[184:187], v[16:19], v[104:107], v[184:187]
 v_mfma_f32_16x16x32_bf16 v[220:223], v[16:19], v[108:111], v[220:223]
 ds_read_b128 v[52:55], v8 offset:52224
 s_waitcnt lgkmcnt(8)
 v_mfma_f32_16x16x32_bf16 v[188:191], v[20:23], v[104:107], v[188:191]
 v_mfma_f32_16x16x32_bf16 v[224:227], v[20:23], v[108:111], v[224:227]
 ds_read_b128 v[56:59], v8 offset:53248
 s_waitcnt lgkmcnt(8)
 v_mfma_f32_16x16x32_bf16 v[192:195], v[24:27], v[104:107], v[192:195]
 v_mfma_f32_16x16x32_bf16 v[228:231], v[24:27], v[108:111], v[228:231]
 ds_read_b128 v[60:63], v8 offset:54272
 s_waitcnt lgkmcnt(8)
 v_mfma_f32_16x16x32_bf16 v[160:163], v[28:31], v[112:115], v[160:163]
 v_mfma_f32_16x16x32_bf16 v[196:199], v[28:31], v[116:119], v[196:199]
 s_waitcnt lgkmcnt(7)
 v_mfma_f32_16x16x32_bf16 v[164:167], v[32:35], v[112:115], v[164:167]
 v_mfma_f32_16x16x32_bf16 v[200:203], v[32:35], v[116:119], v[200:203]
 s_waitcnt lgkmcnt(6)
 v_mfma_f32_16x16x32_bf16 v[168:171], v[36:39], v[112:115], v[168:171]
 v_mfma_f32_16x16x32_bf16 v[204:207], v[36:39], v[116:119], v[204:207]
 s_waitcnt lgkmcnt(5)
 v_mfma_f32_16x16x32_bf16 v[172:175], v[40:43], v[112:115], v[172:175]
 v_mfma_f32_16x16x32_bf16 v[208:211], v[40:43], v[116:119], v[208:211]
 s_waitcnt lgkmcnt(4)
 v_mfma_f32_16x16x32_bf16 v[176:179], v[44:47], v[112:115], v[176:179]
 v_mfma_f32_16x16x32_bf16 v[212:215], v[44:47], v[116:119], v[212:215]
 s_waitcnt lgkmcnt(3)
 v_mfma_f32_16x16x32_bf16 v[180:183], v[48:51], v[112:115], v[180:183]
 v_mfma_f32_16x16x32_bf16 v[216:219], v[48:51], v[116:119], v[216:219]
 s_waitcnt lgkmcnt(2)
 v_mfma_f32_16x16x32_bf16 v[184:187], v[52:55], v[112:115], v[184:187]
 v_mfma_f32_16x16x32_bf16 v[220:223], v[52:55], v[116:119], v[220:223]
 s_waitcnt lgkmcnt(1)
 v_mfma_f32_16x16x32_bf16 v[188:191], v[56:59], v[112:115], v[188:191]
 v_mfma_f32_16x16x32_bf16 v[224:227], v[56:59], v[116:119], v[224:227]
 s_waitcnt lgkmcnt(0)
 v_mfma_f32_16x16x32_bf16 v[192:195], v[60:63], v[112:115], v[192:195]
 v_mfma_f32_16x16x32_bf16 v[228:231], v[60:63], v[116:119], v[228:231]
 s_cmp_lg_u32 s100, 1
 s_cbranch_scc1 ks_nofr
 v_lshlrev_b32 v1, 2, v2
 s_lshl_b32 s47, s20, 9
 s_add_u32 s47, s47, 327680
 s_mov_b32 s3, 0
ks_pl2:
 buffer_load_dword v152, v1, s[76:79], s47 offen sc1
 s_add_u32 s3, s3, 1
 s_waitcnt vmcnt(0)
 v_cmp_ne_u32 vcc, s101, v152
 s_cmp_ge_u32 s3, 0x40000
 s_cbranch_scc1 ks_pl2y
 s_cmp_eq_u64 vcc, 0
 s_cbranch_scc1 ks_pl2y
 s_sleep 3
 s_branch ks_pl2
ks_pl2y:
 s_mov_b64 exec, -1
ks_pl2x:
 s_add_u32 s47, s47, 256
 s_mov_b32 s3, 0
ks_pl3:
 buffer_load_dword v152, v1, s[76:79], s47 offen sc1
 s_add_u32 s3, s3, 1
 s_waitcnt vmcnt(0)
 v_cmp_ne_u32 vcc, s101, v152
 s_cmp_ge_u32 s3, 0x40000
 s_cbranch_scc1 ks_pl3y
 s_cmp_eq_u64 vcc, 0
 s_cbranch_scc1 ks_pl3y
 s_sleep 3
 s_branch ks_pl3
ks_pl3y:
 s_mov_b64 exec, -1
ks_pl3x:
ks_nofr:
 s_barrier
 buffer_load_dwordx4 v[248:251], v236, s[36:39], s68 offen sc1
 buffer_load_dwordx2 v[252:253], v237, s[36:39], s69 offen sc1
 s_nop 5
 s_cmp_eq_u32 s46, 0
 s_cbranch_scc1 ks_x0
 ds_write_b128 v232, v[160:163] offset:0
 ds_write_b128 v232, v[164:167] offset:1024
 ds_write_b128 v232, v[168:171] offset:2048
 ds_write_b128 v232, v[172:175] offset:3072
 ds_write_b128 v232, v[176:179] offset:4096
 ds_write_b128 v232, v[180:183] offset:5120
 ds_write_b128 v232, v[184:187] offset:6144
 ds_write_b128 v232, v[188:191] offset:7168
 ds_write_b128 v232, v[192:195] offset:8192
 s_waitcnt lgkmcnt(0)
 s_barrier
 ds_read_b128 v[88:91], v233 offset:0
 ds_read_b128 v[92:95], v233 offset:1024
 ds_read_b128 v[96:99], v233 offset:2048
 ds_read_b128 v[100:103], v233 offset:3072
 ds_read_b128 v[104:107], v233 offset:4096
 ds_read_b128 v[108:111], v233 offset:5120
 ds_read_b128 v[112:115], v233 offset:6144
 ds_read_b128 v[116:119], v233 offset:7168
 ds_read_b128 v[120:123], v233 offset:8192
 s_waitcnt lgkmcnt(8)
 v_add_f32 v196, v196, v88
 v_add_f32 v197, v197, v89
 v_add_f32 v198, v198, v90
 v_add_f32 v199, v199, v91
 v_cvt_pk_bf16_f32 v16, v196, v197
 v_cvt_pk_bf16_f32 v17, v198, v199
 s_waitcnt lgkmcnt(7)
 v_add_f32 v200, v200, v92
 v_add_f32 v201, v201, v93
 v_add_f32 v202, v202, v94
 v_add_f32 v203, v203, v95
 v_cvt_pk_bf16_f32 v18, v200, v201
 v_cvt_pk_bf16_f32 v19, v202, v203
 buffer_store_dwordx4 v[16:19], v234, s[32:35], s75 offen offset:0 sc1
 s_waitcnt lgkmcnt(6)
 v_add_f32 v204, v204, v96
 v_add_f32 v205, v205, v97
 v_add_f32 v206, v206, v98
 v_add_f32 v207, v207, v99
 v_cvt_pk_bf16_f32 v20, v204, v205
 v_cvt_pk_bf16_f32 v21, v206, v207
 s_waitcnt lgkmcnt(5)
 v_add_f32 v208, v208, v100
 v_add_f32 v209, v209, v101
 v_add_f32 v210, v210, v102
 v_add_f32 v211, v211, v103
 v_cvt_pk_bf16_f32 v22, v208, v209
 v_cvt_pk_bf16_f32 v23, v210, v211
 buffer_store_dwordx4 v[20:23], v234, s[32:35], s75 offen offset:1024 sc1
 s_waitcnt lgkmcnt(4)
 v_add_f32 v212, v212, v104
 v_add_f32 v213, v213, v105
 v_add_f32 v214, v214, v106
 v_add_f32 v215, v215, v107
 v_cvt_pk_bf16_f32 v24, v212, v213
 v_cvt_pk_bf16_f32 v25, v214, v215
 s_waitcnt lgkmcnt(3)
 v_add_f32 v216, v216, v108
 v_add_f32 v217, v217, v109
 v_add_f32 v218, v218, v110
 v_add_f32 v219, v219, v111
 v_cvt_pk_bf16_f32 v26, v216, v217
 v_cvt_pk_bf16_f32 v27, v218, v219
 buffer_store_dwordx4 v[24:27], v234, s[32:35], s75 offen offset:2048 sc1
 s_waitcnt lgkmcnt(2)
 v_add_f32 v220, v220, v112
 v_add_f32 v221, v221, v113
 v_add_f32 v222, v222, v114
 v_add_f32 v223, v223, v115
 v_cvt_pk_bf16_f32 v28, v220, v221
 v_cvt_pk_bf16_f32 v29, v222, v223
 s_waitcnt lgkmcnt(1)
 v_add_f32 v224, v224, v116
 v_add_f32 v225, v225, v117
 v_add_f32 v226, v226, v118
 v_add_f32 v227, v227, v119
 v_cvt_pk_bf16_f32 v30, v224, v225
 v_cvt_pk_bf16_f32 v31, v226, v227
 buffer_store_dwordx4 v[28:31], v234, s[32:35], s75 offen offset:3072 sc1
 s_waitcnt lgkmcnt(0)
 v_add_f32 v228, v228, v120
 v_add_f32 v229, v229, v121
 v_add_f32 v230, v230, v122
 v_add_f32 v231, v231, v123
 v_cvt_pk_bf16_f32 v32, v228, v229
 v_cvt_pk_bf16_f32 v33, v230, v231
 s_branch ks_x1
ks_x0:
 ds_write_b128 v232, v[196:199] offset:0
 ds_write_b128 v232, v[200:203] offset:1024
 ds_write_b128 v232, v[204:207] offset:2048
 ds_write_b128 v232, v[208:211] offset:3072
 ds_write_b128 v232, v[212:215] offset:4096
 ds_write_b128 v232, v[216:219] offset:5120
 ds_write_b128 v232, v[220:223] offset:6144
 ds_write_b128 v232, v[224:227] offset:7168
 ds_write_b128 v232, v[228:231] offset:8192
 s_waitcnt lgkmcnt(0)
 s_barrier
 ds_read_b128 v[88:91], v233 offset:0
 ds_read_b128 v[92:95], v233 offset:1024
 ds_read_b128 v[96:99], v233 offset:2048
 ds_read_b128 v[100:103], v233 offset:3072
 ds_read_b128 v[104:107], v233 offset:4096
 ds_read_b128 v[108:111], v233 offset:5120
 ds_read_b128 v[112:115], v233 offset:6144
 ds_read_b128 v[116:119], v233 offset:7168
 ds_read_b128 v[120:123], v233 offset:8192
 s_waitcnt lgkmcnt(8)
 v_add_f32 v160, v160, v88
 v_add_f32 v161, v161, v89
 v_add_f32 v162, v162, v90
 v_add_f32 v163, v163, v91
 v_cvt_pk_bf16_f32 v16, v160, v161
 v_cvt_pk_bf16_f32 v17, v162, v163
 s_waitcnt lgkmcnt(7)
 v_add_f32 v164, v164, v92
 v_add_f32 v165, v165, v93
 v_add_f32 v166, v166, v94
 v_add_f32 v167, v167, v95
 v_cvt_pk_bf16_f32 v18, v164, v165
 v_cvt_pk_bf16_f32 v19, v166, v167
 buffer_store_dwordx4 v[16:19], v234, s[32:35], s75 offen offset:0 sc1
 s_waitcnt lgkmcnt(6)
 v_add_f32 v168, v168, v96
 v_add_f32 v169, v169, v97
 v_add_f32 v170, v170, v98
 v_add_f32 v171, v171, v99
 v_cvt_pk_bf16_f32 v20, v168, v169
 v_cvt_pk_bf16_f32 v21, v170, v171
 s_waitcnt lgkmcnt(5)
 v_add_f32 v172, v172, v100
 v_add_f32 v173, v173, v101
 v_add_f32 v174, v174, v102
 v_add_f32 v175, v175, v103
 v_cvt_pk_bf16_f32 v22, v172, v173
 v_cvt_pk_bf16_f32 v23, v174, v175
 buffer_store_dwordx4 v[20:23], v234, s[32:35], s75 offen offset:1024 sc1
 s_waitcnt lgkmcnt(4)
 v_add_f32 v176, v176, v104
 v_add_f32 v177, v177, v105
 v_add_f32 v178, v178, v106
 v_add_f32 v179, v179, v107
 v_cvt_pk_bf16_f32 v24, v176, v177
 v_cvt_pk_bf16_f32 v25, v178, v179
 s_waitcnt lgkmcnt(3)
 v_add_f32 v180, v180, v108
 v_add_f32 v181, v181, v109
 v_add_f32 v182, v182, v110
 v_add_f32 v183, v183, v111
 v_cvt_pk_bf16_f32 v26, v180, v181
 v_cvt_pk_bf16_f32 v27, v182, v183
 buffer_store_dwordx4 v[24:27], v234, s[32:35], s75 offen offset:2048 sc1
 s_waitcnt lgkmcnt(2)
 v_add_f32 v184, v184, v112
 v_add_f32 v185, v185, v113
 v_add_f32 v186, v186, v114
 v_add_f32 v187, v187, v115
 v_cvt_pk_bf16_f32 v28, v184, v185
 v_cvt_pk_bf16_f32 v29, v186, v187
 s_waitcnt lgkmcnt(1)
 v_add_f32 v188, v188, v116
 v_add_f32 v189, v189, v117
 v_add_f32 v190, v190, v118
 v_add_f32 v191, v191, v119
 v_cvt_pk_bf16_f32 v30, v188, v189
 v_cvt_pk_bf16_f32 v31, v190, v191
 buffer_store_dwordx4 v[28:31], v234, s[32:35], s75 offen offset:3072 sc1
 s_waitcnt lgkmcnt(0)
 v_add_f32 v192, v192, v120
 v_add_f32 v193, v193, v121
 v_add_f32 v194, v194, v122
 v_add_f32 v195, v195, v123
 v_cvt_pk_bf16_f32 v32, v192, v193
 v_cvt_pk_bf16_f32 v33, v194, v195
ks_x1:
 buffer_store_dwordx2 v[32:33], v235, s[32:35], s75 offen sc1
 v_mov_b32 v9, s101
 v_mov_b32 v10, 0
 s_mov_b32 s53, 0
 s_waitcnt vmcnt(0)
 s_mov_b64 exec, 1
 buffer_store_dword v9, v10, s[76:79], s57 offen sc1
 s_mov_b64 exec, -1
 s_add_u32 s8, s18, 34119680
 s_addc_u32 s9, s19, 0
 s_and_b32 s9, s9, 0xffff
 s_mov_b32 s10, 10911744
 s_mov_b32 s11, 0x00020000
 s_and_b32 s12, s2, 7
 s_lshr_b32 s13, s2, 6
 s_lshl_b32 s12, s12, 2
 s_add_u32 s12, s12, s13
 s_mul_i32 s12, s12, 340992
 s_mul_i32 s13, s20, 4608
 s_add_u32 s12, s12, s13
 s_add_u32 m0, s13, 73728
 s_add_u32 s14, s12, 0
 buffer_load_dwordx4 v234, s[8:11], s14 offen offset:0 sc1 lds
 buffer_load_dwordx4 v234, s[8:11], s14 offen offset:1024 sc1 lds
 buffer_load_dwordx4 v234, s[8:11], s14 offen offset:2048 sc1 lds
 buffer_load_dwordx4 v234, s[8:11], s14 offen offset:3072 sc1 lds
 s_add_u32 m0, s13, 77824
 s_add_u32 s14, s14, 4096
 s_mov_b32 exec_hi, 0
 buffer_load_dwordx4 v234, s[8:11], s14 offen sc1 lds
 s_mov_b64 exec, -1
 s_add_u32 m0, s13, 110592
 s_add_u32 s14, s12, 36864
 buffer_load_dwordx4 v234, s[8:11], s14 offen offset:0 sc1 lds
 buffer_load_dwordx4 v234, s[8:11], s14 offen offset:1024 sc1 lds
 buffer_load_dwordx4 v234, s[8:11], s14 offen offset:2048 sc1 lds
 buffer_load_dwordx4 v234, s[8:11], s14 offen offset:3072 sc1 lds
 s_add_u32 m0, s13, 114688
 s_add_u32 s14, s14, 4096
 s_mov_b32 exec_hi, 0
 buffer_load_dwordx4 v234, s[8:11], s14 offen sc1 lds
 s_mov_b64 exec, -1
 s_mov_b64 exec, 1
ks_poll:
 buffer_load_dwordx4 v[108:111], v10, s[76:79], s56 offen sc1
 s_add_u32 s53, s53, 1
 s_waitcnt vmcnt(0)
 v_xor_b32 v108, s101, v108
 v_xor_b32 v109, s101, v109
 v_xor_b32 v110, s101, v110
 v_xor_b32 v111, s101, v111
 v_or_b32 v108, v108, v109
 v_or_b32 v110, v110, v111
 v_or_b32 v108, v108, v110
 s_nop 0
 v_readfirstlane_b32 s54, v108
 s_cmp_ge_u32 s53, 0x40000
 s_cbranch_scc1 ks_pollx
 s_cmp_eq_u32 s54, 0
 s_cbranch_scc1 ks_pollx
 s_sleep 4
 s_branch ks_poll
ks_pollx:
 s_mov_b64 exec, -1
 buffer_load_dwordx4 v[16:19], v234, s[32:35], s6 offen sc1
 buffer_load_dwordx2 v[20:21], v235, s[32:35], s7 offen sc1
 s_add_u32 s6, s6, 36864
 s_add_u32 s7, s7, 36864
 buffer_load_dwordx4 v[22:25], v234, s[32:35], s6 offen sc1
 buffer_load_dwordx2 v[26:27], v235, s[32:35], s7 offen sc1
 s_add_u32 s6, s6, 36864
 s_add_u32 s7, s7, 36864
 buffer_load_dwordx4 v[28:31], v234, s[32:35], s6 offen sc1
 buffer_load_dwordx2 v[32:33], v235, s[32:35], s7 offen sc1
 s_add_u32 s6, s6, 36864
 s_add_u32 s7, s7, 36864
 buffer_load_dwordx4 v[34:37], v234, s[32:35], s6 offen sc1
 buffer_load_dwordx2 v[38:39], v235, s[32:35], s7 offen sc1
 v_mov_b32 v120, 0
 v_mov_b32 v121, 0
 v_lshlrev_b32 v60, 16, v248
 v_and_b32 v61, s58, v248
 v_lshlrev_b32 v62, 16, v249
 v_and_b32 v63, s58, v249
 v_lshlrev_b32 v64, 16, v250
 v_and_b32 v65, s58, v250
 v_lshlrev_b32 v66, 16, v251
 v_and_b32 v67, s58, v251
 v_lshlrev_b32 v68, 16, v252
 v_and_b32 v69, s58, v252
 v_lshlrev_b32 v70, 16, v253
 v_and_b32 v71, s58, v253
 s_waitcnt vmcnt(0)
 v_lshlrev_b32 v40, 16, v16
 v_and_b32 v41, s58, v16
 v_lshlrev_b32 v42, 16, v22
 v_and_b32 v43, s58, v22
 v_lshlrev_b32 v44, 16, v28
 v_and_b32 v45, s58, v28
 v_lshlrev_b32 v46, 16, v34
 v_and_b32 v47, s58, v34
 v_add_f32 v40, v40, v42
 v_add_f32 v41, v41, v43
 v_add_f32 v44, v44, v46
 v_add_f32 v45, v45, v47
 v_cvt_pk_bf16_f32 v48, v40, v41
 v_cvt_pk_bf16_f32 v49, v44, v45
 v_lshlrev_b32 v40, 16, v48
 v_and_b32 v41, s58, v48
 v_lshlrev_b32 v44, 16, v49
 v_and_b32 v45, s58, v49
 v_sub_f32 v40, v40, v44
 v_sub_f32 v41, v41, v45
 v_cvt_pk_bf16_f32 v48, v40, v41
 v_lshlrev_b32 v40, 16, v48
 v_and_b32 v41, s58, v48
 v_add_f32 v40, v40, v60
 v_add_f32 v41, v41, v61
 v_cvt_pk_bf16_f32 v248, v40, v41
 v_lshlrev_b32 v40, 16, v248
 v_and_b32 v41, s58, v248
 v_add_f32 v120, v120, v40
 v_fmac_f32 v121, v40, v40
 v_add_f32 v120, v120, v41
 v_fmac_f32 v121, v41, v41
 v_lshlrev_b32 v40, 16, v17
 v_and_b32 v41, s58, v17
 v_lshlrev_b32 v42, 16, v23
 v_and_b32 v43, s58, v23
 v_lshlrev_b32 v44, 16, v29
 v_and_b32 v45, s58, v29
 v_lshlrev_b32 v46, 16, v35
 v_and_b32 v47, s58, v35
 v_add_f32 v40, v40, v42
 v_add_f32 v41, v41, v43
 v_add_f32 v44, v44, v46
 v_add_f32 v45, v45, v47
 v_cvt_pk_bf16_f32 v48, v40, v41
 v_cvt_pk_bf16_f32 v49, v44, v45
 v_lshlrev_b32 v40, 16, v48
 v_and_b32 v41, s58, v48
 v_lshlrev_b32 v44, 16, v49
 v_and_b32 v45, s58, v49
 v_sub_f32 v40, v40, v44
 v_sub_f32 v41, v41, v45
 v_cvt_pk_bf16_f32 v48, v40, v41
 v_lshlrev_b32 v40, 16, v48
 v_and_b32 v41, s58, v48
 v_add_f32 v40, v40, v62
 v_add_f32 v41, v41, v63
 v_cvt_pk_bf16_f32 v249, v40, v41
 v_lshlrev_b32 v40, 16, v249
 v_and_b32 v41, s58, v249
 v_add_f32 v120, v120, v40
 v_fmac_f32 v121, v40, v40
 v_add_f32 v120, v120, v41
 v_fmac_f32 v121, v41, v41
 v_lshlrev_b32 v40, 16, v18
 v_and_b32 v41, s58, v18
 v_lshlrev_b32 v42, 16, v24
 v_and_b32 v43, s58, v24
 v_lshlrev_b32 v44, 16, v30
 v_and_b32 v45, s58, v30
 v_lshlrev_b32 v46, 16, v36
 v_and_b32 v47, s58, v36
 v_add_f32 v40, v40, v42
 v_add_f32 v41, v41, v43
 v_add_f32 v44, v44, v46
 v_add_f32 v45, v45, v47
 v_cvt_pk_bf16_f32 v48, v40, v41
 v_cvt_pk_bf16_f32 v49, v44, v45
 v_lshlrev_b32 v40, 16, v48
 v_and_b32 v41, s58, v48
 v_lshlrev_b32 v44, 16, v49
 v_and_b32 v45, s58, v49
 v_sub_f32 v40, v40, v44
 v_sub_f32 v41, v41, v45
 v_cvt_pk_bf16_f32 v48, v40, v41
 v_lshlrev_b32 v40, 16, v48
 v_and_b32 v41, s58, v48
 v_add_f32 v40, v40, v64
 v_add_f32 v41, v41, v65
 v_cvt_pk_bf16_f32 v250, v40, v41
 v_lshlrev_b32 v40, 16, v250
 v_and_b32 v41, s58, v250
 v_add_f32 v120, v120, v40
 v_fmac_f32 v121, v40, v40
 v_add_f32 v120, v120, v41
 v_fmac_f32 v121, v41, v41
 v_lshlrev_b32 v40, 16, v19
 v_and_b32 v41, s58, v19
 v_lshlrev_b32 v42, 16, v25
 v_and_b32 v43, s58, v25
 v_lshlrev_b32 v44, 16, v31
 v_and_b32 v45, s58, v31
 v_lshlrev_b32 v46, 16, v37
 v_and_b32 v47, s58, v37
 v_add_f32 v40, v40, v42
 v_add_f32 v41, v41, v43
 v_add_f32 v44, v44, v46
 v_add_f32 v45, v45, v47
 v_cvt_pk_bf16_f32 v48, v40, v41
 v_cvt_pk_bf16_f32 v49, v44, v45
 v_lshlrev_b32 v40, 16, v48
 v_and_b32 v41, s58, v48
 v_lshlrev_b32 v44, 16, v49
 v_and_b32 v45, s58, v49
 v_sub_f32 v40, v40, v44
 v_sub_f32 v41, v41, v45
 v_cvt_pk_bf16_f32 v48, v40, v41
 v_lshlrev_b32 v40, 16, v48
 v_and_b32 v41, s58, v48
 v_add_f32 v40, v40, v66
 v_add_f32 v41, v41, v67
 v_cvt_pk_bf16_f32 v251, v40, v41
 v_lshlrev_b32 v40, 16, v251
 v_and_b32 v41, s58, v251
 v_add_f32 v120, v120, v40
 v_fmac_f32 v121, v40, v40
 v_add_f32 v120, v120, v41
 v_fmac_f32 v121, v41, v41
 buffer_store_dwordx4 v[248:251], v246, s[40:43], s16 offen sc1
 v_lshlrev_b32 v40, 16, v20
 v_and_b32 v41, s58, v20
 v_lshlrev_b32 v42, 16, v26
 v_and_b32 v43, s58, v26
 v_lshlrev_b32 v44, 16, v32
 v_and_b32 v45, s58, v32
 v_lshlrev_b32 v46, 16, v38
 v_and_b32 v47, s58, v38
 v_add_f32 v40, v40, v42
 v_add_f32 v41, v41, v43
 v_add_f32 v44, v44, v46
 v_add_f32 v45, v45, v47
 v_cvt_pk_bf16_f32 v48, v40, v41
 v_cvt_pk_bf16_f32 v49, v44, v45
 v_lshlrev_b32 v40, 16, v48
 v_and_b32 v41, s58, v48
 v_lshlrev_b32 v44, 16, v49
 v_and_b32 v45, s58, v49
 v_sub_f32 v40, v40, v44
 v_sub_f32 v41, v41, v45
 v_cvt_pk_bf16_f32 v48, v40, v41
 v_lshlrev_b32 v40, 16, v48
 v_and_b32 v41, s58, v48
 v_add_f32 v40, v40, v68
 v_add_f32 v41, v41, v69
 v_cvt_pk_bf16_f32 v252, v40, v41
 v_lshlrev_b32 v40, 16, v252
 v_and_b32 v41, s58, v252
 v_add_f32 v120, v120, v40
 v_fmac_f32 v121, v40, v40
 v_add_f32 v120, v120, v41
 v_fmac_f32 v121, v41, v41
 v_lshlrev_b32 v40, 16, v21
 v_and_b32 v41, s58, v21
 v_lshlrev_b32 v42, 16, v27
 v_and_b32 v43, s58, v27
 v_lshlrev_b32 v44, 16, v33
 v_and_b32 v45, s58, v33
 v_lshlrev_b32 v46, 16, v39
 v_and_b32 v47, s58, v39
 v_add_f32 v40, v40, v42
 v_add_f32 v41, v41, v43
 v_add_f32 v44, v44, v46
 v_add_f32 v45, v45, v47
 v_cvt_pk_bf16_f32 v48, v40, v41
 v_cvt_pk_bf16_f32 v49, v44, v45
 v_lshlrev_b32 v40, 16, v48
 v_and_b32 v41, s58, v48
 v_lshlrev_b32 v44, 16, v49
 v_and_b32 v45, s58, v49
 v_sub_f32 v40, v40, v44
 v_sub_f32 v41, v41, v45
 v_cvt_pk_bf16_f32 v48, v40, v41
 v_lshlrev_b32 v40, 16, v48
 v_and_b32 v41, s58, v48
 v_add_f32 v40, v40, v70
 v_add_f32 v41, v41, v71
 v_cvt_pk_bf16_f32 v253, v40, v41
 v_lshlrev_b32 v40, 16, v253
 v_and_b32 v41, s58, v253
 v_add_f32 v120, v120, v40
 v_fmac_f32 v121, v40, v40
 v_add_f32 v120, v120, v41
 v_fmac_f32 v121, v41, v41
 buffer_store_dwordx2 v[252:253], v247, s[40:43], s17 offen sc1
 v_mov_b32 v44, v120
 v_mov_b32 v45, v121
 s_nop 1
 v_permlane16_swap_b32 v120, v44
 v_permlane16_swap_b32 v121, v45
 s_nop 1
 v_add_f32 v120, v120, v44
 v_add_f32 v121, v121, v45
 v_mov_b32 v44, v120
 v_mov_b32 v45, v121
 s_nop 1
 v_permlane32_swap_b32 v120, v44
 v_permlane32_swap_b32 v121, v45
 s_nop 1
 v_add_f32 v120, v120, v44
 v_add_f32 v121, v121, v45
 s_mov_b64 exec, 0xffff
 buffer_store_dwordx2 v[120:121], v238, s[60:63], s59 offen sc1
 s_mov_b64 exec, -1
 v_mov_b32 v9, s101
 v_mov_b32 v10, 0
 s_waitcnt vmcnt(0)
 s_mov_b64 exec, 1
 buffer_store_dword v9, v10, s[76:79], s67 offen sc1
 s_mov_b64 exec, -1
ks_end:
 s_cmp_eq_u32 s100, 1
 s_cbranch_scc1 mega_p2
 s_cmp_eq_u32 s100, 5
 s_cbranch_scc1 mega_p6
 s_endpgm
.p2align 6
kg_body:
 s_mov_b64 exec, -1
 s_barrier
 s_load_dwordx2 s[18:19], s[0:1], 88
 v_lshrrev_b32 v1, 6, v0
 v_and_b32 v2, 63, v0
 v_readfirstlane_b32 s20, v1
 s_and_b32 s22, s2, 7
 s_lshr_b32 s23, s2, 3
 s_and_b32 s21, s23, 7
 s_lshr_b32 s23, s23, 3
 s_lshl_b32 s22, s22, 2
 s_add_u32 s23, s23, s22
 s_lshl_b32 s21, s21, 3
 s_add_u32 s21, s21, s20
 s_waitcnt lgkmcnt(0)
 s_add_u32 s76, s18, 90517504
 s_addc_u32 s77, s19, 0
 s_and_b32 s77, s77, 0xffff
 s_mov_b32 s78, 524288
 s_mov_b32 s79, 0x00020000
 s_add_u32 s24, s18, 34119680
 s_addc_u32 s25, s19, 0
 s_and_b32 s25, s25, 0xffff
 s_mov_b32 s26, 10911744
 s_mov_b32 s27, 0x00020000
 s_add_u32 s28, s18, s70
 s_addc_u32 s29, s19, 0
 s_and_b32 s29, s29, 0xffff
 s_mov_b32 s30, 2359296
 s_mov_b32 s31, 0x00020000
 s_add_u32 s32, s18, s71
 s_addc_u32 s33, s19, 0
 s_and_b32 s33, s33, 0xffff
 s_mov_b32 s34, 262144
 s_mov_b32 s35, 0x00020000
 s_add_u32 s40, s18, s72
 s_addc_u32 s41, s19, 0
 s_and_b32 s41, s41, 0xffff
 s_mov_b32 s42, 18874368
 s_mov_b32 s43, 0x00020000
 v_lshlrev_b32 v3, 4, v2
 s_mul_i32 s44, s23, 340992
 s_mul_i32 s45, s20, 4608
 s_add_u32 s50, s44, s45
 s_mul_i32 s46, s21, 36864
 s_mul_i32 s52, s20, 1152
 s_add_u32 s51, s44, 331776
 s_add_u32 s51, s51, s52
 v_mov_b32 v4, v3
 v_add_u32 v5, 36864, v3
 v_add_u32 v6, 73728, v3
 v_add_u32 v7, 110592, v3
 v_add_u32 v8, 147456, v3
 v_lshlrev_b32 v1, 2, v2
 s_lshl_b32 s47, s21, 7
 s_add_u32 s47, s47, s64
 s_mov_b32 s3, 0
 s_mov_b64 exec, 4294967295
 s_mov_b32 exec_hi, 0
kg_pl1:
 buffer_load_dword v108, v1, s[76:79], s47 offen sc1
 s_add_u32 s3, s3, 1
 s_waitcnt vmcnt(0)
 v_cmp_ne_u32 vcc, s101, v108
 s_cmp_ge_u32 s3, 0x40000
 s_cbranch_scc1 kg_pl1y
 s_cmp_eq_u64 vcc, 0
 s_cbranch_scc1 kg_pl1y
 s_sleep 3
 s_branch kg_pl1
kg_pl1y:
 s_mov_b64 exec, -1
kg_pl1x:
 s_add_u32 s47, s46, 0
 buffer_load_dwordx4 v[16:19], v3, s[28:31], s47 offen offset:0 sc1
 s_add_u32 s47, s46, 0
 buffer_load_dwordx4 v[20:23], v3, s[28:31], s47 offen offset:1024 sc1
 s_add_u32 s47, s46, 0
 buffer_load_dwordx4 v[24:27], v3, s[28:31], s47 offen offset:2048 sc1
 s_add_u32 s47, s46, 0
 buffer_load_dwordx4 v[28:31], v3, s[28:31], s47 offen offset:3072 sc1
 v_and_b32 v9, 31, v2
 v_lshrrev_b32 v10, 5, v2
 v_lshlrev_b32 v10, 17, v10
 v_lshl_add_u32 v9, v9, 3, v10
 s_lshl_b32 s53, s21, 8
 v_mov_b32 v112, 0
 v_mov_b32 v113, 0
 v_mov_b32 v114, 0
 v_mov_b32 v115, 0
 v_mov_b32 v116, 0
 v_mov_b32 v117, 0
 v_mov_b32 v118, 0
 v_mov_b32 v119, 0
 v_mov_b32 v120, 0
 v_mov_b32 v121, 0
 v_mov_b32 v122, 0
 v_mov_b32 v123, 0
 v_mov_b32 v124, 0
 v_mov_b32 v125, 0
 v_mov_b32 v126, 0
 v_mov_b32 v127, 0
 v_mov_b32 v128, 0
 v_mov_b32 v129, 0
 v_mov_b32 v130, 0
 v_mov_b32 v131, 0
 v_mov_b32 v132, 0
 v_mov_b32 v133, 0
 v_mov_b32 v134, 0
 v_mov_b32 v135, 0
 v_mov_b32 v136, 0
 v_mov_b32 v137, 0
 v_mov_b32 v138, 0
 v_mov_b32 v139, 0
 v_mov_b32 v140, 0
 v_mov_b32 v141, 0
 v_mov_b32 v142, 0
 v_mov_b32 v143, 0
 v_mov_b32 v144, 0
 v_mov_b32 v145, 0
 v_mov_b32 v146, 0
 v_mov_b32 v147, 0
 v_mov_b32 v148, 0
 v_mov_b32 v149, 0
 v_mov_b32 v150, 0
 v_mov_b32 v151, 0
 v_mov_b32 v152, 0
 v_mov_b32 v153, 0
 v_mov_b32 v154, 0
 v_mov_b32 v155, 0
 v_mov_b32 v156, 0
 v_mov_b32 v157, 0
 v_mov_b32 v158, 0
 v_mov_b32 v159, 0
 v_mov_b32 v160, 0
 v_mov_b32 v161, 0
 v_mov_b32 v162, 0
 v_mov_b32 v163, 0
 v_mov_b32 v164, 0
 v_mov_b32 v165, 0
 v_mov_b32 v166, 0
 v_mov_b32 v167, 0
 v_mov_b32 v168, 0
 v_mov_b32 v169, 0
 v_mov_b32 v170, 0
 v_mov_b32 v171, 0
 v_mov_b32 v172, 0
 v_mov_b32 v173, 0
 v_mov_b32 v174, 0
 v_mov_b32 v175, 0
 v_mov_b32 v176, 0
 v_mov_b32 v177, 0
 v_mov_b32 v178, 0
 v_mov_b32 v179, 0
 v_mov_b32 v180, 0
 v_mov_b32 v181, 0
 v_mov_b32 v182, 0
 v_mov_b32 v183, 0
 v_mov_b32 v184, 0
 v_mov_b32 v185, 0
 v_mov_b32 v186, 0
 v_mov_b32 v187, 0
 v_mov_b32 v188, 0
 v_mov_b32 v189, 0
 v_mov_b32 v190, 0
 v_mov_b32 v191, 0
 v_mov_b32 v192, 0
 v_mov_b32 v193, 0
 v_mov_b32 v194, 0
 v_mov_b32 v195, 0
 v_mov_b32 v196, 0
 v_mov_b32 v197, 0
 v_mov_b32 v198, 0
 v_mov_b32 v199, 0
 v_mov_b32 v200, 0
 v_mov_b32 v201, 0
 v_mov_b32 v202, 0
 v_mov_b32 v203, 0
 v_mov_b32 v204, 0
 v_mov_b32 v205, 0
 v_mov_b32 v206, 0
 v_mov_b32 v207, 0
 v_mov_b32 v208, 0
 v_mov_b32 v209, 0
 v_mov_b32 v210, 0
 v_mov_b32 v211, 0
 v_mov_b32 v212, 0
 v_mov_b32 v213, 0
 v_mov_b32 v214, 0
 v_mov_b32 v215, 0
 v_mov_b32 v216, 0
 v_mov_b32 v217, 0
 v_mov_b32 v218, 0
 v_mov_b32 v219, 0
 v_mov_b32 v220, 0
 v_mov_b32 v221, 0
 v_mov_b32 v222, 0
 v_mov_b32 v223, 0
 v_mov_b32 v224, 0
 v_mov_b32 v225, 0
 v_mov_b32 v226, 0
 v_mov_b32 v227, 0
 v_mov_b32 v228, 0
 v_mov_b32 v229, 0
 v_mov_b32 v230, 0
 v_mov_b32 v231, 0
 v_mov_b32 v232, 0
 v_mov_b32 v233, 0
 v_mov_b32 v234, 0
 v_mov_b32 v235, 0
 v_mov_b32 v236, 0
 v_mov_b32 v237, 0
 v_mov_b32 v238, 0
 v_mov_b32 v239, 0
 v_mov_b32 v240, 0
 v_mov_b32 v241, 0
 v_mov_b32 v242, 0
 v_mov_b32 v243, 0
 v_mov_b32 v244, 0
 v_mov_b32 v245, 0
 v_mov_b32 v246, 0
 v_mov_b32 v247, 0
 v_mov_b32 v248, 0
 v_mov_b32 v249, 0
 v_mov_b32 v250, 0
 v_mov_b32 v251, 0
 v_mov_b32 v252, 0
 v_mov_b32 v253, 0
 v_mov_b32 v254, 0
 v_mov_b32 v255, 0
 s_barrier
 s_mul_i32 s48, s21, 294912
 s_mul_i32 s49, s23, 9216
 s_add_u32 s48, s48, s49
 ds_read_b128 v[80:83], v6 offset:0
 ds_read_b128 v[84:87], v6 offset:1024
 ds_read_b128 v[88:91], v6 offset:2048
 ds_read_b128 v[92:95], v6 offset:3072
 ds_read_b128 v[96:99], v6 offset:4096
 s_waitcnt vmcnt(0)
 s_waitcnt lgkmcnt(4)
 v_mfma_f32_32x32x16_bf16 v[112:127], v[80:83], v[16:19], v[112:127]
 s_add_u32 s47, s46, 4096
 buffer_load_dwordx4 v[32:35], v3, s[28:31], s47 offen offset:0 sc1
 ds_read_b128 v[100:103], v6 offset:5120
 s_waitcnt lgkmcnt(4)
 v_mfma_f32_32x32x16_bf16 v[128:143], v[84:87], v[16:19], v[128:143]
 s_add_u32 s47, s46, 4096
 buffer_load_dwordx4 v[36:39], v3, s[28:31], s47 offen offset:1024 sc1
 ds_read_b128 v[80:83], v6 offset:6144
 s_waitcnt lgkmcnt(4)
 v_mfma_f32_32x32x16_bf16 v[144:159], v[88:91], v[16:19], v[144:159]
 s_add_u32 s47, s46, 4096
 buffer_load_dwordx4 v[40:43], v3, s[28:31], s47 offen offset:2048 sc1
 ds_read_b128 v[84:87], v6 offset:7168
 s_waitcnt lgkmcnt(4)
 v_mfma_f32_32x32x16_bf16 v[160:175], v[92:95], v[16:19], v[160:175]
 s_add_u32 s47, s46, 4096
 buffer_load_dwordx4 v[44:47], v3, s[28:31], s47 offen offset:3072 sc1
 ds_read_b128 v[88:91], v6 offset:8192
 s_waitcnt lgkmcnt(4)
 v_mfma_f32_32x32x16_bf16 v[176:191], v[96:99], v[16:19], v[176:191]
 s_add_u32 m0, s45, 0
 s_add_u32 s47, s50, 73728
 buffer_load_dwordx4 v3, s[24:27], s47 offen offset:0 sc1 lds
 ds_read_b128 v[92:95], v6 offset:9216
 s_waitcnt lgkmcnt(4)
 v_mfma_f32_32x32x16_bf16 v[192:207], v[100:103], v[16:19], v[192:207]
 s_add_u32 m0, s45, 0
 s_add_u32 s47, s50, 73728
 buffer_load_dwordx4 v3, s[24:27], s47 offen offset:1024 sc1 lds
 ds_read_b128 v[96:99], v6 offset:10240
 s_waitcnt lgkmcnt(4)
 v_mfma_f32_32x32x16_bf16 v[208:223], v[80:83], v[16:19], v[208:223]
 s_add_u32 m0, s45, 0
 s_add_u32 s47, s50, 73728
 buffer_load_dwordx4 v3, s[24:27], s47 offen offset:2048 sc1 lds
 ds_read_b128 v[100:103], v6 offset:11264
 s_waitcnt lgkmcnt(4)
 v_mfma_f32_32x32x16_bf16 v[224:239], v[84:87], v[16:19], v[224:239]
 s_add_u32 m0, s45, 0
 s_add_u32 s47, s50, 73728
 buffer_load_dwordx4 v3, s[24:27], s47 offen offset:3072 sc1 lds
 ds_read_b128 v[80:83], v6 offset:12288
 s_waitcnt lgkmcnt(4)
 v_mfma_f32_32x32x16_bf16 v[240:255], v[88:91], v[16:19], v[240:255]
 s_add_u32 m0, s45, 4096
 s_add_u32 s47, s50, 77824
 s_mov_b32 exec_hi, 0
 buffer_load_dwordx4 v3, s[24:27], s47 offen sc1 lds
 s_mov_b64 exec, -1
 ds_read_b128 v[84:87], v6 offset:13312
 s_waitcnt lgkmcnt(4)
 v_mfma_f32_32x32x16_bf16 v[112:127], v[92:95], v[20:23], v[112:127]
 s_add_u32 s57, s53, 0
 buffer_load_dwordx2 v[64:65], v9, s[32:35], s57 offen sc1
 ds_read_b128 v[88:91], v6 offset:14336
 s_waitcnt lgkmcnt(4)
 v_mfma_f32_32x32x16_bf16 v[128:143], v[96:99], v[20:23], v[128:143]
 s_add_u32 s57, s53, 16384
 buffer_load_dwordx2 v[66:67], v9, s[32:35], s57 offen sc1
 ds_read_b128 v[92:95], v6 offset:15360
 s_waitcnt lgkmcnt(4)
 v_mfma_f32_32x32x16_bf16 v[144:159], v[100:103], v[20:23], v[144:159]
 s_add_u32 s57, s53, 32768
 buffer_load_dwordx2 v[68:69], v9, s[32:35], s57 offen sc1
 ds_read_b128 v[96:99], v6 offset:16384
 s_waitcnt lgkmcnt(4)
 v_mfma_f32_32x32x16_bf16 v[160:175], v[80:83], v[20:23], v[160:175]
 s_add_u32 s57, s53, 49152
 buffer_load_dwordx2 v[70:71], v9, s[32:35], s57 offen sc1
 ds_read_b128 v[100:103], v6 offset:17408
 s_waitcnt lgkmcnt(4)
 v_mfma_f32_32x32x16_bf16 v[176:191], v[84:87], v[20:23], v[176:191]
 s_add_u32 s57, s53, 65536
 buffer_load_dwordx2 v[72:73], v9, s[32:35], s57 offen sc1
 ds_read_b128 v[80:83], v6 offset:18432
 s_waitcnt lgkmcnt(4)
 v_mfma_f32_32x32x16_bf16 v[192:207], v[88:91], v[20:23], v[192:207]
 s_add_u32 s57, s53, 81920
 buffer_load_dwordx2 v[74:75], v9, s[32:35], s57 offen sc1
 ds_read_b128 v[84:87], v6 offset:19456
 s_waitcnt lgkmcnt(4)
 v_mfma_f32_32x32x16_bf16 v[208:223], v[92:95], v[20:23], v[208:223]
 s_add_u32 s57, s53, 98304
 buffer_load_dwordx2 v[76:77], v9, s[32:35], s57 offen sc1
 ds_read_b128 v[88:91], v6 offset:20480
 s_waitcnt lgkmcnt(4)
 v_mfma_f32_32x32x16_bf16 v[224:239], v[96:99], v[20:23], v[224:239]
 s_add_u32 s57, s53, 114688
 buffer_load_dwordx2 v[78:79], v9, s[32:35], s57 offen sc1
 ds_read_b128 v[92:95], v6 offset:21504
 s_waitcnt lgkmcnt(4)
 v_mfma_f32_32x32x16_bf16 v[240:255], v[100:103], v[20:23], v[240:255]
 s_add_u32 s47, s46, 8192
 buffer_load_dwordx4 v[48:51], v3, s[28:31], s47 offen offset:0 sc1
 ds_read_b128 v[96:99], v6 offset:22528
 s_waitcnt lgkmcnt(4)
 v_mfma_f32_32x32x16_bf16 v[112:127], v[80:83], v[24:27], v[112:127]
 s_add_u32 s47, s46, 8192
 buffer_load_dwordx4 v[52:55], v3, s[28:31], s47 offen offset:1024 sc1
 ds_read_b128 v[100:103], v6 offset:23552
 s_waitcnt lgkmcnt(4)
 v_mfma_f32_32x32x16_bf16 v[128:143], v[84:87], v[24:27], v[128:143]
 s_add_u32 s47, s46, 8192
 buffer_load_dwordx4 v[56:59], v3, s[28:31], s47 offen offset:2048 sc1
 ds_read_b128 v[80:83], v6 offset:24576
 s_waitcnt lgkmcnt(4)
 v_mfma_f32_32x32x16_bf16 v[144:159], v[88:91], v[24:27], v[144:159]
 s_add_u32 s47, s46, 8192
 buffer_load_dwordx4 v[60:63], v3, s[28:31], s47 offen offset:3072 sc1
 ds_read_b128 v[84:87], v6 offset:25600
 s_waitcnt lgkmcnt(4)
 v_mfma_f32_32x32x16_bf16 v[160:175], v[92:95], v[24:27], v[160:175]
 s_add_u32 m0, s45, 36864
 s_add_u32 s47, s50, 110592
 buffer_load_dwordx4 v3, s[24:27], s47 offen offset:0 sc1 lds
 ds_read_b128 v[88:91], v6 offset:26624
 s_waitcnt lgkmcnt(4)
 v_mfma_f32_32x32x16_bf16 v[176:191], v[96:99], v[24:27], v[176:191]
 s_add_u32 m0, s45, 36864
 s_add_u32 s47, s50, 110592
 buffer_load_dwordx4 v3, s[24:27], s47 offen offset:1024 sc1 lds
 ds_read_b128 v[92:95], v6 offset:27648
 s_waitcnt lgkmcnt(4)
 v_mfma_f32_32x32x16_bf16 v[192:207], v[100:103], v[24:27], v[192:207]
 s_add_u32 m0, s45, 36864
 s_add_u32 s47, s50, 110592
 buffer_load_dwordx4 v3, s[24:27], s47 offen offset:2048 sc1 lds
 ds_read_b128 v[96:99], v6 offset:28672
 s_waitcnt lgkmcnt(4)
 v_mfma_f32_32x32x16_bf16 v[208:223], v[80:83], v[24:27], v[208:223]
 s_add_u32 m0, s45, 36864
 s_add_u32 s47, s50, 110592
 buffer_load_dwordx4 v3, s[24:27], s47 offen offset:3072 sc1 lds
 ds_read_b128 v[100:103], v6 offset:29696
 s_waitcnt lgkmcnt(4)
 v_mfma_f32_32x32x16_bf16 v[224:239], v[84:87], v[24:27], v[224:239]
 s_add_u32 m0, s45, 40960
 s_add_u32 s47, s50, 114688
 s_mov_b32 exec_hi, 0
 buffer_load_dwordx4 v3, s[24:27], s47 offen sc1 lds
 s_mov_b64 exec, -1
 ds_read_b128 v[80:83], v6 offset:30720
 s_waitcnt lgkmcnt(4)
 v_mfma_f32_32x32x16_bf16 v[240:255], v[88:91], v[24:27], v[240:255]
 s_add_u32 m0, s52, 147456
 s_nop 0
 buffer_load_dwordx4 v3, s[24:27], s51 offen sc1 lds
 ds_read_b128 v[84:87], v6 offset:31744
 s_waitcnt lgkmcnt(4)
 v_mfma_f32_32x32x16_bf16 v[112:127], v[92:95], v[28:31], v[112:127]
 s_add_u32 m0, s52, 147456
 s_mov_b64 exec, 0xff
 buffer_load_dwordx4 v3, s[24:27], s51 offen offset:1024 sc1 lds
 s_mov_b64 exec, -1
 ds_read_b128 v[88:91], v6 offset:32768
 s_waitcnt lgkmcnt(4)
 v_mfma_f32_32x32x16_bf16 v[128:143], v[96:99], v[28:31], v[128:143]
 ds_read_b128 v[92:95], v6 offset:33792
 s_waitcnt lgkmcnt(4)
 v_mfma_f32_32x32x16_bf16 v[144:159], v[100:103], v[28:31], v[144:159]
 ds_read_b128 v[96:99], v6 offset:34816
 s_waitcnt lgkmcnt(4)
 v_mfma_f32_32x32x16_bf16 v[160:175], v[80:83], v[28:31], v[160:175]
 ds_read_b128 v[100:103], v6 offset:35840
 s_waitcnt lgkmcnt(4)
 v_mfma_f32_32x32x16_bf16 v[176:191], v[84:87], v[28:31], v[176:191]
 s_barrier
 s_waitcnt vmcnt(11)
 v_add_f32 v64, v64, v66
 v_add_f32 v65, v65, v67
 v_add_f32 v64, v64, v68
 v_add_f32 v65, v65, v69
 v_add_f32 v64, v64, v70
 v_add_f32 v65, v65, v71
 v_add_f32 v64, v64, v72
 v_add_f32 v65, v65, v73
 v_add_f32 v64, v64, v74
 v_add_f32 v65, v65, v75
 v_add_f32 v64, v64, v76
 v_add_f32 v65, v65, v77
 v_add_f32 v64, v64, v78
 v_add_f32 v65, v65, v79
 v_mov_b32 v66, v64
 v_mov_b32 v67, v65
 s_nop 1
 v_permlane32_swap_b32 v64, v66
 v_permlane32_swap_b32 v65, v67
 s_nop 1
 v_add_f32 v64, v64, v66
 v_add_f32 v65, v65, v67
 v_mov_b32 v13, 0x3ae38e39
 v_mul_f32 v14, v64, v13
 v_mul_f32 v15, v65, v13
 v_fma_f32 v15, -v14, v14, v15
 v_max_f32 v15, 0, v15
 v_cvt_pk_bf16_f32 v13, v14, v15
 v_lshlrev_b32 v12, 16, v13
 v_and_b32 v15, 0xffff0000, v13
 v_add_f32 v15, 0x3727c5ac, v15
 v_cvt_pk_bf16_f32 v13, v15, v15
 v_lshlrev_b32 v15, 16, v13
 v_sqrt_f32 v15, v15
 s_nop 0
 v_cvt_pk_bf16_f32 v13, v15, v15
 v_lshlrev_b32 v10, 16, v13
 v_rcp_f32 v11, v10
 v_xor_b32 v12, 0x80000000, v12
 v_mul_f32 v11, 0xbfb8aa3b, v11
 v_lshrrev_b32 v13, 16, v12
 v_or_b32 v14, v12, v13
 v_mov_b32 v104, v14
 v_mov_b32 v105, v13
 v_mov_b32 v106, v14
 v_mov_b32 v107, v13
 ds_read_b128 v[80:83], v7 offset:0
 s_waitcnt lgkmcnt(4)
 v_mfma_f32_32x32x16_bf16 v[192:207], v[88:91], v[28:31], v[192:207]
 s_add_u32 s47, s46, 12288
 buffer_load_dwordx4 v[64:67], v3, s[28:31], s47 offen offset:0 sc1
 ds_read_b128 v[84:87], v7 offset:1024
 s_waitcnt lgkmcnt(4)
 v_mfma_f32_32x32x16_bf16 v[208:223], v[92:95], v[28:31], v[208:223]
 s_add_u32 s47, s46, 12288
 buffer_load_dwordx4 v[68:71], v3, s[28:31], s47 offen offset:1024 sc1
 ds_read_b128 v[88:91], v7 offset:2048
 s_waitcnt lgkmcnt(4)
 v_mfma_f32_32x32x16_bf16 v[224:239], v[96:99], v[28:31], v[224:239]
 s_add_u32 s47, s46, 12288
 buffer_load_dwordx4 v[72:75], v3, s[28:31], s47 offen offset:2048 sc1
 ds_read_b128 v[92:95], v7 offset:3072
 s_waitcnt lgkmcnt(4)
 v_mfma_f32_32x32x16_bf16 v[240:255], v[100:103], v[28:31], v[240:255]
 s_add_u32 s47, s46, 12288
 buffer_load_dwordx4 v[76:79], v3, s[28:31], s47 offen offset:3072 sc1
 ds_read_b128 v[96:99], v7 offset:4096
 s_waitcnt lgkmcnt(4)
 v_mfma_f32_32x32x16_bf16 v[112:127], v[80:83], v[32:35], v[112:127]
 ds_read_b128 v[100:103], v7 offset:5120
 s_waitcnt lgkmcnt(4)
 v_mfma_f32_32x32x16_bf16 v[128:143], v[84:87], v[32:35], v[128:143]
 ds_read_b128 v[80:83], v7 offset:6144
 s_waitcnt lgkmcnt(4)
 v_mfma_f32_32x32x16_bf16 v[144:159], v[88:91], v[32:35], v[144:159]
 ds_read_b128 v[84:87], v7 offset:7168
 s_waitcnt lgkmcnt(4)
 v_mfma_f32_32x32x16_bf16 v[160:175], v[92:95], v[32:35], v[160:175]
 ds_read_b128 v[88:91], v7 offset:8192
 s_waitcnt lgkmcnt(4)
 v_mfma_f32_32x32x16_bf16 v[176:191], v[96:99], v[32:35], v[176:191]
 ds_read_b128 v[92:95], v7 offset:9216
 s_waitcnt lgkmcnt(4)
 v_mfma_f32_32x32x16_bf16 v[192:207], v[100:103], v[32:35], v[192:207]
 ds_read_b128 v[96:99], v7 offset:10240
 s_waitcnt lgkmcnt(4)
 v_mfma_f32_32x32x16_bf16 v[208:223], v[80:83], v[32:35], v[208:223]
 ds_read_b128 v[100:103], v7 offset:11264
 s_waitcnt lgkmcnt(4)
 v_mfma_f32_32x32x16_bf16 v[224:239], v[84:87], v[32:35], v[224:239]
 ds_read_b128 v[80:83], v7 offset:12288
 s_waitcnt lgkmcnt(4)
 v_mfma_f32_32x32x16_bf16 v[240:255], v[88:91], v[32:35], v[240:255]
 ds_read_b128 v[84:87], v7 offset:13312
 s_waitcnt lgkmcnt(4)
 v_mfma_f32_32x32x16_bf16 v[112:127], v[92:95], v[36:39], v[112:127]
 ds_read_b128 v[88:91], v7 offset:14336
 s_waitcnt lgkmcnt(4)
 v_mfma_f32_32x32x16_bf16 v[128:143], v[96:99], v[36:39], v[128:143]
 ds_read_b128 v[92:95], v7 offset:15360
 s_waitcnt lgkmcnt(4)
 v_mfma_f32_32x32x16_bf16 v[144:159], v[100:103], v[36:39], v[144:159]
 ds_read_b128 v[96:99], v7 offset:16384
 s_waitcnt lgkmcnt(4)
 v_mfma_f32_32x32x16_bf16 v[160:175], v[80:83], v[36:39], v[160:175]
 ds_read_b128 v[100:103], v7 offset:17408
 s_waitcnt lgkmcnt(4)
 v_mfma_f32_32x32x16_bf16 v[176:191], v[84:87], v[36:39], v[176:191]
 ds_read_b128 v[80:83], v7 offset:18432
 s_waitcnt lgkmcnt(4)
 v_mfma_f32_32x32x16_bf16 v[192:207], v[88:91], v[36:39], v[192:207]
 ds_read_b128 v[84:87], v7 offset:19456
 s_waitcnt lgkmcnt(4)
 v_mfma_f32_32x32x16_bf16 v[208:223], v[92:95], v[36:39], v[208:223]
 ds_read_b128 v[88:91], v7 offset:20480
 s_waitcnt lgkmcnt(4)
 v_mfma_f32_32x32x16_bf16 v[224:239], v[96:99], v[36:39], v[224:239]
 ds_read_b128 v[92:95], v7 offset:21504
 s_waitcnt lgkmcnt(4)
 v_mfma_f32_32x32x16_bf16 v[240:255], v[100:103], v[36:39], v[240:255]
 ds_read_b128 v[96:99], v7 offset:22528
 s_waitcnt lgkmcnt(4)
 v_mfma_f32_32x32x16_bf16 v[112:127], v[80:83], v[40:43], v[112:127]
 ds_read_b128 v[100:103], v7 offset:23552
 s_waitcnt lgkmcnt(4)
 v_mfma_f32_32x32x16_bf16 v[128:143], v[84:87], v[40:43], v[128:143]
 ds_read_b128 v[80:83], v7 offset:24576
 s_waitcnt lgkmcnt(4)
 v_mfma_f32_32x32x16_bf16 v[144:159], v[88:91], v[40:43], v[144:159]
 ds_read_b128 v[84:87], v7 offset:25600
 s_waitcnt lgkmcnt(4)
 v_mfma_f32_32x32x16_bf16 v[160:175], v[92:95], v[40:43], v[160:175]
 ds_read_b128 v[88:91], v7 offset:26624
 s_waitcnt lgkmcnt(4)
 v_mfma_f32_32x32x16_bf16 v[176:191], v[96:99], v[40:43], v[176:191]
 ds_read_b128 v[92:95], v7 offset:27648
 s_waitcnt lgkmcnt(4)
 v_mfma_f32_32x32x16_bf16 v[192:207], v[100:103], v[40:43], v[192:207]
 ds_read_b128 v[96:99], v7 offset:28672
 s_waitcnt lgkmcnt(4)
 v_mfma_f32_32x32x16_bf16 v[208:223], v[80:83], v[40:43], v[208:223]
 ds_read_b128 v[100:103], v7 offset:29696
 s_waitcnt lgkmcnt(4)
 v_mfma_f32_32x32x16_bf16 v[224:239], v[84:87], v[40:43], v[224:239]
 ds_read_b128 v[80:83], v7 offset:30720
 s_waitcnt lgkmcnt(4)
 v_mfma_f32_32x32x16_bf16 v[240:255], v[88:91], v[40:43], v[240:255]
 ds_read_b128 v[84:87], v7 offset:31744
 s_waitcnt lgkmcnt(4)
 v_mfma_f32_32x32x16_bf16 v[112:127], v[92:95], v[44:47], v[112:127]
 ds_read_b128 v[88:91], v7 offset:32768
 s_waitcnt lgkmcnt(4)
 v_mfma_f32_32x32x16_bf16 v[128:143], v[96:99], v[44:47], v[128:143]
 ds_read_b128 v[92:95], v7 offset:33792
 s_waitcnt lgkmcnt(4)
 v_mfma_f32_32x32x16_bf16 v[144:159], v[100:103], v[44:47], v[144:159]
 ds_read_b128 v[96:99], v7 offset:34816
 s_waitcnt lgkmcnt(4)
 v_mfma_f32_32x32x16_bf16 v[160:175], v[80:83], v[44:47], v[160:175]
 ds_read_b128 v[100:103], v7 offset:35840
 s_waitcnt lgkmcnt(4)
 v_mfma_f32_32x32x16_bf16 v[176:191], v[84:87], v[44:47], v[176:191]
 s_barrier
 ds_read_b128 v[80:83], v4 offset:0
 s_waitcnt lgkmcnt(4)
 v_mfma_f32_32x32x16_bf16 v[192:207], v[88:91], v[44:47], v[192:207]
 s_add_u32 m0, s45, 73728
 s_add_u32 s47, s50, 147456
 buffer_load_dwordx4 v3, s[24:27], s47 offen offset:0 sc1 lds
 ds_read_b128 v[84:87], v4 offset:1024
 s_waitcnt lgkmcnt(4)
 v_mfma_f32_32x32x16_bf16 v[208:223], v[92:95], v[44:47], v[208:223]
 ds_read_b128 v[88:91], v4 offset:2048
 s_waitcnt lgkmcnt(4)
 v_mfma_f32_32x32x16_bf16 v[224:239], v[96:99], v[44:47], v[224:239]
 ds_read_b128 v[92:95], v4 offset:3072
 s_waitcnt lgkmcnt(4)
 v_mfma_f32_32x32x16_bf16 v[240:255], v[100:103], v[44:47], v[240:255]
 s_add_u32 m0, s45, 73728
 s_add_u32 s47, s50, 147456
 buffer_load_dwordx4 v3, s[24:27], s47 offen offset:1024 sc1 lds
 ds_read_b128 v[96:99], v4 offset:4096
 s_waitcnt vmcnt(13)
 s_waitcnt lgkmcnt(4)
 v_mfma_f32_32x32x16_bf16 v[112:127], v[80:83], v[48:51], v[112:127]
 ds_read_b128 v[100:103], v4 offset:5120
 s_waitcnt lgkmcnt(4)
 v_mfma_f32_32x32x16_bf16 v[128:143], v[84:87], v[48:51], v[128:143]
 ds_read_b128 v[80:83], v4 offset:6144
 s_waitcnt lgkmcnt(4)
 v_mfma_f32_32x32x16_bf16 v[144:159], v[88:91], v[48:51], v[144:159]
 s_add_u32 m0, s45, 73728
 s_add_u32 s47, s50, 147456
 buffer_load_dwordx4 v3, s[24:27], s47 offen offset:2048 sc1 lds
 ds_read_b128 v[84:87], v4 offset:7168
 s_waitcnt lgkmcnt(4)
 v_mfma_f32_32x32x16_bf16 v[160:175], v[92:95], v[48:51], v[160:175]
 ds_read_b128 v[88:91], v4 offset:8192
 s_waitcnt lgkmcnt(4)
 v_mfma_f32_32x32x16_bf16 v[176:191], v[96:99], v[48:51], v[176:191]
 ds_read_b128 v[92:95], v4 offset:9216
 s_waitcnt lgkmcnt(4)
 v_mfma_f32_32x32x16_bf16 v[192:207], v[100:103], v[48:51], v[192:207]
 s_add_u32 m0, s45, 73728
 s_add_u32 s47, s50, 147456
 buffer_load_dwordx4 v3, s[24:27], s47 offen offset:3072 sc1 lds
 ds_read_b128 v[96:99], v4 offset:10240
 s_waitcnt lgkmcnt(4)
 v_mfma_f32_32x32x16_bf16 v[208:223], v[80:83], v[48:51], v[208:223]
 ds_read_b128 v[100:103], v4 offset:11264
 s_waitcnt lgkmcnt(4)
 v_mfma_f32_32x32x16_bf16 v[224:239], v[84:87], v[48:51], v[224:239]
 ds_read_b128 v[80:83], v4 offset:12288
 s_waitcnt lgkmcnt(4)
 v_mfma_f32_32x32x16_bf16 v[240:255], v[88:91], v[48:51], v[240:255]
 s_add_u32 m0, s45, 77824
 s_add_u32 s47, s50, 151552
 s_mov_b32 exec_hi, 0
 buffer_load_dwordx4 v3, s[24:27], s47 offen sc1 lds
 s_mov_b64 exec, -1
 ds_read_b128 v[84:87], v4 offset:13312
 s_waitcnt lgkmcnt(4)
 v_mfma_f32_32x32x16_bf16 v[112:127], v[92:95], v[52:55], v[112:127]
 ds_read_b128 v[88:91], v4 offset:14336
 s_waitcnt lgkmcnt(4)
 v_mfma_f32_32x32x16_bf16 v[128:143], v[96:99], v[52:55], v[128:143]
 ds_read_b128 v[92:95], v4 offset:15360
 s_waitcnt lgkmcnt(4)
 v_mfma_f32_32x32x16_bf16 v[144:159], v[100:103], v[52:55], v[144:159]
 s_add_u32 s47, s46, 16384
 buffer_load_dwordx4 v[16:19], v3, s[28:31], s47 offen offset:0 sc1
 ds_read_b128 v[96:99], v4 offset:16384
 s_waitcnt lgkmcnt(4)
 v_mfma_f32_32x32x16_bf16 v[160:175], v[80:83], v[52:55], v[160:175]
 ds_read_b128 v[100:103], v4 offset:17408
 s_waitcnt lgkmcnt(4)
 v_mfma_f32_32x32x16_bf16 v[176:191], v[84:87], v[52:55], v[176:191]
 ds_read_b128 v[80:83], v4 offset:18432
 s_waitcnt lgkmcnt(4)
 v_mfma_f32_32x32x16_bf16 v[192:207], v[88:91], v[52:55], v[192:207]
 s_add_u32 s47, s46, 16384
 buffer_load_dwordx4 v[20:23], v3, s[28:31], s47 offen offset:1024 sc1
 ds_read_b128 v[84:87], v4 offset:19456
 s_waitcnt lgkmcnt(4)
 v_mfma_f32_32x32x16_bf16 v[208:223], v[92:95], v[52:55], v[208:223]
 ds_read_b128 v[88:91], v4 offset:20480
 s_waitcnt lgkmcnt(4)
 v_mfma_f32_32x32x16_bf16 v[224:239], v[96:99], v[52:55], v[224:239]
 ds_read_b128 v[92:95], v4 offset:21504
 s_waitcnt lgkmcnt(4)
 v_mfma_f32_32x32x16_bf16 v[240:255], v[100:103], v[52:55], v[240:255]
 s_add_u32 s47, s46, 16384
 buffer_load_dwordx4 v[24:27], v3, s[28:31], s47 offen offset:2048 sc1
 ds_read_b128 v[96:99], v4 offset:22528
 s_waitcnt lgkmcnt(4)
 v_mfma_f32_32x32x16_bf16 v[112:127], v[80:83], v[56:59], v[112:127]
 ds_read_b128 v[100:103], v4 offset:23552
 s_waitcnt lgkmcnt(4)
 v_mfma_f32_32x32x16_bf16 v[128:143], v[84:87], v[56:59], v[128:143]
 ds_read_b128 v[80:83], v4 offset:24576
 s_waitcnt lgkmcnt(4)
 v_mfma_f32_32x32x16_bf16 v[144:159], v[88:91], v[56:59], v[144:159]
 s_add_u32 s47, s46, 16384
 buffer_load_dwordx4 v[28:31], v3, s[28:31], s47 offen offset:3072 sc1
 ds_read_b128 v[84:87], v4 offset:25600
 s_waitcnt lgkmcnt(4)
 v_mfma_f32_32x32x16_bf16 v[160:175], v[92:95], v[56:59], v[160:175]
 ds_read_b128 v[88:91], v4 offset:26624
 s_waitcnt lgkmcnt(4)
 v_mfma_f32_32x32x16_bf16 v[176:191], v[96:99], v[56:59], v[176:191]
 ds_read_b128 v[92:95], v4 offset:27648
 s_waitcnt lgkmcnt(4)
 v_mfma_f32_32x32x16_bf16 v[192:207], v[100:103], v[56:59], v[192:207]
 ds_read_b128 v[96:99], v4 offset:28672
 s_waitcnt lgkmcnt(4)
 v_mfma_f32_32x32x16_bf16 v[208:223], v[80:83], v[56:59], v[208:223]
 ds_read_b128 v[100:103], v4 offset:29696
 s_waitcnt lgkmcnt(4)
 v_mfma_f32_32x32x16_bf16 v[224:239], v[84:87], v[56:59], v[224:239]
 ds_read_b128 v[80:83], v4 offset:30720
 s_waitcnt lgkmcnt(4)
 v_mfma_f32_32x32x16_bf16 v[240:255], v[88:91], v[56:59], v[240:255]
 ds_read_b128 v[84:87], v4 offset:31744
 s_waitcnt lgkmcnt(4)
 v_mfma_f32_32x32x16_bf16 v[112:127], v[92:95], v[60:63], v[112:127]
 ds_read_b128 v[88:91], v4 offset:32768
 s_waitcnt lgkmcnt(4)
 v_mfma_f32_32x32x16_bf16 v[128:143], v[96:99], v[60:63], v[128:143]
 ds_read_b128 v[92:95], v4 offset:33792
 s_waitcnt lgkmcnt(4)
 v_mfma_f32_32x32x16_bf16 v[144:159], v[100:103], v[60:63], v[144:159]
 ds_read_b128 v[96:99], v4 offset:34816
 s_waitcnt lgkmcnt(4)
 v_mfma_f32_32x32x16_bf16 v[160:175], v[80:83], v[60:63], v[160:175]
 ds_read_b128 v[100:103], v4 offset:35840
 s_waitcnt lgkmcnt(4)
 v_mfma_f32_32x32x16_bf16 v[176:191], v[84:87], v[60:63], v[176:191]
 s_waitcnt vmcnt(15)
 s_barrier
 ds_read_b128 v[80:83], v5 offset:0
 s_waitcnt lgkmcnt(4)
 v_mfma_f32_32x32x16_bf16 v[192:207], v[88:91], v[60:63], v[192:207]
 s_add_u32 m0, s45, 110592
 s_add_u32 s47, s50, 184320
 buffer_load_dwordx4 v3, s[24:27], s47 offen offset:0 sc1 lds
 ds_read_b128 v[84:87], v5 offset:1024
 s_waitcnt lgkmcnt(4)
 v_mfma_f32_32x32x16_bf16 v[208:223], v[92:95], v[60:63], v[208:223]
 ds_read_b128 v[88:91], v5 offset:2048
 s_waitcnt lgkmcnt(4)
 v_mfma_f32_32x32x16_bf16 v[224:239], v[96:99], v[60:63], v[224:239]
 ds_read_b128 v[92:95], v5 offset:3072
 s_waitcnt lgkmcnt(4)
 v_mfma_f32_32x32x16_bf16 v[240:255], v[100:103], v[60:63], v[240:255]
 s_add_u32 m0, s45, 110592
 s_add_u32 s47, s50, 184320
 buffer_load_dwordx4 v3, s[24:27], s47 offen offset:1024 sc1 lds
 ds_read_b128 v[96:99], v5 offset:4096
 s_waitcnt vmcnt(11)
 s_waitcnt lgkmcnt(4)
 v_mfma_f32_32x32x16_bf16 v[112:127], v[80:83], v[64:67], v[112:127]
 ds_read_b128 v[100:103], v5 offset:5120
 s_waitcnt lgkmcnt(4)
 v_mfma_f32_32x32x16_bf16 v[128:143], v[84:87], v[64:67], v[128:143]
 ds_read_b128 v[80:83], v5 offset:6144
 s_waitcnt lgkmcnt(4)
 v_mfma_f32_32x32x16_bf16 v[144:159], v[88:91], v[64:67], v[144:159]
 s_add_u32 m0, s45, 110592
 s_add_u32 s47, s50, 184320
 buffer_load_dwordx4 v3, s[24:27], s47 offen offset:2048 sc1 lds
 ds_read_b128 v[84:87], v5 offset:7168
 s_waitcnt lgkmcnt(4)
 v_mfma_f32_32x32x16_bf16 v[160:175], v[92:95], v[64:67], v[160:175]
 ds_read_b128 v[88:91], v5 offset:8192
 s_waitcnt lgkmcnt(4)
 v_mfma_f32_32x32x16_bf16 v[176:191], v[96:99], v[64:67], v[176:191]
 ds_read_b128 v[92:95], v5 offset:9216
 s_waitcnt lgkmcnt(4)
 v_mfma_f32_32x32x16_bf16 v[192:207], v[100:103], v[64:67], v[192:207]
 s_add_u32 m0, s45, 110592
 s_add_u32 s47, s50, 184320
 buffer_load_dwordx4 v3, s[24:27], s47 offen offset:3072 sc1 lds
 ds_read_b128 v[96:99], v5 offset:10240
 s_waitcnt lgkmcnt(4)
 v_mfma_f32_32x32x16_bf16 v[208:223], v[80:83], v[64:67], v[208:223]
 ds_read_b128 v[100:103], v5 offset:11264
 s_waitcnt lgkmcnt(4)
 v_mfma_f32_32x32x16_bf16 v[224:239], v[84:87], v[64:67], v[224:239]
 ds_read_b128 v[80:83], v5 offset:12288
 s_waitcnt lgkmcnt(4)
 v_mfma_f32_32x32x16_bf16 v[240:255], v[88:91], v[64:67], v[240:255]
 s_add_u32 m0, s45, 114688
 s_add_u32 s47, s50, 188416
 s_mov_b32 exec_hi, 0
 buffer_load_dwordx4 v3, s[24:27], s47 offen sc1 lds
 s_mov_b64 exec, -1
 ds_read_b128 v[84:87], v5 offset:13312
 s_waitcnt lgkmcnt(4)
 v_mfma_f32_32x32x16_bf16 v[112:127], v[92:95], v[68:71], v[112:127]
 ds_read_b128 v[88:91], v5 offset:14336
 s_waitcnt lgkmcnt(4)
 v_mfma_f32_32x32x16_bf16 v[128:143], v[96:99], v[68:71], v[128:143]
 ds_read_b128 v[92:95], v5 offset:15360
 s_waitcnt lgkmcnt(4)
 v_mfma_f32_32x32x16_bf16 v[144:159], v[100:103], v[68:71], v[144:159]
 s_add_u32 s47, s46, 20480
 buffer_load_dwordx4 v[32:35], v3, s[28:31], s47 offen offset:0 sc1
 ds_read_b128 v[96:99], v5 offset:16384
 s_waitcnt lgkmcnt(4)
 v_mfma_f32_32x32x16_bf16 v[160:175], v[80:83], v[68:71], v[160:175]
 ds_read_b128 v[100:103], v5 offset:17408
 s_waitcnt lgkmcnt(4)
 v_mfma_f32_32x32x16_bf16 v[176:191], v[84:87], v[68:71], v[176:191]
 ds_read_b128 v[80:83], v5 offset:18432
 s_waitcnt lgkmcnt(4)
 v_mfma_f32_32x32x16_bf16 v[192:207], v[88:91], v[68:71], v[192:207]
 s_add_u32 s47, s46, 20480
 buffer_load_dwordx4 v[36:39], v3, s[28:31], s47 offen offset:1024 sc1
 ds_read_b128 v[84:87], v5 offset:19456
 s_waitcnt lgkmcnt(4)
 v_mfma_f32_32x32x16_bf16 v[208:223], v[92:95], v[68:71], v[208:223]
 ds_read_b128 v[88:91], v5 offset:20480
 s_waitcnt lgkmcnt(4)
 v_mfma_f32_32x32x16_bf16 v[224:239], v[96:99], v[68:71], v[224:239]
 ds_read_b128 v[92:95], v5 offset:21504
 s_waitcnt lgkmcnt(4)
 v_mfma_f32_32x32x16_bf16 v[240:255], v[100:103], v[68:71], v[240:255]
 s_add_u32 s47, s46, 20480
 buffer_load_dwordx4 v[40:43], v3, s[28:31], s47 offen offset:2048 sc1
 ds_read_b128 v[96:99], v5 offset:22528
 s_waitcnt lgkmcnt(4)
 v_mfma_f32_32x32x16_bf16 v[112:127], v[80:83], v[72:75], v[112:127]
 ds_read_b128 v[100:103], v5 offset:23552
 s_waitcnt lgkmcnt(4)
 v_mfma_f32_32x32x16_bf16 v[128:143], v[84:87], v[72:75], v[128:143]
 ds_read_b128 v[80:83], v5 offset:24576
 s_waitcnt lgkmcnt(4)
 v_mfma_f32_32x32x16_bf16 v[144:159], v[88:91], v[72:75], v[144:159]
 s_add_u32 s47, s46, 20480
 buffer_load_dwordx4 v[44:47], v3, s[28:31], s47 offen offset:3072 sc1
 ds_read_b128 v[84:87], v5 offset:25600
 s_waitcnt lgkmcnt(4)
 v_mfma_f32_32x32x16_bf16 v[160:175], v[92:95], v[72:75], v[160:175]
 ds_read_b128 v[88:91], v5 offset:26624
 s_waitcnt lgkmcnt(4)
 v_mfma_f32_32x32x16_bf16 v[176:191], v[96:99], v[72:75], v[176:191]
 ds_read_b128 v[92:95], v5 offset:27648
 s_waitcnt lgkmcnt(4)
 v_mfma_f32_32x32x16_bf16 v[192:207], v[100:103], v[72:75], v[192:207]
 ds_read_b128 v[96:99], v5 offset:28672
 s_waitcnt lgkmcnt(4)
 v_mfma_f32_32x32x16_bf16 v[208:223], v[80:83], v[72:75], v[208:223]
 ds_read_b128 v[100:103], v5 offset:29696
 s_waitcnt lgkmcnt(4)
 v_mfma_f32_32x32x16_bf16 v[224:239], v[84:87], v[72:75], v[224:239]
 ds_read_b128 v[80:83], v5 offset:30720
 s_waitcnt lgkmcnt(4)
 v_mfma_f32_32x32x16_bf16 v[240:255], v[88:91], v[72:75], v[240:255]
 ds_read_b128 v[84:87], v5 offset:31744
 s_waitcnt lgkmcnt(4)
 v_mfma_f32_32x32x16_bf16 v[112:127], v[92:95], v[76:79], v[112:127]
 ds_read_b128 v[88:91], v5 offset:32768
 s_waitcnt lgkmcnt(4)
 v_mfma_f32_32x32x16_bf16 v[128:143], v[96:99], v[76:79], v[128:143]
 ds_read_b128 v[92:95], v5 offset:33792
 s_waitcnt lgkmcnt(4)
 v_mfma_f32_32x32x16_bf16 v[144:159], v[100:103], v[76:79], v[144:159]
 ds_read_b128 v[96:99], v5 offset:34816
 s_waitcnt lgkmcnt(4)
 v_mfma_f32_32x32x16_bf16 v[160:175], v[80:83], v[76:79], v[160:175]
 ds_read_b128 v[100:103], v5 offset:35840
 s_waitcnt lgkmcnt(4)
 v_mfma_f32_32x32x16_bf16 v[176:191], v[84:87], v[76:79], v[176:191]
 s_waitcnt vmcnt(13)
 s_barrier
 ds_read_b128 v[80:83], v6 offset:0
 s_waitcnt lgkmcnt(4)
 v_mfma_f32_32x32x16_bf16 v[192:207], v[88:91], v[76:79], v[192:207]
 s_add_u32 m0, s45, 0
 s_add_u32 s47, s50, 221184
 buffer_load_dwordx4 v3, s[24:27], s47 offen offset:0 sc1 lds
 ds_read_b128 v[84:87], v6 offset:1024
 s_waitcnt lgkmcnt(4)
 v_mfma_f32_32x32x16_bf16 v[208:223], v[92:95], v[76:79], v[208:223]
 ds_read_b128 v[88:91], v6 offset:2048
 s_waitcnt lgkmcnt(4)
 v_mfma_f32_32x32x16_bf16 v[224:239], v[96:99], v[76:79], v[224:239]
 ds_read_b128 v[92:95], v6 offset:3072
 s_waitcnt lgkmcnt(4)
 v_mfma_f32_32x32x16_bf16 v[240:255], v[100:103], v[76:79], v[240:255]
 s_add_u32 m0, s45, 0
 s_add_u32 s47, s50, 221184
 buffer_load_dwordx4 v3, s[24:27], s47 offen offset:1024 sc1 lds
 ds_read_b128 v[96:99], v6 offset:4096
 s_waitcnt vmcnt(11)
 s_waitcnt lgkmcnt(4)
 v_mfma_f32_32x32x16_bf16 v[112:127], v[80:83], v[16:19], v[112:127]
 ds_read_b128 v[100:103], v6 offset:5120
 s_waitcnt lgkmcnt(4)
 v_mfma_f32_32x32x16_bf16 v[128:143], v[84:87], v[16:19], v[128:143]
 ds_read_b128 v[80:83], v6 offset:6144
 s_waitcnt lgkmcnt(4)
 v_mfma_f32_32x32x16_bf16 v[144:159], v[88:91], v[16:19], v[144:159]
 s_add_u32 m0, s45, 0
 s_add_u32 s47, s50, 221184
 buffer_load_dwordx4 v3, s[24:27], s47 offen offset:2048 sc1 lds
 ds_read_b128 v[84:87], v6 offset:7168
 s_waitcnt lgkmcnt(4)
 v_mfma_f32_32x32x16_bf16 v[160:175], v[92:95], v[16:19], v[160:175]
 ds_read_b128 v[88:91], v6 offset:8192
 s_waitcnt lgkmcnt(4)
 v_mfma_f32_32x32x16_bf16 v[176:191], v[96:99], v[16:19], v[176:191]
 ds_read_b128 v[92:95], v6 offset:9216
 s_waitcnt lgkmcnt(4)
 v_mfma_f32_32x32x16_bf16 v[192:207], v[100:103], v[16:19], v[192:207]
 s_add_u32 m0, s45, 0
 s_add_u32 s47, s50, 221184
 buffer_load_dwordx4 v3, s[24:27], s47 offen offset:3072 sc1 lds
 ds_read_b128 v[96:99], v6 offset:10240
 s_waitcnt lgkmcnt(4)
 v_mfma_f32_32x32x16_bf16 v[208:223], v[80:83], v[16:19], v[208:223]
 ds_read_b128 v[100:103], v6 offset:11264
 s_waitcnt lgkmcnt(4)
 v_mfma_f32_32x32x16_bf16 v[224:239], v[84:87], v[16:19], v[224:239]
 ds_read_b128 v[80:83], v6 offset:12288
 s_waitcnt lgkmcnt(4)
 v_mfma_f32_32x32x16_bf16 v[240:255], v[88:91], v[16:19], v[240:255]
 s_add_u32 m0, s45, 4096
 s_add_u32 s47, s50, 225280
 s_mov_b32 exec_hi, 0
 buffer_load_dwordx4 v3, s[24:27], s47 offen sc1 lds
 s_mov_b64 exec, -1
 ds_read_b128 v[84:87], v6 offset:13312
 s_waitcnt lgkmcnt(4)
 v_mfma_f32_32x32x16_bf16 v[112:127], v[92:95], v[20:23], v[112:127]
 ds_read_b128 v[88:91], v6 offset:14336
 s_waitcnt lgkmcnt(4)
 v_mfma_f32_32x32x16_bf16 v[128:143], v[96:99], v[20:23], v[128:143]
 ds_read_b128 v[92:95], v6 offset:15360
 s_waitcnt lgkmcnt(4)
 v_mfma_f32_32x32x16_bf16 v[144:159], v[100:103], v[20:23], v[144:159]
 s_add_u32 s47, s46, 24576
 buffer_load_dwordx4 v[48:51], v3, s[28:31], s47 offen offset:0 sc1
 ds_read_b128 v[96:99], v6 offset:16384
 s_waitcnt lgkmcnt(4)
 v_mfma_f32_32x32x16_bf16 v[160:175], v[80:83], v[20:23], v[160:175]
 ds_read_b128 v[100:103], v6 offset:17408
 s_waitcnt lgkmcnt(4)
 v_mfma_f32_32x32x16_bf16 v[176:191], v[84:87], v[20:23], v[176:191]
 ds_read_b128 v[80:83], v6 offset:18432
 s_waitcnt lgkmcnt(4)
 v_mfma_f32_32x32x16_bf16 v[192:207], v[88:91], v[20:23], v[192:207]
 s_add_u32 s47, s46, 24576
 buffer_load_dwordx4 v[52:55], v3, s[28:31], s47 offen offset:1024 sc1
 ds_read_b128 v[84:87], v6 offset:19456
 s_waitcnt lgkmcnt(4)
 v_mfma_f32_32x32x16_bf16 v[208:223], v[92:95], v[20:23], v[208:223]
 ds_read_b128 v[88:91], v6 offset:20480
 s_waitcnt lgkmcnt(4)
 v_mfma_f32_32x32x16_bf16 v[224:239], v[96:99], v[20:23], v[224:239]
 ds_read_b128 v[92:95], v6 offset:21504
 s_waitcnt lgkmcnt(4)
 v_mfma_f32_32x32x16_bf16 v[240:255], v[100:103], v[20:23], v[240:255]
 s_add_u32 s47, s46, 24576
 buffer_load_dwordx4 v[56:59], v3, s[28:31], s47 offen offset:2048 sc1
 ds_read_b128 v[96:99], v6 offset:22528
 s_waitcnt lgkmcnt(4)
 v_mfma_f32_32x32x16_bf16 v[112:127], v[80:83], v[24:27], v[112:127]
 ds_read_b128 v[100:103], v6 offset:23552
 s_waitcnt lgkmcnt(4)
 v_mfma_f32_32x32x16_bf16 v[128:143], v[84:87], v[24:27], v[128:143]
 ds_read_b128 v[80:83], v6 offset:24576
 s_waitcnt lgkmcnt(4)
 v_mfma_f32_32x32x16_bf16 v[144:159], v[88:91], v[24:27], v[144:159]
 s_add_u32 s47, s46, 24576
 buffer_load_dwordx4 v[60:63], v3, s[28:31], s47 offen offset:3072 sc1
 ds_read_b128 v[84:87], v6 offset:25600
 s_waitcnt lgkmcnt(4)
 v_mfma_f32_32x32x16_bf16 v[160:175], v[92:95], v[24:27], v[160:175]
 ds_read_b128 v[88:91], v6 offset:26624
 s_waitcnt lgkmcnt(4)
 v_mfma_f32_32x32x16_bf16 v[176:191], v[96:99], v[24:27], v[176:191]
 ds_read_b128 v[92:95], v6 offset:27648
 s_waitcnt lgkmcnt(4)
 v_mfma_f32_32x32x16_bf16 v[192:207], v[100:103], v[24:27], v[192:207]
 ds_read_b128 v[96:99], v6 offset:28672
 s_waitcnt lgkmcnt(4)
 v_mfma_f32_32x32x16_bf16 v[208:223], v[80:83], v[24:27], v[208:223]
 ds_read_b128 v[100:103], v6 offset:29696
 s_waitcnt lgkmcnt(4)
 v_mfma_f32_32x32x16_bf16 v[224:239], v[84:87], v[24:27], v[224:239]
 ds_read_b128 v[80:83], v6 offset:30720
 s_waitcnt lgkmcnt(4)
 v_mfma_f32_32x32x16_bf16 v[240:255], v[88:91], v[24:27], v[240:255]
 ds_read_b128 v[84:87], v6 offset:31744
 s_waitcnt lgkmcnt(4)
 v_mfma_f32_32x32x16_bf16 v[112:127], v[92:95], v[28:31], v[112:127]
 ds_read_b128 v[88:91], v6 offset:32768
 s_waitcnt lgkmcnt(4)
 v_mfma_f32_32x32x16_bf16 v[128:143], v[96:99], v[28:31], v[128:143]
 ds_read_b128 v[92:95], v6 offset:33792
 s_waitcnt lgkmcnt(4)
 v_mfma_f32_32x32x16_bf16 v[144:159], v[100:103], v[28:31], v[144:159]
 ds_read_b128 v[96:99], v6 offset:34816
 s_waitcnt lgkmcnt(4)
 v_mfma_f32_32x32x16_bf16 v[160:175], v[80:83], v[28:31], v[160:175]
 ds_read_b128 v[100:103], v6 offset:35840
 s_waitcnt lgkmcnt(4)
 v_mfma_f32_32x32x16_bf16 v[176:191], v[84:87], v[28:31], v[176:191]
 s_waitcnt vmcnt(13)
 s_barrier
 ds_read_b128 v[80:83], v7 offset:0
 s_waitcnt lgkmcnt(4)
 v_mfma_f32_32x32x16_bf16 v[192:207], v[88:91], v[28:31], v[192:207]
 s_add_u32 m0, s45, 36864
 s_add_u32 s47, s50, 258048
 buffer_load_dwordx4 v3, s[24:27], s47 offen offset:0 sc1 lds
 ds_read_b128 v[84:87], v7 offset:1024
 s_waitcnt lgkmcnt(4)
 v_mfma_f32_32x32x16_bf16 v[208:223], v[92:95], v[28:31], v[208:223]
 ds_read_b128 v[88:91], v7 offset:2048
 s_waitcnt lgkmcnt(4)
 v_mfma_f32_32x32x16_bf16 v[224:239], v[96:99], v[28:31], v[224:239]
 ds_read_b128 v[92:95], v7 offset:3072
 s_waitcnt lgkmcnt(4)
 v_mfma_f32_32x32x16_bf16 v[240:255], v[100:103], v[28:31], v[240:255]
 s_add_u32 m0, s45, 36864
 s_add_u32 s47, s50, 258048
 buffer_load_dwordx4 v3, s[24:27], s47 offen offset:1024 sc1 lds
 ds_read_b128 v[96:99], v7 offset:4096
 s_waitcnt vmcnt(11)
 s_waitcnt lgkmcnt(4)
 v_mfma_f32_32x32x16_bf16 v[112:127], v[80:83], v[32:35], v[112:127]
 ds_read_b128 v[100:103], v7 offset:5120
 s_waitcnt lgkmcnt(4)
 v_mfma_f32_32x32x16_bf16 v[128:143], v[84:87], v[32:35], v[128:143]
 ds_read_b128 v[80:83], v7 offset:6144
 s_waitcnt lgkmcnt(4)
 v_mfma_f32_32x32x16_bf16 v[144:159], v[88:91], v[32:35], v[144:159]
 s_add_u32 m0, s45, 36864
 s_add_u32 s47, s50, 258048
 buffer_load_dwordx4 v3, s[24:27], s47 offen offset:2048 sc1 lds
 ds_read_b128 v[84:87], v7 offset:7168
 s_waitcnt lgkmcnt(4)
 v_mfma_f32_32x32x16_bf16 v[160:175], v[92:95], v[32:35], v[160:175]
 ds_read_b128 v[88:91], v7 offset:8192
 s_waitcnt lgkmcnt(4)
 v_mfma_f32_32x32x16_bf16 v[176:191], v[96:99], v[32:35], v[176:191]
 ds_read_b128 v[92:95], v7 offset:9216
 s_waitcnt lgkmcnt(4)
 v_mfma_f32_32x32x16_bf16 v[192:207], v[100:103], v[32:35], v[192:207]
 s_add_u32 m0, s45, 36864
 s_add_u32 s47, s50, 258048
 buffer_load_dwordx4 v3, s[24:27], s47 offen offset:3072 sc1 lds
 ds_read_b128 v[96:99], v7 offset:10240
 s_waitcnt lgkmcnt(4)
 v_mfma_f32_32x32x16_bf16 v[208:223], v[80:83], v[32:35], v[208:223]
 ds_read_b128 v[100:103], v7 offset:11264
 s_waitcnt lgkmcnt(4)
 v_mfma_f32_32x32x16_bf16 v[224:239], v[84:87], v[32:35], v[224:239]
 ds_read_b128 v[80:83], v7 offset:12288
 s_waitcnt lgkmcnt(4)
 v_mfma_f32_32x32x16_bf16 v[240:255], v[88:91], v[32:35], v[240:255]
 s_add_u32 m0, s45, 40960
 s_add_u32 s47, s50, 262144
 s_mov_b32 exec_hi, 0
 buffer_load_dwordx4 v3, s[24:27], s47 offen sc1 lds
 s_mov_b64 exec, -1
 ds_read_b128 v[84:87], v7 offset:13312
 s_waitcnt lgkmcnt(4)
 v_mfma_f32_32x32x16_bf16 v[112:127], v[92:95], v[36:39], v[112:127]
 ds_read_b128 v[88:91], v7 offset:14336
 s_waitcnt lgkmcnt(4)
 v_mfma_f32_32x32x16_bf16 v[128:143], v[96:99], v[36:39], v[128:143]
 ds_read_b128 v[92:95], v7 offset:15360
 s_waitcnt lgkmcnt(4)
 v_mfma_f32_32x32x16_bf16 v[144:159], v[100:103], v[36:39], v[144:159]
 s_add_u32 s47, s46, 28672
 buffer_load_dwordx4 v[64:67], v3, s[28:31], s47 offen offset:0 sc1
 ds_read_b128 v[96:99], v7 offset:16384
 s_waitcnt lgkmcnt(4)
 v_mfma_f32_32x32x16_bf16 v[160:175], v[80:83], v[36:39], v[160:175]
 ds_read_b128 v[100:103], v7 offset:17408
 s_waitcnt lgkmcnt(4)
 v_mfma_f32_32x32x16_bf16 v[176:191], v[84:87], v[36:39], v[176:191]
 ds_read_b128 v[80:83], v7 offset:18432
 s_waitcnt lgkmcnt(4)
 v_mfma_f32_32x32x16_bf16 v[192:207], v[88:91], v[36:39], v[192:207]
 s_add_u32 s47, s46, 28672
 buffer_load_dwordx4 v[68:71], v3, s[28:31], s47 offen offset:1024 sc1
 ds_read_b128 v[84:87], v7 offset:19456
 s_waitcnt lgkmcnt(4)
 v_mfma_f32_32x32x16_bf16 v[208:223], v[92:95], v[36:39], v[208:223]
 ds_read_b128 v[88:91], v7 offset:20480
 s_waitcnt lgkmcnt(4)
 v_mfma_f32_32x32x16_bf16 v[224:239], v[96:99], v[36:39], v[224:239]
 ds_read_b128 v[92:95], v7 offset:21504
 s_waitcnt lgkmcnt(4)
 v_mfma_f32_32x32x16_bf16 v[240:255], v[100:103], v[36:39], v[240:255]
 s_add_u32 s47, s46, 28672
 buffer_load_dwordx4 v[72:75], v3, s[28:31], s47 offen offset:2048 sc1
 ds_read_b128 v[96:99], v7 offset:22528
 s_waitcnt lgkmcnt(4)
 v_mfma_f32_32x32x16_bf16 v[112:127], v[80:83], v[40:43], v[112:127]
 ds_read_b128 v[100:103], v7 offset:23552
 s_waitcnt lgkmcnt(4)
 v_mfma_f32_32x32x16_bf16 v[128:143], v[84:87], v[40:43], v[128:143]
 ds_read_b128 v[80:83], v7 offset:24576
 s_waitcnt lgkmcnt(4)
 v_mfma_f32_32x32x16_bf16 v[144:159], v[88:91], v[40:43], v[144:159]
 s_add_u32 s47, s46, 28672
 buffer_load_dwordx4 v[76:79], v3, s[28:31], s47 offen offset:3072 sc1
 ds_read_b128 v[84:87], v7 offset:25600
 s_waitcnt lgkmcnt(4)
 v_mfma_f32_32x32x16_bf16 v[160:175], v[92:95], v[40:43], v[160:175]
 ds_read_b128 v[88:91], v7 offset:26624
 s_waitcnt lgkmcnt(4)
 v_mfma_f32_32x32x16_bf16 v[176:191], v[96:99], v[40:43], v[176:191]
 ds_read_b128 v[92:95], v7 offset:27648
 s_waitcnt lgkmcnt(4)
 v_mfma_f32_32x32x16_bf16 v[192:207], v[100:103], v[40:43], v[192:207]
 ds_read_b128 v[96:99], v7 offset:28672
 s_waitcnt lgkmcnt(4)
 v_mfma_f32_32x32x16_bf16 v[208:223], v[80:83], v[40:43], v[208:223]
 ds_read_b128 v[100:103], v7 offset:29696
 s_waitcnt lgkmcnt(4)
 v_mfma_f32_32x32x16_bf16 v[224:239], v[84:87], v[40:43], v[224:239]
 ds_read_b128 v[80:83], v7 offset:30720
 s_waitcnt lgkmcnt(4)
 v_mfma_f32_32x32x16_bf16 v[240:255], v[88:91], v[40:43], v[240:255]
 ds_read_b128 v[84:87], v7 offset:31744
 s_waitcnt lgkmcnt(4)
 v_mfma_f32_32x32x16_bf16 v[112:127], v[92:95], v[44:47], v[112:127]
 ds_read_b128 v[88:91], v7 offset:32768
 s_waitcnt lgkmcnt(4)
 v_mfma_f32_32x32x16_bf16 v[128:143], v[96:99], v[44:47], v[128:143]
 ds_read_b128 v[92:95], v7 offset:33792
 s_waitcnt lgkmcnt(4)
 v_mfma_f32_32x32x16_bf16 v[144:159], v[100:103], v[44:47], v[144:159]
 ds_read_b128 v[96:99], v7 offset:34816
 s_waitcnt lgkmcnt(4)
 v_mfma_f32_32x32x16_bf16 v[160:175], v[80:83], v[44:47], v[160:175]
 ds_read_b128 v[100:103], v7 offset:35840
 s_waitcnt lgkmcnt(4)
 v_mfma_f32_32x32x16_bf16 v[176:191], v[84:87], v[44:47], v[176:191]
 s_waitcnt vmcnt(13)
 s_barrier
 ds_read_b128 v[80:83], v4 offset:0
 s_waitcnt lgkmcnt(4)
 v_mfma_f32_32x32x16_bf16 v[192:207], v[88:91], v[44:47], v[192:207]
 s_add_u32 m0, s45, 73728
 s_add_u32 s47, s50, 294912
 buffer_load_dwordx4 v3, s[24:27], s47 offen offset:0 sc1 lds
 ds_read_b128 v[84:87], v4 offset:1024
 s_waitcnt lgkmcnt(4)
 v_mfma_f32_32x32x16_bf16 v[208:223], v[92:95], v[44:47], v[208:223]
 ds_read_b128 v[88:91], v4 offset:2048
 s_waitcnt lgkmcnt(4)
 v_mfma_f32_32x32x16_bf16 v[224:239], v[96:99], v[44:47], v[224:239]
 ds_read_b128 v[92:95], v4 offset:3072
 s_waitcnt lgkmcnt(4)
 v_mfma_f32_32x32x16_bf16 v[240:255], v[100:103], v[44:47], v[240:255]
 s_add_u32 m0, s45, 73728
 s_add_u32 s47, s50, 294912
 buffer_load_dwordx4 v3, s[24:27], s47 offen offset:1024 sc1 lds
 ds_read_b128 v[96:99], v4 offset:4096
 s_waitcnt vmcnt(11)
 s_waitcnt lgkmcnt(4)
 v_mfma_f32_32x32x16_bf16 v[112:127], v[80:83], v[48:51], v[112:127]
 ds_read_b128 v[100:103], v4 offset:5120
 s_waitcnt lgkmcnt(4)
 v_mfma_f32_32x32x16_bf16 v[128:143], v[84:87], v[48:51], v[128:143]
 ds_read_b128 v[80:83], v4 offset:6144
 s_waitcnt lgkmcnt(4)
 v_mfma_f32_32x32x16_bf16 v[144:159], v[88:91], v[48:51], v[144:159]
 s_add_u32 m0, s45, 73728
 s_add_u32 s47, s50, 294912
 buffer_load_dwordx4 v3, s[24:27], s47 offen offset:2048 sc1 lds
 ds_read_b128 v[84:87], v4 offset:7168
 s_waitcnt lgkmcnt(4)
 v_mfma_f32_32x32x16_bf16 v[160:175], v[92:95], v[48:51], v[160:175]
 ds_read_b128 v[88:91], v4 offset:8192
 s_waitcnt lgkmcnt(4)
 v_mfma_f32_32x32x16_bf16 v[176:191], v[96:99], v[48:51], v[176:191]
 ds_read_b128 v[92:95], v4 offset:9216
 s_waitcnt lgkmcnt(4)
 v_mfma_f32_32x32x16_bf16 v[192:207], v[100:103], v[48:51], v[192:207]
 s_add_u32 m0, s45, 73728
 s_add_u32 s47, s50, 294912
 buffer_load_dwordx4 v3, s[24:27], s47 offen offset:3072 sc1 lds
 ds_read_b128 v[96:99], v4 offset:10240
 s_waitcnt lgkmcnt(4)
 v_mfma_f32_32x32x16_bf16 v[208:223], v[80:83], v[48:51], v[208:223]
 ds_read_b128 v[100:103], v4 offset:11264
 s_waitcnt lgkmcnt(4)
 v_mfma_f32_32x32x16_bf16 v[224:239], v[84:87], v[48:51], v[224:239]
 ds_read_b128 v[80:83], v4 offset:12288
 s_waitcnt lgkmcnt(4)
 v_mfma_f32_32x32x16_bf16 v[240:255], v[88:91], v[48:51], v[240:255]
 s_add_u32 m0, s45, 77824
 s_add_u32 s47, s50, 299008
 s_mov_b32 exec_hi, 0
 buffer_load_dwordx4 v3, s[24:27], s47 offen sc1 lds
 s_mov_b64 exec, -1
 ds_read_b128 v[84:87], v4 offset:13312
 s_waitcnt lgkmcnt(4)
 v_mfma_f32_32x32x16_bf16 v[112:127], v[92:95], v[52:55], v[112:127]
 ds_read_b128 v[88:91], v4 offset:14336
 s_waitcnt lgkmcnt(4)
 v_mfma_f32_32x32x16_bf16 v[128:143], v[96:99], v[52:55], v[128:143]
 ds_read_b128 v[92:95], v4 offset:15360
 s_waitcnt lgkmcnt(4)
 v_mfma_f32_32x32x16_bf16 v[144:159], v[100:103], v[52:55], v[144:159]
 s_add_u32 s47, s46, 32768
 buffer_load_dwordx4 v[16:19], v3, s[28:31], s47 offen offset:0 sc1
 ds_read_b128 v[96:99], v4 offset:16384
 s_waitcnt lgkmcnt(4)
 v_mfma_f32_32x32x16_bf16 v[160:175], v[80:83], v[52:55], v[160:175]
 ds_read_b128 v[100:103], v4 offset:17408
 s_waitcnt lgkmcnt(4)
 v_mfma_f32_32x32x16_bf16 v[176:191], v[84:87], v[52:55], v[176:191]
 ds_read_b128 v[80:83], v4 offset:18432
 s_waitcnt lgkmcnt(4)
 v_mfma_f32_32x32x16_bf16 v[192:207], v[88:91], v[52:55], v[192:207]
 s_add_u32 s47, s46, 32768
 buffer_load_dwordx4 v[20:23], v3, s[28:31], s47 offen offset:1024 sc1
 ds_read_b128 v[84:87], v4 offset:19456
 s_waitcnt lgkmcnt(4)
 v_mfma_f32_32x32x16_bf16 v[208:223], v[92:95], v[52:55], v[208:223]
 ds_read_b128 v[88:91], v4 offset:20480
 s_waitcnt lgkmcnt(4)
 v_mfma_f32_32x32x16_bf16 v[224:239], v[96:99], v[52:55], v[224:239]
 ds_read_b128 v[92:95], v4 offset:21504
 s_waitcnt lgkmcnt(4)
 v_mfma_f32_32x32x16_bf16 v[240:255], v[100:103], v[52:55], v[240:255]
 s_add_u32 s47, s46, 32768
 buffer_load_dwordx4 v[24:27], v3, s[28:31], s47 offen offset:2048 sc1
 ds_read_b128 v[96:99], v4 offset:22528
 s_waitcnt lgkmcnt(4)
 v_mfma_f32_32x32x16_bf16 v[112:127], v[80:83], v[56:59], v[112:127]
 ds_read_b128 v[100:103], v4 offset:23552
 s_waitcnt lgkmcnt(4)
 v_mfma_f32_32x32x16_bf16 v[128:143], v[84:87], v[56:59], v[128:143]
 ds_read_b128 v[80:83], v4 offset:24576
 s_waitcnt lgkmcnt(4)
 v_mfma_f32_32x32x16_bf16 v[144:159], v[88:91], v[56:59], v[144:159]
 s_add_u32 s47, s46, 32768
 buffer_load_dwordx4 v[28:31], v3, s[28:31], s47 offen offset:3072 sc1
 ds_read_b128 v[84:87], v4 offset:25600
 s_waitcnt lgkmcnt(4)
 v_mfma_f32_32x32x16_bf16 v[160:175], v[92:95], v[56:59], v[160:175]
 ds_read_b128 v[88:91], v4 offset:26624
 s_waitcnt lgkmcnt(4)
 v_mfma_f32_32x32x16_bf16 v[176:191], v[96:99], v[56:59], v[176:191]
 ds_read_b128 v[92:95], v4 offset:27648
 s_waitcnt lgkmcnt(4)
 v_mfma_f32_32x32x16_bf16 v[192:207], v[100:103], v[56:59], v[192:207]
 ds_read_b128 v[96:99], v4 offset:28672
 s_waitcnt lgkmcnt(4)
 v_mfma_f32_32x32x16_bf16 v[208:223], v[80:83], v[56:59], v[208:223]
 ds_read_b128 v[100:103], v4 offset:29696
 s_waitcnt lgkmcnt(4)
 v_mfma_f32_32x32x16_bf16 v[224:239], v[84:87], v[56:59], v[224:239]
 ds_read_b128 v[80:83], v4 offset:30720
 s_waitcnt lgkmcnt(4)
 v_mfma_f32_32x32x16_bf16 v[240:255], v[88:91], v[56:59], v[240:255]
 ds_read_b128 v[84:87], v4 offset:31744
 s_waitcnt lgkmcnt(4)
 v_mfma_f32_32x32x16_bf16 v[112:127], v[92:95], v[60:63], v[112:127]
 ds_read_b128 v[88:91], v4 offset:32768
 s_waitcnt lgkmcnt(4)
 v_mfma_f32_32x32x16_bf16 v[128:143], v[96:99], v[60:63], v[128:143]
 ds_read_b128 v[92:95], v4 offset:33792
 s_waitcnt lgkmcnt(4)
 v_mfma_f32_32x32x16_bf16 v[144:159], v[100:103], v[60:63], v[144:159]
 ds_read_b128 v[96:99], v4 offset:34816
 s_waitcnt lgkmcnt(4)
 v_mfma_f32_32x32x16_bf16 v[160:175], v[80:83], v[60:63], v[160:175]
 ds_read_b128 v[100:103], v4 offset:35840
 s_waitcnt lgkmcnt(4)
 v_mfma_f32_32x32x16_bf16 v[176:191], v[84:87], v[60:63], v[176:191]
 s_waitcnt vmcnt(4)
 s_barrier
 ds_read_b128 v[80:83], v5 offset:0
 s_waitcnt lgkmcnt(4)
 v_mfma_f32_32x32x16_bf16 v[192:207], v[88:91], v[60:63], v[192:207]
 ds_read_b128 v[84:87], v5 offset:9216
 s_waitcnt lgkmcnt(4)
 v_mfma_f32_32x32x16_bf16 v[208:223], v[92:95], v[60:63], v[208:223]
 ds_read_b128 v[88:91], v5 offset:18432
 s_waitcnt lgkmcnt(4)
 v_mfma_f32_32x32x16_bf16 v[224:239], v[96:99], v[60:63], v[224:239]
 ds_read_b128 v[92:95], v5 offset:27648
 s_waitcnt lgkmcnt(4)
 v_mfma_f32_32x32x16_bf16 v[240:255], v[100:103], v[60:63], v[240:255]
 ds_read_b128 v[96:99], v6 offset:0
 s_waitcnt vmcnt(0)
 s_waitcnt lgkmcnt(4)
 v_mfma_f32_32x32x16_bf16 v[112:127], v[80:83], v[64:67], v[112:127]
 ds_read_b128 v[100:103], v6 offset:9216
 s_waitcnt lgkmcnt(4)
 v_mfma_f32_32x32x16_bf16 v[112:127], v[84:87], v[68:71], v[112:127]
 ds_read_b128 v[80:83], v6 offset:18432
 s_waitcnt lgkmcnt(4)
 v_mfma_f32_32x32x16_bf16 v[112:127], v[88:91], v[72:75], v[112:127]
 ds_read_b128 v[84:87], v6 offset:27648
 s_waitcnt lgkmcnt(4)
 v_mfma_f32_32x32x16_bf16 v[112:127], v[92:95], v[76:79], v[112:127]
 ds_read_b128 v[88:91], v8 offset:0
 s_waitcnt lgkmcnt(4)
 v_mfma_f32_32x32x16_bf16 v[112:127], v[96:99], v[16:19], v[112:127]
 ds_read_b128 v[92:95], v5 offset:1024
 s_waitcnt lgkmcnt(4)
 v_mfma_f32_32x32x16_bf16 v[112:127], v[100:103], v[20:23], v[112:127]
 ds_read_b128 v[96:99], v5 offset:10240
 s_waitcnt lgkmcnt(4)
 v_mfma_f32_32x32x16_bf16 v[112:127], v[80:83], v[24:27], v[112:127]
 ds_read_b128 v[100:103], v5 offset:19456
 s_waitcnt lgkmcnt(4)
 v_mfma_f32_32x32x16_bf16 v[112:127], v[84:87], v[28:31], v[112:127]
 ds_read_b128 v[80:83], v5 offset:28672
 s_waitcnt lgkmcnt(4)
 v_mfma_f32_32x32x16_bf16 v[112:127], v[88:91], v[104:107], v[112:127]
 ds_read_b128 v[84:87], v6 offset:1024
 s_waitcnt lgkmcnt(4)
 v_mfma_f32_32x32x16_bf16 v[128:143], v[92:95], v[64:67], v[128:143]
 ds_read_b128 v[88:91], v6 offset:10240
 s_waitcnt lgkmcnt(4)
 v_mfma_f32_32x32x16_bf16 v[128:143], v[96:99], v[68:71], v[128:143]
 ds_read_b128 v[92:95], v6 offset:19456
 s_waitcnt lgkmcnt(4)
 v_mfma_f32_32x32x16_bf16 v[128:143], v[100:103], v[72:75], v[128:143]
 ds_read_b128 v[96:99], v6 offset:28672
 s_waitcnt lgkmcnt(4)
 v_mfma_f32_32x32x16_bf16 v[128:143], v[80:83], v[76:79], v[128:143]
 v_mul_f32 v32, v112, v11
 v_mul_f32 v33, v113, v11
 v_mul_f32 v34, v114, v11
 v_mul_f32 v35, v115, v11
 v_mul_f32 v36, v116, v11
 v_mul_f32 v37, v117, v11
 v_mul_f32 v38, v118, v11
 v_mul_f32 v39, v119, v11
 v_exp_f32 v32, v32
 ds_read_b128 v[100:103], v8 offset:1024
 s_waitcnt lgkmcnt(4)
 v_mfma_f32_32x32x16_bf16 v[128:143], v[84:87], v[16:19], v[128:143]
 v_exp_f32 v33, v33
 v_exp_f32 v34, v34
 v_exp_f32 v35, v35
 v_exp_f32 v36, v36
 v_exp_f32 v37, v37
 v_exp_f32 v38, v38
 v_exp_f32 v39, v39
 v_fma_f32 v32, v32, v10, v10
 v_fma_f32 v33, v33, v10, v10
 ds_read_b128 v[80:83], v5 offset:2048
 s_waitcnt lgkmcnt(4)
 v_mfma_f32_32x32x16_bf16 v[128:143], v[88:91], v[20:23], v[128:143]
 v_fma_f32 v34, v34, v10, v10
 v_fma_f32 v35, v35, v10, v10
 v_fma_f32 v36, v36, v10, v10
 v_fma_f32 v37, v37, v10, v10
 v_fma_f32 v38, v38, v10, v10
 v_fma_f32 v39, v39, v10, v10
 v_rcp_f32 v32, v32
 v_rcp_f32 v33, v33
 v_rcp_f32 v34, v34
 ds_read_b128 v[84:87], v5 offset:11264
 s_waitcnt lgkmcnt(4)
 v_mfma_f32_32x32x16_bf16 v[128:143], v[92:95], v[24:27], v[128:143]
 v_rcp_f32 v35, v35
 v_rcp_f32 v36, v36
 v_rcp_f32 v37, v37
 v_rcp_f32 v38, v38
 v_rcp_f32 v39, v39
 v_mul_f32 v32, v32, v120
 v_mul_f32 v33, v33, v121
 v_mul_f32 v34, v34, v122
 v_mul_f32 v35, v35, v123
 ds_read_b128 v[88:91], v5 offset:20480
 s_waitcnt lgkmcnt(4)
 v_mfma_f32_32x32x16_bf16 v[128:143], v[96:99], v[28:31], v[128:143]
 v_mul_f32 v36, v36, v124
 v_mul_f32 v37, v37, v125
 v_mul_f32 v38, v38, v126
 v_mul_f32 v39, v39, v127
 v_cvt_pk_bf16_f32 v40, v32, v33
 v_cvt_pk_bf16_f32 v41, v34, v35
 v_cvt_pk_bf16_f32 v42, v36, v37
 v_cvt_pk_bf16_f32 v43, v38, v39
 buffer_store_dwordx4 v[40:43], v3, s[40:43], s48 offen sc1
 s_add_u32 s48, s48, 1024
 ds_read_b128 v[92:95], v5 offset:29696
 s_waitcnt lgkmcnt(4)
 v_mfma_f32_32x32x16_bf16 v[128:143], v[100:103], v[104:107], v[128:143]
 ds_read_b128 v[96:99], v6 offset:2048
 s_waitcnt lgkmcnt(4)
 v_mfma_f32_32x32x16_bf16 v[144:159], v[80:83], v[64:67], v[144:159]
 ds_read_b128 v[100:103], v6 offset:11264
 s_waitcnt lgkmcnt(4)
 v_mfma_f32_32x32x16_bf16 v[144:159], v[84:87], v[68:71], v[144:159]
 ds_read_b128 v[80:83], v6 offset:20480
 s_waitcnt lgkmcnt(4)
 v_mfma_f32_32x32x16_bf16 v[144:159], v[88:91], v[72:75], v[144:159]
 ds_read_b128 v[84:87], v6 offset:29696
 s_waitcnt lgkmcnt(4)
 v_mfma_f32_32x32x16_bf16 v[144:159], v[92:95], v[76:79], v[144:159]
 v_mul_f32 v44, v128, v11
 v_mul_f32 v45, v129, v11
 v_mul_f32 v46, v130, v11
 v_mul_f32 v47, v131, v11
 v_mul_f32 v48, v132, v11
 v_mul_f32 v49, v133, v11
 v_mul_f32 v50, v134, v11
 v_mul_f32 v51, v135, v11
 v_exp_f32 v44, v44
 ds_read_b128 v[88:91], v8 offset:2048
 s_waitcnt lgkmcnt(4)
 v_mfma_f32_32x32x16_bf16 v[144:159], v[96:99], v[16:19], v[144:159]
 v_exp_f32 v45, v45
 v_exp_f32 v46, v46
 v_exp_f32 v47, v47
 v_exp_f32 v48, v48
 v_exp_f32 v49, v49
 v_exp_f32 v50, v50
 v_exp_f32 v51, v51
 v_fma_f32 v44, v44, v10, v10
 v_fma_f32 v45, v45, v10, v10
 ds_read_b128 v[92:95], v5 offset:3072
 s_waitcnt lgkmcnt(4)
 v_mfma_f32_32x32x16_bf16 v[144:159], v[100:103], v[20:23], v[144:159]
 v_fma_f32 v46, v46, v10, v10
 v_fma_f32 v47, v47, v10, v10
 v_fma_f32 v48, v48, v10, v10
 v_fma_f32 v49, v49, v10, v10
 v_fma_f32 v50, v50, v10, v10
 v_fma_f32 v51, v51, v10, v10
 v_rcp_f32 v44, v44
 v_rcp_f32 v45, v45
 v_rcp_f32 v46, v46
 ds_read_b128 v[96:99], v5 offset:12288
 s_waitcnt lgkmcnt(4)
 v_mfma_f32_32x32x16_bf16 v[144:159], v[80:83], v[24:27], v[144:159]
 v_rcp_f32 v47, v47
 v_rcp_f32 v48, v48
 v_rcp_f32 v49, v49
 v_rcp_f32 v50, v50
 v_rcp_f32 v51, v51
 v_mul_f32 v44, v44, v136
 v_mul_f32 v45, v45, v137
 v_mul_f32 v46, v46, v138
 v_mul_f32 v47, v47, v139
 ds_read_b128 v[100:103], v5 offset:21504
 s_waitcnt lgkmcnt(4)
 v_mfma_f32_32x32x16_bf16 v[144:159], v[84:87], v[28:31], v[144:159]
 v_mul_f32 v48, v48, v140
 v_mul_f32 v49, v49, v141
 v_mul_f32 v50, v50, v142
 v_mul_f32 v51, v51, v143
 v_cvt_pk_bf16_f32 v52, v44, v45
 v_cvt_pk_bf16_f32 v53, v46, v47
 v_cvt_pk_bf16_f32 v54, v48, v49
 v_cvt_pk_bf16_f32 v55, v50, v51
 buffer_store_dwordx4 v[52:55], v3, s[40:43], s48 offen sc1
 s_add_u32 s48, s48, 1024
 ds_read_b128 v[80:83], v5 offset:30720
 s_waitcnt lgkmcnt(4)
 v_mfma_f32_32x32x16_bf16 v[144:159], v[88:91], v[104:107], v[144:159]
 ds_read_b128 v[84:87], v6 offset:3072
 s_waitcnt lgkmcnt(4)
 v_mfma_f32_32x32x16_bf16 v[160:175], v[92:95], v[64:67], v[160:175]
 ds_read_b128 v[88:91], v6 offset:12288
 s_waitcnt lgkmcnt(4)
 v_mfma_f32_32x32x16_bf16 v[160:175], v[96:99], v[68:71], v[160:175]
 ds_read_b128 v[92:95], v6 offset:21504
 s_waitcnt lgkmcnt(4)
 v_mfma_f32_32x32x16_bf16 v[160:175], v[100:103], v[72:75], v[160:175]
 ds_read_b128 v[96:99], v6 offset:30720
 s_waitcnt lgkmcnt(4)
 v_mfma_f32_32x32x16_bf16 v[160:175], v[80:83], v[76:79], v[160:175]
 v_mul_f32 v32, v144, v11
 v_mul_f32 v33, v145, v11
 v_mul_f32 v34, v146, v11
 v_mul_f32 v35, v147, v11
 v_mul_f32 v36, v148, v11
 v_mul_f32 v37, v149, v11
 v_mul_f32 v38, v150, v11
 v_mul_f32 v39, v151, v11
 v_exp_f32 v32, v32
 ds_read_b128 v[100:103], v8 offset:3072
 s_waitcnt lgkmcnt(4)
 v_mfma_f32_32x32x16_bf16 v[160:175], v[84:87], v[16:19], v[160:175]
 v_exp_f32 v33, v33
 v_exp_f32 v34, v34
 v_exp_f32 v35, v35
 v_exp_f32 v36, v36
 v_exp_f32 v37, v37
 v_exp_f32 v38, v38
 v_exp_f32 v39, v39
 v_fma_f32 v32, v32, v10, v10
 v_fma_f32 v33, v33, v10, v10
 ds_read_b128 v[80:83], v5 offset:4096
 s_waitcnt lgkmcnt(4)
 v_mfma_f32_32x32x16_bf16 v[160:175], v[88:91], v[20:23], v[160:175]
 v_fma_f32 v34, v34, v10, v10
 v_fma_f32 v35, v35, v10, v10
 v_fma_f32 v36, v36, v10, v10
 v_fma_f32 v37, v37, v10, v10
 v_fma_f32 v38, v38, v10, v10
 v_fma_f32 v39, v39, v10, v10
 v_rcp_f32 v32, v32
 v_rcp_f32 v33, v33
 v_rcp_f32 v34, v34
 ds_read_b128 v[84:87], v5 offset:13312
 s_waitcnt lgkmcnt(4)
 v_mfma_f32_32x32x16_bf16 v[160:175], v[92:95], v[24:27], v[160:175]
 v_rcp_f32 v35, v35
 v_rcp_f32 v36, v36
 v_rcp_f32 v37, v37
 v_rcp_f32 v38, v38
 v_rcp_f32 v39, v39
 v_mul_f32 v32, v32, v152
 v_mul_f32 v33, v33, v153
 v_mul_f32 v34, v34, v154
 v_mul_f32 v35, v35, v155
 ds_read_b128 v[88:91], v5 offset:22528
 s_waitcnt lgkmcnt(4)
 v_mfma_f32_32x32x16_bf16 v[160:175], v[96:99], v[28:31], v[160:175]
 v_mul_f32 v36, v36, v156
 v_mul_f32 v37, v37, v157
 v_mul_f32 v38, v38, v158
 v_mul_f32 v39, v39, v159
 v_cvt_pk_bf16_f32 v40, v32, v33
 v_cvt_pk_bf16_f32 v41, v34, v35
 v_cvt_pk_bf16_f32 v42, v36, v37
 v_cvt_pk_bf16_f32 v43, v38, v39
 buffer_store_dwordx4 v[40:43], v3, s[40:43], s48 offen sc1
 s_add_u32 s48, s48, 1024
 ds_read_b128 v[92:95], v5 offset:31744
 s_waitcnt lgkmcnt(4)
 v_mfma_f32_32x32x16_bf16 v[160:175], v[100:103], v[104:107], v[160:175]
 ds_read_b128 v[96:99], v6 offset:4096
 s_waitcnt lgkmcnt(4)
 v_mfma_f32_32x32x16_bf16 v[176:191], v[80:83], v[64:67], v[176:191]
 ds_read_b128 v[100:103], v6 offset:13312
 s_waitcnt lgkmcnt(4)
 v_mfma_f32_32x32x16_bf16 v[176:191], v[84:87], v[68:71], v[176:191]
 ds_read_b128 v[80:83], v6 offset:22528
 s_waitcnt lgkmcnt(4)
 v_mfma_f32_32x32x16_bf16 v[176:191], v[88:91], v[72:75], v[176:191]
 ds_read_b128 v[84:87], v6 offset:31744
 s_waitcnt lgkmcnt(4)
 v_mfma_f32_32x32x16_bf16 v[176:191], v[92:95], v[76:79], v[176:191]
 v_mul_f32 v44, v160, v11
 v_mul_f32 v45, v161, v11
 v_mul_f32 v46, v162, v11
 v_mul_f32 v47, v163, v11
 v_mul_f32 v48, v164, v11
 v_mul_f32 v49, v165, v11
 v_mul_f32 v50, v166, v11
 v_mul_f32 v51, v167, v11
 v_exp_f32 v44, v44
 ds_read_b128 v[88:91], v8 offset:4096
 s_waitcnt lgkmcnt(4)
 v_mfma_f32_32x32x16_bf16 v[176:191], v[96:99], v[16:19], v[176:191]
 v_exp_f32 v45, v45
 v_exp_f32 v46, v46
 v_exp_f32 v47, v47
 v_exp_f32 v48, v48
 v_exp_f32 v49, v49
 v_exp_f32 v50, v50
 v_exp_f32 v51, v51
 v_fma_f32 v44, v44, v10, v10
 v_fma_f32 v45, v45, v10, v10
 ds_read_b128 v[92:95], v5 offset:5120
 s_waitcnt lgkmcnt(4)
 v_mfma_f32_32x32x16_bf16 v[176:191], v[100:103], v[20:23], v[176:191]
 v_fma_f32 v46, v46, v10, v10
 v_fma_f32 v47, v47, v10, v10
 v_fma_f32 v48, v48, v10, v10
 v_fma_f32 v49, v49, v10, v10
 v_fma_f32 v50, v50, v10, v10
 v_fma_f32 v51, v51, v10, v10
 v_rcp_f32 v44, v44
 v_rcp_f32 v45, v45
 v_rcp_f32 v46, v46
 ds_read_b128 v[96:99], v5 offset:14336
 s_waitcnt lgkmcnt(4)
 v_mfma_f32_32x32x16_bf16 v[176:191], v[80:83], v[24:27], v[176:191]
 v_rcp_f32 v47, v47
 v_rcp_f32 v48, v48
 v_rcp_f32 v49, v49
 v_rcp_f32 v50, v50
 v_rcp_f32 v51, v51
 v_mul_f32 v44, v44, v168
 v_mul_f32 v45, v45, v169
 v_mul_f32 v46, v46, v170
 v_mul_f32 v47, v47, v171
 ds_read_b128 v[100:103], v5 offset:23552
 s_waitcnt lgkmcnt(4)
 v_mfma_f32_32x32x16_bf16 v[176:191], v[84:87], v[28:31], v[176:191]
 v_mul_f32 v48, v48, v172
 v_mul_f32 v49, v49, v173
 v_mul_f32 v50, v50, v174
 v_mul_f32 v51, v51, v175
 v_cvt_pk_bf16_f32 v52, v44, v45
 v_cvt_pk_bf16_f32 v53, v46, v47
 v_cvt_pk_bf16_f32 v54, v48, v49
 v_cvt_pk_bf16_f32 v55, v50, v51
 buffer_store_dwordx4 v[52:55], v3, s[40:43], s48 offen sc1
 s_add_u32 s48, s48, 1024
 ds_read_b128 v[80:83], v5 offset:32768
 s_waitcnt lgkmcnt(4)
 v_mfma_f32_32x32x16_bf16 v[176:191], v[88:91], v[104:107], v[176:191]
 ds_read_b128 v[84:87], v6 offset:5120
 s_waitcnt lgkmcnt(4)
 v_mfma_f32_32x32x16_bf16 v[192:207], v[92:95], v[64:67], v[192:207]
 ds_read_b128 v[88:91], v6 offset:14336
 s_waitcnt lgkmcnt(4)
 v_mfma_f32_32x32x16_bf16 v[192:207], v[96:99], v[68:71], v[192:207]
 ds_read_b128 v[92:95], v6 offset:23552
 s_waitcnt lgkmcnt(4)
 v_mfma_f32_32x32x16_bf16 v[192:207], v[100:103], v[72:75], v[192:207]
 ds_read_b128 v[96:99], v6 offset:32768
 s_waitcnt lgkmcnt(4)
 v_mfma_f32_32x32x16_bf16 v[192:207], v[80:83], v[76:79], v[192:207]
 v_mul_f32 v32, v176, v11
 v_mul_f32 v33, v177, v11
 v_mul_f32 v34, v178, v11
 v_mul_f32 v35, v179, v11
 v_mul_f32 v36, v180, v11
 v_mul_f32 v37, v181, v11
 v_mul_f32 v38, v182, v11
 v_mul_f32 v39, v183, v11
 v_exp_f32 v32, v32
 ds_read_b128 v[100:103], v8 offset:5120
 s_waitcnt lgkmcnt(4)
 v_mfma_f32_32x32x16_bf16 v[192:207], v[84:87], v[16:19], v[192:207]
 v_exp_f32 v33, v33
 v_exp_f32 v34, v34
 v_exp_f32 v35, v35
 v_exp_f32 v36, v36
 v_exp_f32 v37, v37
 v_exp_f32 v38, v38
 v_exp_f32 v39, v39
 v_fma_f32 v32, v32, v10, v10
 v_fma_f32 v33, v33, v10, v10
 ds_read_b128 v[80:83], v5 offset:6144
 s_waitcnt lgkmcnt(4)
 v_mfma_f32_32x32x16_bf16 v[192:207], v[88:91], v[20:23], v[192:207]
 v_fma_f32 v34, v34, v10, v10
 v_fma_f32 v35, v35, v10, v10
 v_fma_f32 v36, v36, v10, v10
 v_fma_f32 v37, v37, v10, v10
 v_fma_f32 v38, v38, v10, v10
 v_fma_f32 v39, v39, v10, v10
 v_rcp_f32 v32, v32
 v_rcp_f32 v33, v33
 v_rcp_f32 v34, v34
 ds_read_b128 v[84:87], v5 offset:15360
 s_waitcnt lgkmcnt(4)
 v_mfma_f32_32x32x16_bf16 v[192:207], v[92:95], v[24:27], v[192:207]
 v_rcp_f32 v35, v35
 v_rcp_f32 v36, v36
 v_rcp_f32 v37, v37
 v_rcp_f32 v38, v38
 v_rcp_f32 v39, v39
 v_mul_f32 v32, v32, v184
 v_mul_f32 v33, v33, v185
 v_mul_f32 v34, v34, v186
 v_mul_f32 v35, v35, v187
 ds_read_b128 v[88:91], v5 offset:24576
 s_waitcnt lgkmcnt(4)
 v_mfma_f32_32x32x16_bf16 v[192:207], v[96:99], v[28:31], v[192:207]
 v_mul_f32 v36, v36, v188
 v_mul_f32 v37, v37, v189
 v_mul_f32 v38, v38, v190
 v_mul_f32 v39, v39, v191
 v_cvt_pk_bf16_f32 v40, v32, v33
 v_cvt_pk_bf16_f32 v41, v34, v35
 v_cvt_pk_bf16_f32 v42, v36, v37
 v_cvt_pk_bf16_f32 v43, v38, v39
 buffer_store_dwordx4 v[40:43], v3, s[40:43], s48 offen sc1
 s_add_u32 s48, s48, 1024
 ds_read_b128 v[92:95], v5 offset:33792
 s_waitcnt lgkmcnt(4)
 v_mfma_f32_32x32x16_bf16 v[192:207], v[100:103], v[104:107], v[192:207]
 ds_read_b128 v[96:99], v6 offset:6144
 s_waitcnt lgkmcnt(4)
 v_mfma_f32_32x32x16_bf16 v[208:223], v[80:83], v[64:67], v[208:223]
 ds_read_b128 v[100:103], v6 offset:15360
 s_waitcnt lgkmcnt(4)
 v_mfma_f32_32x32x16_bf16 v[208:223], v[84:87], v[68:71], v[208:223]
 ds_read_b128 v[80:83], v6 offset:24576
 s_waitcnt lgkmcnt(4)
 v_mfma_f32_32x32x16_bf16 v[208:223], v[88:91], v[72:75], v[208:223]
 ds_read_b128 v[84:87], v6 offset:33792
 s_waitcnt lgkmcnt(4)
 v_mfma_f32_32x32x16_bf16 v[208:223], v[92:95], v[76:79], v[208:223]
 v_mul_f32 v44, v192, v11
 v_mul_f32 v45, v193, v11
 v_mul_f32 v46, v194, v11
 v_mul_f32 v47, v195, v11
 v_mul_f32 v48, v196, v11
 v_mul_f32 v49, v197, v11
 v_mul_f32 v50, v198, v11
 v_mul_f32 v51, v199, v11
 v_exp_f32 v44, v44
 ds_read_b128 v[88:91], v8 offset:6144
 s_waitcnt lgkmcnt(4)
 v_mfma_f32_32x32x16_bf16 v[208:223], v[96:99], v[16:19], v[208:223]
 v_exp_f32 v45, v45
 v_exp_f32 v46, v46
 v_exp_f32 v47, v47
 v_exp_f32 v48, v48
 v_exp_f32 v49, v49
 v_exp_f32 v50, v50
 v_exp_f32 v51, v51
 v_fma_f32 v44, v44, v10, v10
 v_fma_f32 v45, v45, v10, v10
 ds_read_b128 v[92:95], v5 offset:7168
 s_waitcnt lgkmcnt(4)
 v_mfma_f32_32x32x16_bf16 v[208:223], v[100:103], v[20:23], v[208:223]
 v_fma_f32 v46, v46, v10, v10
 v_fma_f32 v47, v47, v10, v10
 v_fma_f32 v48, v48, v10, v10
 v_fma_f32 v49, v49, v10, v10
 v_fma_f32 v50, v50, v10, v10
 v_fma_f32 v51, v51, v10, v10
 v_rcp_f32 v44, v44
 v_rcp_f32 v45, v45
 v_rcp_f32 v46, v46
 ds_read_b128 v[96:99], v5 offset:16384
 s_waitcnt lgkmcnt(4)
 v_mfma_f32_32x32x16_bf16 v[208:223], v[80:83], v[24:27], v[208:223]
 v_rcp_f32 v47, v47
 v_rcp_f32 v48, v48
 v_rcp_f32 v49, v49
 v_rcp_f32 v50, v50
 v_rcp_f32 v51, v51
 v_mul_f32 v44, v44, v200
 v_mul_f32 v45, v45, v201
 v_mul_f32 v46, v46, v202
 v_mul_f32 v47, v47, v203
 ds_read_b128 v[100:103], v5 offset:25600
 s_waitcnt lgkmcnt(4)
 v_mfma_f32_32x32x16_bf16 v[208:223], v[84:87], v[28:31], v[208:223]
 v_mul_f32 v48, v48, v204
 v_mul_f32 v49, v49, v205
 v_mul_f32 v50, v50, v206
 v_mul_f32 v51, v51, v207
 v_cvt_pk_bf16_f32 v52, v44, v45
 v_cvt_pk_bf16_f32 v53, v46, v47
 v_cvt_pk_bf16_f32 v54, v48, v49
 v_cvt_pk_bf16_f32 v55, v50, v51
 buffer_store_dwordx4 v[52:55], v3, s[40:43], s48 offen sc1
 s_add_u32 s48, s48, 1024
 ds_read_b128 v[80:83], v5 offset:34816
 s_waitcnt lgkmcnt(4)
 v_mfma_f32_32x32x16_bf16 v[208:223], v[88:91], v[104:107], v[208:223]
 ds_read_b128 v[84:87], v6 offset:7168
 s_waitcnt lgkmcnt(4)
 v_mfma_f32_32x32x16_bf16 v[224:239], v[92:95], v[64:67], v[224:239]
 ds_read_b128 v[88:91], v6 offset:16384
 s_waitcnt lgkmcnt(4)
 v_mfma_f32_32x32x16_bf16 v[224:239], v[96:99], v[68:71], v[224:239]
 ds_read_b128 v[92:95], v6 offset:25600
 s_waitcnt lgkmcnt(4)
 v_mfma_f32_32x32x16_bf16 v[224:239], v[100:103], v[72:75], v[224:239]
 ds_read_b128 v[96:99], v6 offset:34816
 s_waitcnt lgkmcnt(4)
 v_mfma_f32_32x32x16_bf16 v[224:239], v[80:83], v[76:79], v[224:239]
 v_mul_f32 v32, v208, v11
 v_mul_f32 v33, v209, v11
 v_mul_f32 v34, v210, v11
 v_mul_f32 v35, v211, v11
 v_mul_f32 v36, v212, v11
 v_mul_f32 v37, v213, v11
 v_mul_f32 v38, v214, v11
 v_mul_f32 v39, v215, v11
 v_exp_f32 v32, v32
 ds_read_b128 v[100:103], v8 offset:7168
 s_waitcnt lgkmcnt(4)
 v_mfma_f32_32x32x16_bf16 v[224:239], v[84:87], v[16:19], v[224:239]
 v_exp_f32 v33, v33
 v_exp_f32 v34, v34
 v_exp_f32 v35, v35
 v_exp_f32 v36, v36
 v_exp_f32 v37, v37
 v_exp_f32 v38, v38
 v_exp_f32 v39, v39
 v_fma_f32 v32, v32, v10, v10
 v_fma_f32 v33, v33, v10, v10
 ds_read_b128 v[80:83], v5 offset:8192
 s_waitcnt lgkmcnt(4)
 v_mfma_f32_32x32x16_bf16 v[224:239], v[88:91], v[20:23], v[224:239]
 v_fma_f32 v34, v34, v10, v10
 v_fma_f32 v35, v35, v10, v10
 v_fma_f32 v36, v36, v10, v10
 v_fma_f32 v37, v37, v10, v10
 v_fma_f32 v38, v38, v10, v10
 v_fma_f32 v39, v39, v10, v10
 v_rcp_f32 v32, v32
 v_rcp_f32 v33, v33
 v_rcp_f32 v34, v34
 ds_read_b128 v[84:87], v5 offset:17408
 s_waitcnt lgkmcnt(4)
 v_mfma_f32_32x32x16_bf16 v[224:239], v[92:95], v[24:27], v[224:239]
 v_rcp_f32 v35, v35
 v_rcp_f32 v36, v36
 v_rcp_f32 v37, v37
 v_rcp_f32 v38, v38
 v_rcp_f32 v39, v39
 v_mul_f32 v32, v32, v216
 v_mul_f32 v33, v33, v217
 v_mul_f32 v34, v34, v218
 v_mul_f32 v35, v35, v219
 ds_read_b128 v[88:91], v5 offset:26624
 s_waitcnt lgkmcnt(4)
 v_mfma_f32_32x32x16_bf16 v[224:239], v[96:99], v[28:31], v[224:239]
 v_mul_f32 v36, v36, v220
 v_mul_f32 v37, v37, v221
 v_mul_f32 v38, v38, v222
 v_mul_f32 v39, v39, v223
 v_cvt_pk_bf16_f32 v40, v32, v33
 v_cvt_pk_bf16_f32 v41, v34, v35
 v_cvt_pk_bf16_f32 v42, v36, v37
 v_cvt_pk_bf16_f32 v43, v38, v39
 buffer_store_dwordx4 v[40:43], v3, s[40:43], s48 offen sc1
 s_add_u32 s48, s48, 1024
 ds_read_b128 v[92:95], v5 offset:35840
 s_waitcnt lgkmcnt(4)
 v_mfma_f32_32x32x16_bf16 v[224:239], v[100:103], v[104:107], v[224:239]
 ds_read_b128 v[96:99], v6 offset:8192
 s_waitcnt lgkmcnt(4)
 v_mfma_f32_32x32x16_bf16 v[240:255], v[80:83], v[64:67], v[240:255]
 ds_read_b128 v[100:103], v6 offset:17408
 s_waitcnt lgkmcnt(4)
 v_mfma_f32_32x32x16_bf16 v[240:255], v[84:87], v[68:71], v[240:255]
 ds_read_b128 v[80:83], v6 offset:26624
 s_waitcnt lgkmcnt(4)
 v_mfma_f32_32x32x16_bf16 v[240:255], v[88:91], v[72:75], v[240:255]
 ds_read_b128 v[84:87], v6 offset:35840
 s_waitcnt lgkmcnt(4)
 v_mfma_f32_32x32x16_bf16 v[240:255], v[92:95], v[76:79], v[240:255]
 v_mul_f32 v44, v224, v11
 v_mul_f32 v45, v225, v11
 v_mul_f32 v46, v226, v11
 v_mul_f32 v47, v227, v11
 v_mul_f32 v48, v228, v11
 v_mul_f32 v49, v229, v11
 v_mul_f32 v50, v230, v11
 v_mul_f32 v51, v231, v11
 v_exp_f32 v44, v44
 ds_read_b128 v[88:91], v8 offset:8192
 s_waitcnt lgkmcnt(4)
 v_mfma_f32_32x32x16_bf16 v[240:255], v[96:99], v[16:19], v[240:255]
 v_exp_f32 v45, v45
 v_exp_f32 v46, v46
 v_exp_f32 v47, v47
 v_exp_f32 v48, v48
 v_exp_f32 v49, v49
 v_exp_f32 v50, v50
 v_exp_f32 v51, v51
 v_fma_f32 v44, v44, v10, v10
 v_fma_f32 v45, v45, v10, v10
 s_waitcnt lgkmcnt(3)
 v_mfma_f32_32x32x16_bf16 v[240:255], v[100:103], v[20:23], v[240:255]
 v_fma_f32 v46, v46, v10, v10
 v_fma_f32 v47, v47, v10, v10
 v_fma_f32 v48, v48, v10, v10
 v_fma_f32 v49, v49, v10, v10
 v_fma_f32 v50, v50, v10, v10
 v_fma_f32 v51, v51, v10, v10
 v_rcp_f32 v44, v44
 v_rcp_f32 v45, v45
 v_rcp_f32 v46, v46
 s_waitcnt lgkmcnt(2)
 v_mfma_f32_32x32x16_bf16 v[240:255], v[80:83], v[24:27], v[240:255]
 v_rcp_f32 v47, v47
 v_rcp_f32 v48, v48
 v_rcp_f32 v49, v49
 v_rcp_f32 v50, v50
 v_rcp_f32 v51, v51
 v_mul_f32 v44, v44, v232
 v_mul_f32 v45, v45, v233
 v_mul_f32 v46, v46, v234
 v_mul_f32 v47, v47, v235
 s_waitcnt lgkmcnt(1)
 v_mfma_f32_32x32x16_bf16 v[240:255], v[84:87], v[28:31], v[240:255]
 v_mul_f32 v48, v48, v236
 v_mul_f32 v49, v49, v237
 v_mul_f32 v50, v50, v238
 v_mul_f32 v51, v51, v239
 v_cvt_pk_bf16_f32 v52, v44, v45
 v_cvt_pk_bf16_f32 v53, v46, v47
 v_cvt_pk_bf16_f32 v54, v48, v49
 v_cvt_pk_bf16_f32 v55, v50, v51
 buffer_store_dwordx4 v[52:55], v3, s[40:43], s48 offen sc1
 s_add_u32 s48, s48, 1024
 s_waitcnt lgkmcnt(0)
 v_mfma_f32_32x32x16_bf16 v[240:255], v[88:91], v[104:107], v[240:255]
 s_nop 15
 v_mul_f32 v32, v240, v11
 v_mul_f32 v33, v241, v11
 v_mul_f32 v34, v242, v11
 v_mul_f32 v35, v243, v11
 v_mul_f32 v36, v244, v11
 v_mul_f32 v37, v245, v11
 v_mul_f32 v38, v246, v11
 v_mul_f32 v39, v247, v11
 v_exp_f32 v32, v32
 v_exp_f32 v33, v33
 v_exp_f32 v34, v34
 v_exp_f32 v35, v35
 v_exp_f32 v36, v36
 v_exp_f32 v37, v37
 v_exp_f32 v38, v38
 v_exp_f32 v39, v39
 v_fma_f32 v32, v32, v10, v10
 v_fma_f32 v33, v33, v10, v10
 v_fma_f32 v34, v34, v10, v10
 v_fma_f32 v35, v35, v10, v10
 v_fma_f32 v36, v36, v10, v10
 v_fma_f32 v37, v37, v10, v10
 v_fma_f32 v38, v38, v10, v10
 v_fma_f32 v39, v39, v10, v10
 v_rcp_f32 v32, v32
 v_rcp_f32 v33, v33
 v_rcp_f32 v34, v34
 v_rcp_f32 v35, v35
 v_rcp_f32 v36, v36
 v_rcp_f32 v37, v37
 v_rcp_f32 v38, v38
 v_rcp_f32 v39, v39
 v_mul_f32 v32, v32, v248
 v_mul_f32 v33, v33, v249
 v_mul_f32 v34, v34, v250
 v_mul_f32 v35, v35, v251
 v_mul_f32 v36, v36, v252
 v_mul_f32 v37, v37, v253
 v_mul_f32 v38, v38, v254
 v_mul_f32 v39, v39, v255
 v_cvt_pk_bf16_f32 v40, v32, v33
 v_cvt_pk_bf16_f32 v41, v34, v35
 v_cvt_pk_bf16_f32 v42, v36, v37
 v_cvt_pk_bf16_f32 v43, v38, v39
 buffer_store_dwordx4 v[40:43], v3, s[40:43], s48 offen sc1
 s_add_u32 s48, s48, 1024
 s_lshl_b32 s47, s21, 7
 s_lshl_b32 s3, s23, 2
 s_add_u32 s47, s47, s3
 s_add_u32 s47, s47, s65
 s_mov_b64 exec, -1
 v_mov_b32 v1, s101
 v_mov_b32 v9, 0
 s_waitcnt vmcnt(0)
 s_mov_b64 exec, 1
 buffer_store_dword v1, v9, s[76:79], s47 offen sc1
 s_mov_b64 exec, -1
kg_end:
 s_cmp_eq_u32 s100, 2
 s_cbranch_scc1 mega_p3
 s_cmp_eq_u32 s100, 6
 s_cbranch_scc1 mega_p7
 s_endpgm
.p2align 6
kd_body:
 s_mov_b64 exec, -1
 s_barrier
 s_load_dwordx2 s[18:19], s[0:1], 88
 s_load_dwordx4 s[12:15], s[0:1], 72
 v_lshrrev_b32 v1, 6, v0
 v_and_b32 v2, 63, v0
 v_readfirstlane_b32 s20, v1
 s_and_b32 s22, s2, 7
 s_lshr_b32 s23, s2, 3
 s_lshr_b32 s44, s22, 1
 s_and_b32 s21, s22, 1
 s_lshl_b32 s21, s21, 3
 s_and_b32 s45, s23, 7
 s_add_u32 s21, s21, s45
 s_lshr_b32 s23, s23, 3
 s_and_b32 s45, s20, 3
 s_lshr_b32 s46, s20, 2
 s_waitcnt lgkmcnt(0)
 s_add_u32 s24, s18, s68
 s_addc_u32 s25, s19, 0
 s_and_b32 s25, s25, 0xffff
 s_mov_b32 s26, 18874368
 s_mov_b32 s27, 0x00020000
 s_add_u32 s28, s18, 45035520
 s_addc_u32 s29, s19, 0
 s_and_b32 s29, s29, 0xffff
 s_mov_b32 s30, 5308416
 s_mov_b32 s31, 0x00020000
 s_add_u32 s32, s18, s75
 s_addc_u32 s33, s19, 0
 s_and_b32 s33, s33, 0xffff
 s_mov_b32 s34, 9437184
 s_mov_b32 s35, 0x00020000
 s_add_u32 s76, s18, 90517504
 s_addc_u32 s77, s19, 0
 s_and_b32 s77, s77, 0xffff
 s_mov_b32 s78, 524288
 s_mov_b32 s79, 0x00020000
 s_mov_b32 s66, s69
 v_and_b32 v11, 15, v2
 v_lshrrev_b32 v12, 4, v2
 v_mul_u32_u24 v13, 1152, v12
 v_lshl_add_u32 v14, v11, 4, v13
 v_and_b32 v15, 7, v11
 v_lshl_add_u32 v15, v15, 4, v13
 v_add_u32 v15, 1024, v15
 v_lshrrev_b32 v16, 3, v11
 s_mov_b32 s47, 663552
 v_mul_lo_u32 v16, v16, s47
 v_add_u32 v15, v15, v16
 s_lshl_b32 s47, s45, 8
 v_add_u32 v3, s47, v14
 s_mul_i32 s47, s45, 4608
 v_add_u32 v4, s47, v15
 s_lshl_b32 s48, s23, 1
 s_mul_i32 s48, s48, 663552
 s_mul_i32 s47, s44, 18
 s_add_u32 s47, s47, s46
 s_mul_i32 s49, s47, 9216
 s_add_u32 s48, s48, s49
 s_mul_i32 s50, s46, 18432
 s_lshl_b32 s51, s45, 10
 s_add_u32 s50, s50, s51
 s_lshl_b32 s51, s45, 13
 s_add_u32 s5, s50, s51
 s_add_u32 s5, s5, 8192
 s_cmp_lt_u32 s45, 2
 s_cselect_b64 s[52:53], -1, 0
 s_mul_i32 s51, s46, 18432
 v_lshl_add_u32 v8, v2, 4, s51
 v_add_u32 v9, 73728, v8
 s_mov_b32 s4, s47
 v_lshlrev_b32 v1, 2, v2
 s_add_u32 m0, s50, 110592
 s_add_u32 s47, s48, 0
 buffer_load_dwordx4 v3, s[28:31], s47 offen sc1 lds
 s_add_u32 m0, s50, 114688
 s_add_u32 s47, s48, 663552
 buffer_load_dwordx4 v3, s[28:31], s47 offen sc1 lds
 s_add_u32 m0, s50, 119808
 s_add_u32 s47, s48, 4608
 buffer_load_dwordx4 v3, s[28:31], s47 offen sc1 lds
 s_add_u32 m0, s50, 123904
 s_add_u32 s47, s48, 668160
 buffer_load_dwordx4 v3, s[28:31], s47 offen sc1 lds
 s_add_u32 m0, s5, 110592
 s_add_u32 s47, s48, 0
 s_mov_b64 exec, s[52:53]
 buffer_load_dwordx4 v4, s[28:31], s47 offen sc1 lds
 s_mov_b64 exec, -1
 s_add_u32 m0, s50, 0
 s_add_u32 s47, s48, 18432
 buffer_load_dwordx4 v3, s[28:31], s47 offen sc1 lds
 s_add_u32 m0, s50, 4096
 s_add_u32 s47, s48, 681984
 buffer_load_dwordx4 v3, s[28:31], s47 offen sc1 lds
 s_add_u32 m0, s50, 9216
 s_add_u32 s47, s48, 23040
 buffer_load_dwordx4 v3, s[28:31], s47 offen sc1 lds
 s_add_u32 m0, s50, 13312
 s_add_u32 s47, s48, 686592
 buffer_load_dwordx4 v3, s[28:31], s47 offen sc1 lds
 s_add_u32 m0, s5, 0
 s_add_u32 s47, s48, 18432
 s_mov_b64 exec, s[52:53]
 buffer_load_dwordx4 v4, s[28:31], s47 offen sc1 lds
 s_mov_b64 exec, -1
 v_lshlrev_b32 v13, 9, v12
 v_lshl_add_u32 v10, v11, 4, v13
 s_lshl_b32 s51, s21, 2
 s_add_u32 s51, s51, s45
 s_mul_i32 s49, s51, 294912
 s_lshl_b32 s51, s4, 12
 s_add_u32 s49, s49, s51
 s_lshl_b32 s47, s21, 2
 s_add_u32 s47, s47, s45
 s_lshl_b32 s47, s47, 7
 s_lshl_b32 s3, s44, 5
 s_add_u32 s47, s47, s3
 s_add_u32 s47, s47, s64
 s_mov_b32 s3, 0
 s_mov_b64 exec, 255
kd_pl1:
 buffer_load_dword v152, v1, s[76:79], s47 offen sc1
 s_add_u32 s3, s3, 1
 s_waitcnt vmcnt(0)
 v_cmp_ne_u32 vcc, s101, v152
 s_cmp_ge_u32 s3, 0x40000
 s_cbranch_scc1 kd_pl1y
 s_cmp_eq_u64 vcc, 0
 s_cbranch_scc1 kd_pl1y
 s_sleep 3
 s_branch kd_pl1
kd_pl1y:
 s_mov_b64 exec, -1
kd_pl1x:
 s_add_u32 s47, s49, 0
 buffer_load_dwordx4 v[88:91], v10, s[24:27], s47 offen offset:0 sc1
 s_add_u32 s47, s49, 0
 buffer_load_dwordx4 v[92:95], v10, s[24:27], s47 offen offset:256 sc1
 s_add_u32 s47, s49, 0
 buffer_load_dwordx4 v[96:99], v10, s[24:27], s47 offen offset:2048 sc1
 s_add_u32 s47, s49, 0
 buffer_load_dwordx4 v[100:103], v10, s[24:27], s47 offen offset:2304 sc1
 s_add_u32 s47, s49, 8192
 buffer_load_dwordx4 v[104:107], v10, s[24:27], s47 offen offset:0 sc1
 s_add_u32 s47, s49, 8192
 buffer_load_dwordx4 v[108:111], v10, s[24:27], s47 offen offset:256 sc1
 s_add_u32 s47, s49, 8192
 buffer_load_dwordx4 v[112:115], v10, s[24:27], s47 offen offset:2048 sc1
 s_add_u32 s47, s49, 8192
 buffer_load_dwordx4 v[116:119], v10, s[24:27], s47 offen offset:2304 sc1
 v_mov_b32 v160, 0
 v_mov_b32 v161, 0
 v_mov_b32 v162, 0
 v_mov_b32 v163, 0
 v_mov_b32 v164, 0
 v_mov_b32 v165, 0
 v_mov_b32 v166, 0
 v_mov_b32 v167, 0
 v_mov_b32 v168, 0
 v_mov_b32 v169, 0
 v_mov_b32 v170, 0
 v_mov_b32 v171, 0
 v_mov_b32 v172, 0
 v_mov_b32 v173, 0
 v_mov_b32 v174, 0
 v_mov_b32 v175, 0
 v_mov_b32 v176, 0
 v_mov_b32 v177, 0
 v_mov_b32 v178, 0
 v_mov_b32 v179, 0
 v_mov_b32 v180, 0
 v_mov_b32 v181, 0
 v_mov_b32 v182, 0
 v_mov_b32 v183, 0
 v_mov_b32 v184, 0
 v_mov_b32 v185, 0
 v_mov_b32 v186, 0
 v_mov_b32 v187, 0
 v_mov_b32 v188, 0
 v_mov_b32 v189, 0
 v_mov_b32 v190, 0
 v_mov_b32 v191, 0
 v_mov_b32 v192, 0
 v_mov_b32 v193, 0
 v_mov_b32 v194, 0
 v_mov_b32 v195, 0
 v_mov_b32 v196, 0
 v_mov_b32 v197, 0
 v_mov_b32 v198, 0
 v_mov_b32 v199, 0
 v_mov_b32 v200, 0
 v_mov_b32 v201, 0
 v_mov_b32 v202, 0
 v_mov_b32 v203, 0
 v_mov_b32 v204, 0
 v_mov_b32 v205, 0
 v_mov_b32 v206, 0
 v_mov_b32 v207, 0
 v_mov_b32 v208, 0
 v_mov_b32 v209, 0
 v_mov_b32 v210, 0
 v_mov_b32 v211, 0
 v_mov_b32 v212, 0
 v_mov_b32 v213, 0
 v_mov_b32 v214, 0
 v_mov_b32 v215, 0
 v_mov_b32 v216, 0
 v_mov_b32 v217, 0
 v_mov_b32 v218, 0
 v_mov_b32 v219, 0
 v_mov_b32 v220, 0
 v_mov_b32 v221, 0
 v_mov_b32 v222, 0
 v_mov_b32 v223, 0
 v_mov_b32 v224, 0
 v_mov_b32 v225, 0
 v_mov_b32 v226, 0
 v_mov_b32 v227, 0
 v_mov_b32 v228, 0
 v_mov_b32 v229, 0
 v_mov_b32 v230, 0
 v_mov_b32 v231, 0
 s_mul_i32 s51, s20, 9216
 s_add_u32 s51, s51, 0
 v_lshl_add_u32 v232, v2, 4, s51
 s_xor_b32 s51, s20, 4
 s_mul_i32 s51, s51, 9216
 s_add_u32 s51, s51, 0
 v_lshl_add_u32 v233, v2, 4, s51
 s_lshl_b32 s55, s21, 2
 s_add_u32 s55, s55, s23
 s_lshl_b32 s51, s55, 2
 s_add_u32 s51, s51, s44
 s_lshl_b32 s51, s51, 3
 s_lshl_b32 s3, s45, 1
 s_add_u32 s51, s51, s3
 s_add_u32 s51, s51, s46
 s_mul_i32 s75, s51, 4608
 v_lshlrev_b32 v234, 4, v2
 v_lshlrev_b32 v235, 3, v2
 v_add_u32 v235, 4096, v235
 s_add_u32 s36, s18, s70
 s_addc_u32 s37, s19, 0
 s_and_b32 s37, s37, 0xffff
 s_mov_b32 s38, 2359296
 s_mov_b32 s39, 0x00020000
 s_add_u32 s40, s18, s71
 s_addc_u32 s41, s19, 0
 s_and_b32 s41, s41, 0xffff
 s_mov_b32 s42, 2359296
 s_mov_b32 s43, 0x00020000
 s_add_u32 s60, s18, s72
 s_addc_u32 s61, s19, 0
 s_and_b32 s61, s61, 0xffff
 s_mov_b32 s62, 262144
 s_mov_b32 s63, 0x00020000
 s_cmp_lg_u32 s73, 0
 s_cselect_b32 s40, s12, s40
 s_cselect_b32 s41, s13, s41
 s_and_b32 s41, s41, 0xffff
 s_and_b32 s56, s20, 1
 s_lshr_b32 s57, s20, 1
 s_lshl_b32 s58, s21, 2
 s_add_u32 s58, s58, s44
 s_mul_i32 s59, s58, 36864
 s_mul_i32 s3, s23, 9216
 s_add_u32 s59, s59, s3
 s_lshl_b32 s3, s56, 8
 s_add_u32 s59, s59, s3
 s_lshr_b32 s3, s57, 1
 s_mul_i32 s3, s3, 4608
 s_and_b32 s51, s57, 1
 s_lshl_b32 s51, s51, 11
 s_add_u32 s3, s3, s51
 s_add_u32 s68, s59, s3
 v_lshlrev_b32 v236, 9, v12
 v_lshl_add_u32 v236, v11, 4, v236
 v_lshrrev_b32 v237, 1, v12
 v_mul_u32_u24 v237, 4608, v237
 v_and_b32 v238, 1, v12
 v_lshl_add_u32 v237, v238, 3, v237
 v_lshl_add_u32 v237, v11, 4, v237
 v_add_u32 v237, 4096, v237
 s_cmp_eq_u32 s57, 0
 s_cselect_b32 s69, s59, 0x7f000000
 buffer_load_dwordx4 v[248:251], v236, s[36:39], s68 offen sc1
 buffer_load_dwordx2 v[252:253], v237, s[36:39], s69 offen sc1
 s_lshl_b32 s51, s55, 5
 s_lshl_b32 s3, s44, 1
 s_add_u32 s51, s51, s3
 s_add_u32 s51, s51, s56
 s_mul_i32 s51, s51, 4608
 s_lshl_b32 s3, s57, 10
 s_add_u32 s6, s3, s51
 s_cmp_eq_u32 s57, 0
 s_cselect_b32 s7, s51, 0x7f000000
 v_lshrrev_b32 v238, 2, v11
 v_and_b32 v239, 3, v11
 v_lshl_add_u32 v238, v238, 3, v239
 v_mul_u32_u24 v238, 1152, v238
 v_lshl_add_u32 v239, v12, 4, v238
 v_lshrrev_b32 v246, 1, v12
 v_mul_u32_u24 v246, 144, v246
 v_add_u32 v238, v238, v246
 v_and_b32 v246, 1, v12
 v_lshl_add_u32 v238, v246, 3, v238
 v_add_u32 v238, 128, v238
 s_lshl_b32 s51, s58, 5
 s_lshl_b32 s3, s56, 2
 s_add_u32 s51, s51, s3
 s_mul_i32 s51, s51, 1152
 s_mul_i32 s3, s23, 288
 s_add_u32 s51, s51, s3
 s_lshr_b32 s3, s57, 1
 s_mul_i32 s3, s3, 144
 s_and_b32 s16, s57, 1
 s_lshl_b32 s16, s16, 6
 s_add_u32 s3, s3, s16
 s_add_u32 s3, s3, s51
 s_cmp_eq_u32 s57, 0
 s_cselect_b32 s51, s51, 0x7f000000
 s_cmp_lg_u32 s73, 0
 s_cselect_b32 s16, s3, s68
 s_cselect_b32 s17, s51, s69
 s_cselect_b64 vcc, -1, 0
 v_cndmask_b32 v246, v236, v239, vcc
 v_cndmask_b32 v247, v237, v238, vcc
 s_lshl_b32 s51, s23, 2
 s_add_u32 s51, s51, s57
 s_lshl_b32 s51, s51, 14
 s_lshl_b32 s3, s58, 8
 s_add_u32 s51, s51, s3
 s_lshl_b32 s3, s56, 7
 s_add_u32 s51, s51, s3
 s_cmp_lg_u32 s73, 0
 s_cselect_b32 s59, 0x7f000000, s51
 v_lshlrev_b32 v238, 3, v11
 s_lshl_b32 s3, s55, 3
 s_lshl_b32 s51, s44, 1
 s_add_u32 s51, s51, s3
 s_add_u32 s51, s51, s56
 s_lshl_b32 s56, s51, 7
 s_add_u32 s56, s56, s66
 s_lshl_b32 s51, s45, 1
 s_add_u32 s51, s51, s3
 s_add_u32 s51, s51, s46
 s_lshl_b32 s51, s51, 7
 s_lshl_b32 s57, s44, 2
 s_add_u32 s57, s57, s51
 s_add_u32 s57, s57, s66
 s_lshl_b32 s67, s58, 7
 s_lshl_b32 s3, s23, 5
 s_add_u32 s67, s67, s3
 s_lshl_b32 s3, s20, 2
 s_add_u32 s67, s67, s3
 s_add_u32 s67, s67, s65
 s_mov_b32 s58, 0xffff0000
 s_barrier
 ds_read_b128 v[16:19], v9 offset:36864
 ds_read_b128 v[20:23], v9 offset:37888
 ds_read_b128 v[24:27], v9 offset:38912
 ds_read_b128 v[28:31], v9 offset:39936
 ds_read_b128 v[32:35], v9 offset:40960
 ds_read_b128 v[36:39], v9 offset:41984
 ds_read_b128 v[40:43], v9 offset:43008
 ds_read_b128 v[44:47], v9 offset:44032
 ds_read_b128 v[48:51], v9 offset:45056
 s_waitcnt vmcnt(6)
 s_waitcnt lgkmcnt(8)
 v_mfma_f32_16x16x32_bf16 v[160:163], v[16:19], v[88:91], v[160:163]
 s_add_u32 m0, s50, 36864
 s_add_u32 s47, s48, 36864
 buffer_load_dwordx4 v3, s[28:31], s47 offen sc1 lds
 v_mfma_f32_16x16x32_bf16 v[196:199], v[16:19], v[92:95], v[196:199]
 s_add_u32 m0, s50, 40960
 s_add_u32 s47, s48, 700416
 buffer_load_dwordx4 v3, s[28:31], s47 offen sc1 lds
 ds_read_b128 v[52:55], v9 offset:46080
 s_waitcnt lgkmcnt(8)
 v_mfma_f32_16x16x32_bf16 v[164:167], v[20:23], v[88:91], v[164:167]
 s_add_u32 m0, s50, 46080
 s_add_u32 s47, s48, 41472
 buffer_load_dwordx4 v3, s[28:31], s47 offen sc1 lds
 v_mfma_f32_16x16x32_bf16 v[200:203], v[20:23], v[92:95], v[200:203]
 s_add_u32 m0, s50, 50176
 s_add_u32 s47, s48, 705024
 buffer_load_dwordx4 v3, s[28:31], s47 offen sc1 lds
 ds_read_b128 v[56:59], v9 offset:47104
 s_waitcnt lgkmcnt(8)
 v_mfma_f32_16x16x32_bf16 v[168:171], v[24:27], v[88:91], v[168:171]
 s_add_u32 m0, s5, 36864
 s_add_u32 s47, s48, 36864
 s_mov_b64 exec, s[52:53]
 buffer_load_dwordx4 v4, s[28:31], s47 offen sc1 lds
 s_mov_b64 exec, -1
 v_mfma_f32_16x16x32_bf16 v[204:207], v[24:27], v[92:95], v[204:207]
 s_add_u32 m0, s50, 73728
 s_add_u32 s47, s48, 55296
 buffer_load_dwordx4 v3, s[28:31], s47 offen sc1 lds
 ds_read_b128 v[60:63], v9 offset:48128
 s_waitcnt lgkmcnt(8)
 v_mfma_f32_16x16x32_bf16 v[172:175], v[28:31], v[88:91], v[172:175]
 s_add_u32 m0, s50, 77824
 s_add_u32 s47, s48, 718848
 buffer_load_dwordx4 v3, s[28:31], s47 offen sc1 lds
 v_mfma_f32_16x16x32_bf16 v[208:211], v[28:31], v[92:95], v[208:211]
 s_add_u32 m0, s50, 82944
 s_add_u32 s47, s48, 59904
 buffer_load_dwordx4 v3, s[28:31], s47 offen sc1 lds
 ds_read_b128 v[16:19], v9 offset:49152
 s_waitcnt lgkmcnt(8)
 v_mfma_f32_16x16x32_bf16 v[176:179], v[32:35], v[88:91], v[176:179]
 s_add_u32 m0, s50, 87040
 s_add_u32 s47, s48, 723456
 buffer_load_dwordx4 v3, s[28:31], s47 offen sc1 lds
 v_mfma_f32_16x16x32_bf16 v[212:215], v[32:35], v[92:95], v[212:215]
 s_add_u32 m0, s5, 73728
 s_add_u32 s47, s48, 55296
 s_mov_b64 exec, s[52:53]
 buffer_load_dwordx4 v4, s[28:31], s47 offen sc1 lds
 s_mov_b64 exec, -1
 ds_read_b128 v[20:23], v9 offset:50176
 s_waitcnt lgkmcnt(8)
 v_mfma_f32_16x16x32_bf16 v[180:183], v[36:39], v[88:91], v[180:183]
 s_add_u32 s47, s49, 16384
 buffer_load_dwordx4 v[120:123], v10, s[24:27], s47 offen offset:0 sc1
 v_mfma_f32_16x16x32_bf16 v[216:219], v[36:39], v[92:95], v[216:219]
 s_add_u32 s47, s49, 16384
 buffer_load_dwordx4 v[124:127], v10, s[24:27], s47 offen offset:256 sc1
 ds_read_b128 v[24:27], v9 offset:51200
 s_waitcnt lgkmcnt(8)
 v_mfma_f32_16x16x32_bf16 v[184:187], v[40:43], v[88:91], v[184:187]
 s_add_u32 s47, s49, 16384
 buffer_load_dwordx4 v[128:131], v10, s[24:27], s47 offen offset:2048 sc1
 v_mfma_f32_16x16x32_bf16 v[220:223], v[40:43], v[92:95], v[220:223]
 s_add_u32 s47, s49, 16384
 buffer_load_dwordx4 v[132:135], v10, s[24:27], s47 offen offset:2304 sc1
 ds_read_b128 v[28:31], v9 offset:52224
 s_waitcnt lgkmcnt(8)
 v_mfma_f32_16x16x32_bf16 v[188:191], v[44:47], v[88:91], v[188:191]
 v_mfma_f32_16x16x32_bf16 v[224:227], v[44:47], v[92:95], v[224:227]
 ds_read_b128 v[32:35], v9 offset:53248
 s_waitcnt lgkmcnt(8)
 v_mfma_f32_16x16x32_bf16 v[192:195], v[48:51], v[88:91], v[192:195]
 v_mfma_f32_16x16x32_bf16 v[228:231], v[48:51], v[92:95], v[228:231]
 ds_read_b128 v[36:39], v9 offset:54272
 s_waitcnt lgkmcnt(8)
 v_mfma_f32_16x16x32_bf16 v[160:163], v[52:55], v[96:99], v[160:163]
 v_mfma_f32_16x16x32_bf16 v[196:199], v[52:55], v[100:103], v[196:199]
 s_barrier
 ds_read_b128 v[40:43], v8 offset:0
 s_waitcnt lgkmcnt(8)
 v_mfma_f32_16x16x32_bf16 v[164:167], v[56:59], v[96:99], v[164:167]
 s_add_u32 s47, s49, 24576
 buffer_load_dwordx4 v[136:139], v10, s[24:27], s47 offen offset:0 sc1
 v_mfma_f32_16x16x32_bf16 v[200:203], v[56:59], v[100:103], v[200:203]
 s_add_u32 s47, s49, 24576
 buffer_load_dwordx4 v[140:143], v10, s[24:27], s47 offen offset:256 sc1
 ds_read_b128 v[44:47], v8 offset:1024
 s_waitcnt lgkmcnt(8)
 v_mfma_f32_16x16x32_bf16 v[168:171], v[60:63], v[96:99], v[168:171]
 s_add_u32 s47, s49, 24576
 buffer_load_dwordx4 v[144:147], v10, s[24:27], s47 offen offset:2048 sc1
 v_mfma_f32_16x16x32_bf16 v[204:207], v[60:63], v[100:103], v[204:207]
 s_add_u32 s47, s49, 24576
 buffer_load_dwordx4 v[148:151], v10, s[24:27], s47 offen offset:2304 sc1
 ds_read_b128 v[48:51], v8 offset:2048
 s_waitcnt lgkmcnt(8)
 v_mfma_f32_16x16x32_bf16 v[172:175], v[16:19], v[96:99], v[172:175]
 v_mfma_f32_16x16x32_bf16 v[208:211], v[16:19], v[100:103], v[208:211]
 ds_read_b128 v[52:55], v8 offset:3072
 s_waitcnt lgkmcnt(8)
 v_mfma_f32_16x16x32_bf16 v[176:179], v[20:23], v[96:99], v[176:179]
 v_mfma_f32_16x16x32_bf16 v[212:215], v[20:23], v[100:103], v[212:215]
 ds_read_b128 v[56:59], v8 offset:4096
 s_waitcnt lgkmcnt(8)
 v_mfma_f32_16x16x32_bf16 v[180:183], v[24:27], v[96:99], v[180:183]
 v_mfma_f32_16x16x32_bf16 v[216:219], v[24:27], v[100:103], v[216:219]
 ds_read_b128 v[60:63], v8 offset:5120
 s_waitcnt lgkmcnt(8)
 v_mfma_f32_16x16x32_bf16 v[184:187], v[28:31], v[96:99], v[184:187]
 v_mfma_f32_16x16x32_bf16 v[220:223], v[28:31], v[100:103], v[220:223]
 ds_read_b128 v[16:19], v8 offset:6144
 s_waitcnt lgkmcnt(8)
 v_mfma_f32_16x16x32_bf16 v[188:191], v[32:35], v[96:99], v[188:191]
 v_mfma_f32_16x16x32_bf16 v[224:227], v[32:35], v[100:103], v[224:227]
 ds_read_b128 v[20:23], v8 offset:7168
 s_waitcnt lgkmcnt(8)
 v_mfma_f32_16x16x32_bf16 v[192:195], v[36:39], v[96:99], v[192:195]
 v_mfma_f32_16x16x32_bf16 v[228:231], v[36:39], v[100:103], v[228:231]
 ds_read_b128 v[24:27], v8 offset:8192
 s_waitcnt vmcnt(20)
 s_waitcnt lgkmcnt(8)
 v_mfma_f32_16x16x32_bf16 v[160:163], v[40:43], v[104:107], v[160:163]
 v_mfma_f32_16x16x32_bf16 v[196:199], v[40:43], v[108:111], v[196:199]
 ds_read_b128 v[28:31], v8 offset:9216
 s_waitcnt lgkmcnt(8)
 v_mfma_f32_16x16x32_bf16 v[164:167], v[44:47], v[104:107], v[164:167]
 v_mfma_f32_16x16x32_bf16 v[200:203], v[44:47], v[108:111], v[200:203]
 ds_read_b128 v[32:35], v8 offset:10240
 s_waitcnt lgkmcnt(8)
 v_mfma_f32_16x16x32_bf16 v[168:171], v[48:51], v[104:107], v[168:171]
 v_mfma_f32_16x16x32_bf16 v[204:207], v[48:51], v[108:111], v[204:207]
 ds_read_b128 v[36:39], v8 offset:11264
 s_waitcnt lgkmcnt(8)
 v_mfma_f32_16x16x32_bf16 v[172:175], v[52:55], v[104:107], v[172:175]
 v_mfma_f32_16x16x32_bf16 v[208:211], v[52:55], v[108:111], v[208:211]
 ds_read_b128 v[40:43], v8 offset:12288
 s_waitcnt lgkmcnt(8)
 v_mfma_f32_16x16x32_bf16 v[176:179], v[56:59], v[104:107], v[176:179]
 v_mfma_f32_16x16x32_bf16 v[212:215], v[56:59], v[108:111], v[212:215]
 ds_read_b128 v[44:47], v8 offset:13312
 s_waitcnt lgkmcnt(8)
 v_mfma_f32_16x16x32_bf16 v[180:183], v[60:63], v[104:107], v[180:183]
 v_mfma_f32_16x16x32_bf16 v[216:219], v[60:63], v[108:111], v[216:219]
 ds_read_b128 v[48:51], v8 offset:14336
 s_waitcnt lgkmcnt(8)
 v_mfma_f32_16x16x32_bf16 v[184:187], v[16:19], v[104:107], v[184:187]
 v_mfma_f32_16x16x32_bf16 v[220:223], v[16:19], v[108:111], v[220:223]
 ds_read_b128 v[52:55], v8 offset:15360
 s_waitcnt lgkmcnt(8)
 v_mfma_f32_16x16x32_bf16 v[188:191], v[20:23], v[104:107], v[188:191]
 v_mfma_f32_16x16x32_bf16 v[224:227], v[20:23], v[108:111], v[224:227]
 ds_read_b128 v[56:59], v8 offset:16384
 s_waitcnt lgkmcnt(8)
 v_mfma_f32_16x16x32_bf16 v[192:195], v[24:27], v[104:107], v[192:195]
 v_mfma_f32_16x16x32_bf16 v[228:231], v[24:27], v[108:111], v[228:231]
 ds_read_b128 v[60:63], v8 offset:17408
 s_waitcnt lgkmcnt(8)
 v_mfma_f32_16x16x32_bf16 v[160:163], v[28:31], v[112:115], v[160:163]
 v_mfma_f32_16x16x32_bf16 v[196:199], v[28:31], v[116:119], v[196:199]
 s_waitcnt vmcnt(13)
 s_barrier
 ds_read_b128 v[16:19], v8 offset:36864
 s_waitcnt lgkmcnt(8)
 v_mfma_f32_16x16x32_bf16 v[164:167], v[32:35], v[112:115], v[164:167]
 s_add_u32 m0, s50, 110592
 s_add_u32 s47, s48, 73728
 buffer_load_dwordx4 v3, s[28:31], s47 offen sc1 lds
 v_mfma_f32_16x16x32_bf16 v[200:203], v[32:35], v[116:119], v[200:203]
 ds_read_b128 v[20:23], v8 offset:37888
 s_waitcnt lgkmcnt(8)
 v_mfma_f32_16x16x32_bf16 v[168:171], v[36:39], v[112:115], v[168:171]
 v_mfma_f32_16x16x32_bf16 v[204:207], v[36:39], v[116:119], v[204:207]
 s_add_u32 m0, s50, 114688
 s_add_u32 s47, s48, 737280
 buffer_load_dwordx4 v3, s[28:31], s47 offen sc1 lds
 ds_read_b128 v[24:27], v8 offset:38912
 s_waitcnt lgkmcnt(8)
 v_mfma_f32_16x16x32_bf16 v[172:175], v[40:43], v[112:115], v[172:175]
 v_mfma_f32_16x16x32_bf16 v[208:211], v[40:43], v[116:119], v[208:211]
 ds_read_b128 v[28:31], v8 offset:39936
 s_waitcnt lgkmcnt(8)
 v_mfma_f32_16x16x32_bf16 v[176:179], v[44:47], v[112:115], v[176:179]
 s_add_u32 m0, s50, 119808
 s_add_u32 s47, s48, 78336
 buffer_load_dwordx4 v3, s[28:31], s47 offen sc1 lds
 v_mfma_f32_16x16x32_bf16 v[212:215], v[44:47], v[116:119], v[212:215]
 ds_read_b128 v[32:35], v8 offset:40960
 s_waitcnt lgkmcnt(8)
 v_mfma_f32_16x16x32_bf16 v[180:183], v[48:51], v[112:115], v[180:183]
 v_mfma_f32_16x16x32_bf16 v[216:219], v[48:51], v[116:119], v[216:219]
 s_add_u32 m0, s50, 123904
 s_add_u32 s47, s48, 741888
 buffer_load_dwordx4 v3, s[28:31], s47 offen sc1 lds
 ds_read_b128 v[36:39], v8 offset:41984
 s_waitcnt lgkmcnt(8)
 v_mfma_f32_16x16x32_bf16 v[184:187], v[52:55], v[112:115], v[184:187]
 v_mfma_f32_16x16x32_bf16 v[220:223], v[52:55], v[116:119], v[220:223]
 ds_read_b128 v[40:43], v8 offset:43008
 s_waitcnt lgkmcnt(8)
 v_mfma_f32_16x16x32_bf16 v[188:191], v[56:59], v[112:115], v[188:191]
 s_add_u32 m0, s5, 110592
 s_add_u32 s47, s48, 73728
 s_mov_b64 exec, s[52:53]
 buffer_load_dwordx4 v4, s[28:31], s47 offen sc1 lds
 s_mov_b64 exec, -1
 v_mfma_f32_16x16x32_bf16 v[224:227], v[56:59], v[116:119], v[224:227]
 ds_read_b128 v[44:47], v8 offset:44032
 s_waitcnt lgkmcnt(8)
 v_mfma_f32_16x16x32_bf16 v[192:195], v[60:63], v[112:115], v[192:195]
 v_mfma_f32_16x16x32_bf16 v[228:231], v[60:63], v[116:119], v[228:231]
 s_add_u32 s47, s49, 32768
 buffer_load_dwordx4 v[88:91], v10, s[24:27], s47 offen offset:0 sc1
 ds_read_b128 v[48:51], v8 offset:45056
 s_waitcnt vmcnt(10)
 s_waitcnt lgkmcnt(8)
 v_mfma_f32_16x16x32_bf16 v[160:163], v[16:19], v[120:123], v[160:163]
 v_mfma_f32_16x16x32_bf16 v[196:199], v[16:19], v[124:127], v[196:199]
 ds_read_b128 v[52:55], v8 offset:46080
 s_waitcnt lgkmcnt(8)
 v_mfma_f32_16x16x32_bf16 v[164:167], v[20:23], v[120:123], v[164:167]
 s_add_u32 s47, s49, 32768
 buffer_load_dwordx4 v[92:95], v10, s[24:27], s47 offen offset:256 sc1
 v_mfma_f32_16x16x32_bf16 v[200:203], v[20:23], v[124:127], v[200:203]
 ds_read_b128 v[56:59], v8 offset:47104
 s_waitcnt lgkmcnt(8)
 v_mfma_f32_16x16x32_bf16 v[168:171], v[24:27], v[120:123], v[168:171]
 v_mfma_f32_16x16x32_bf16 v[204:207], v[24:27], v[124:127], v[204:207]
 s_add_u32 s47, s49, 32768
 buffer_load_dwordx4 v[96:99], v10, s[24:27], s47 offen offset:2048 sc1
 ds_read_b128 v[60:63], v8 offset:48128
 s_waitcnt lgkmcnt(8)
 v_mfma_f32_16x16x32_bf16 v[172:175], v[28:31], v[120:123], v[172:175]
 v_mfma_f32_16x16x32_bf16 v[208:211], v[28:31], v[124:127], v[208:211]
 ds_read_b128 v[16:19], v8 offset:49152
 s_waitcnt lgkmcnt(8)
 v_mfma_f32_16x16x32_bf16 v[176:179], v[32:35], v[120:123], v[176:179]
 s_add_u32 s47, s49, 32768
 buffer_load_dwordx4 v[100:103], v10, s[24:27], s47 offen offset:2304 sc1
 v_mfma_f32_16x16x32_bf16 v[212:215], v[32:35], v[124:127], v[212:215]
 ds_read_b128 v[20:23], v8 offset:50176
 s_waitcnt lgkmcnt(8)
 v_mfma_f32_16x16x32_bf16 v[180:183], v[36:39], v[120:123], v[180:183]
 v_mfma_f32_16x16x32_bf16 v[216:219], v[36:39], v[124:127], v[216:219]
 ds_read_b128 v[24:27], v8 offset:51200
 s_waitcnt lgkmcnt(8)
 v_mfma_f32_16x16x32_bf16 v[184:187], v[40:43], v[120:123], v[184:187]
 v_mfma_f32_16x16x32_bf16 v[220:223], v[40:43], v[124:127], v[220:223]
 ds_read_b128 v[28:31], v8 offset:52224
 s_waitcnt lgkmcnt(8)
 v_mfma_f32_16x16x32_bf16 v[188:191], v[44:47], v[120:123], v[188:191]
 v_mfma_f32_16x16x32_bf16 v[224:227], v[44:47], v[124:127], v[224:227]
 ds_read_b128 v[32:35], v8 offset:53248
 s_waitcnt lgkmcnt(8)
 v_mfma_f32_16x16x32_bf16 v[192:195], v[48:51], v[120:123], v[192:195]
 v_mfma_f32_16x16x32_bf16 v[228:231], v[48:51], v[124:127], v[228:231]
 ds_read_b128 v[36:39], v8 offset:54272
 s_waitcnt lgkmcnt(8)
 v_mfma_f32_16x16x32_bf16 v[160:163], v[52:55], v[128:131], v[160:163]
 v_mfma_f32_16x16x32_bf16 v[196:199], v[52:55], v[132:135], v[196:199]
 s_barrier
 ds_read_b128 v[40:43], v9 offset:0
 s_waitcnt lgkmcnt(8)
 v_mfma_f32_16x16x32_bf16 v[164:167], v[56:59], v[128:131], v[164:167]
 s_add_u32 m0, s50, 0
 s_add_u32 s47, s48, 92160
 buffer_load_dwordx4 v3, s[28:31], s47 offen sc1 lds
 v_mfma_f32_16x16x32_bf16 v[200:203], v[56:59], v[132:135], v[200:203]
 ds_read_b128 v[44:47], v9 offset:1024
 s_waitcnt lgkmcnt(8)
 v_mfma_f32_16x16x32_bf16 v[168:171], v[60:63], v[128:131], v[168:171]
 v_mfma_f32_16x16x32_bf16 v[204:207], v[60:63], v[132:135], v[204:207]
 s_add_u32 m0, s50, 4096
 s_add_u32 s47, s48, 755712
 buffer_load_dwordx4 v3, s[28:31], s47 offen sc1 lds
 ds_read_b128 v[48:51], v9 offset:2048
 s_waitcnt lgkmcnt(8)
 v_mfma_f32_16x16x32_bf16 v[172:175], v[16:19], v[128:131], v[172:175]
 v_mfma_f32_16x16x32_bf16 v[208:211], v[16:19], v[132:135], v[208:211]
 ds_read_b128 v[52:55], v9 offset:3072
 s_waitcnt lgkmcnt(8)
 v_mfma_f32_16x16x32_bf16 v[176:179], v[20:23], v[128:131], v[176:179]
 s_add_u32 m0, s50, 9216
 s_add_u32 s47, s48, 96768
 buffer_load_dwordx4 v3, s[28:31], s47 offen sc1 lds
 v_mfma_f32_16x16x32_bf16 v[212:215], v[20:23], v[132:135], v[212:215]
 ds_read_b128 v[56:59], v9 offset:4096
 s_waitcnt lgkmcnt(8)
 v_mfma_f32_16x16x32_bf16 v[180:183], v[24:27], v[128:131], v[180:183]
 v_mfma_f32_16x16x32_bf16 v[216:219], v[24:27], v[132:135], v[216:219]
 s_add_u32 m0, s50, 13312
 s_add_u32 s47, s48, 760320
 buffer_load_dwordx4 v3, s[28:31], s47 offen sc1 lds
 ds_read_b128 v[60:63], v9 offset:5120
 s_waitcnt lgkmcnt(8)
 v_mfma_f32_16x16x32_bf16 v[184:187], v[28:31], v[128:131], v[184:187]
 v_mfma_f32_16x16x32_bf16 v[220:223], v[28:31], v[132:135], v[220:223]
 ds_read_b128 v[16:19], v9 offset:6144
 s_waitcnt lgkmcnt(8)
 v_mfma_f32_16x16x32_bf16 v[188:191], v[32:35], v[128:131], v[188:191]
 s_add_u32 m0, s5, 0
 s_add_u32 s47, s48, 92160
 s_mov_b64 exec, s[52:53]
 buffer_load_dwordx4 v4, s[28:31], s47 offen sc1 lds
 s_mov_b64 exec, -1
 v_mfma_f32_16x16x32_bf16 v[224:227], v[32:35], v[132:135], v[224:227]
 ds_read_b128 v[20:23], v9 offset:7168
 s_waitcnt lgkmcnt(8)
 v_mfma_f32_16x16x32_bf16 v[192:195], v[36:39], v[128:131], v[192:195]
 v_mfma_f32_16x16x32_bf16 v[228:231], v[36:39], v[132:135], v[228:231]
 s_add_u32 s47, s49, 40960
 buffer_load_dwordx4 v[104:107], v10, s[24:27], s47 offen offset:0 sc1
 ds_read_b128 v[24:27], v9 offset:8192
 s_waitcnt vmcnt(15)
 s_waitcnt lgkmcnt(8)
 v_mfma_f32_16x16x32_bf16 v[160:163], v[40:43], v[136:139], v[160:163]
 v_mfma_f32_16x16x32_bf16 v[196:199], v[40:43], v[140:143], v[196:199]
 ds_read_b128 v[28:31], v9 offset:9216
 s_waitcnt lgkmcnt(8)
 v_mfma_f32_16x16x32_bf16 v[164:167], v[44:47], v[136:139], v[164:167]
 s_add_u32 s47, s49, 40960
 buffer_load_dwordx4 v[108:111], v10, s[24:27], s47 offen offset:256 sc1
 v_mfma_f32_16x16x32_bf16 v[200:203], v[44:47], v[140:143], v[200:203]
 ds_read_b128 v[32:35], v9 offset:10240
 s_waitcnt lgkmcnt(8)
 v_mfma_f32_16x16x32_bf16 v[168:171], v[48:51], v[136:139], v[168:171]
 v_mfma_f32_16x16x32_bf16 v[204:207], v[48:51], v[140:143], v[204:207]
 s_add_u32 s47, s49, 40960
 buffer_load_dwordx4 v[112:115], v10, s[24:27], s47 offen offset:2048 sc1
 ds_read_b128 v[36:39], v9 offset:11264
 s_waitcnt lgkmcnt(8)
 v_mfma_f32_16x16x32_bf16 v[172:175], v[52:55], v[136:139], v[172:175]
 v_mfma_f32_16x16x32_bf16 v[208:211], v[52:55], v[140:143], v[208:211]
 ds_read_b128 v[40:43], v9 offset:12288
 s_waitcnt lgkmcnt(8)
 v_mfma_f32_16x16x32_bf16 v[176:179], v[56:59], v[136:139], v[176:179]
 s_add_u32 s47, s49, 40960
 buffer_load_dwordx4 v[116:119], v10, s[24:27], s47 offen offset:2304 sc1
 v_mfma_f32_16x16x32_bf16 v[212:215], v[56:59], v[140:143], v[212:215]
 ds_read_b128 v[44:47], v9 offset:13312
 s_waitcnt lgkmcnt(8)
 v_mfma_f32_16x16x32_bf16 v[180:183], v[60:63], v[136:139], v[180:183]
 v_mfma_f32_16x16x32_bf16 v[216:219], v[60:63], v[140:143], v[216:219]
 ds_read_b128 v[48:51], v9 offset:14336
 s_waitcnt lgkmcnt(8)
 v_mfma_f32_16x16x32_bf16 v[184:187], v[16:19], v[136:139], v[184:187]
 v_mfma_f32_16x16x32_bf16 v[220:223], v[16:19], v[140:143], v[220:223]
 ds_read_b128 v[52:55], v9 offset:15360
 s_waitcnt lgkmcnt(8)
 v_mfma_f32_16x16x32_bf16 v[188:191], v[20:23], v[136:139], v[188:191]
 v_mfma_f32_16x16x32_bf16 v[224:227], v[20:23], v[140:143], v[224:227]
 ds_read_b128 v[56:59], v9 offset:16384
 s_waitcnt lgkmcnt(8)
 v_mfma_f32_16x16x32_bf16 v[192:195], v[24:27], v[136:139], v[192:195]
 v_mfma_f32_16x16x32_bf16 v[228:231], v[24:27], v[140:143], v[228:231]
 ds_read_b128 v[60:63], v9 offset:17408
 s_waitcnt lgkmcnt(8)
 v_mfma_f32_16x16x32_bf16 v[160:163], v[28:31], v[144:147], v[160:163]
 v_mfma_f32_16x16x32_bf16 v[196:199], v[28:31], v[148:151], v[196:199]
 s_waitcnt vmcnt(13)
 s_barrier
 ds_read_b128 v[16:19], v9 offset:36864
 s_waitcnt lgkmcnt(8)
 v_mfma_f32_16x16x32_bf16 v[164:167], v[32:35], v[144:147], v[164:167]
 s_add_u32 m0, s50, 36864
 s_add_u32 s47, s48, 110592
 buffer_load_dwordx4 v3, s[28:31], s47 offen sc1 lds
 v_mfma_f32_16x16x32_bf16 v[200:203], v[32:35], v[148:151], v[200:203]
 ds_read_b128 v[20:23], v9 offset:37888
 s_waitcnt lgkmcnt(8)
 v_mfma_f32_16x16x32_bf16 v[168:171], v[36:39], v[144:147], v[168:171]
 v_mfma_f32_16x16x32_bf16 v[204:207], v[36:39], v[148:151], v[204:207]
 s_add_u32 m0, s50, 40960
 s_add_u32 s47, s48, 774144
 buffer_load_dwordx4 v3, s[28:31], s47 offen sc1 lds
 ds_read_b128 v[24:27], v9 offset:38912
 s_waitcnt lgkmcnt(8)
 v_mfma_f32_16x16x32_bf16 v[172:175], v[40:43], v[144:147], v[172:175]
 v_mfma_f32_16x16x32_bf16 v[208:211], v[40:43], v[148:151], v[208:211]
 ds_read_b128 v[28:31], v9 offset:39936
 s_waitcnt lgkmcnt(8)
 v_mfma_f32_16x16x32_bf16 v[176:179], v[44:47], v[144:147], v[176:179]
 s_add_u32 m0, s50, 46080
 s_add_u32 s47, s48, 115200
 buffer_load_dwordx4 v3, s[28:31], s47 offen sc1 lds
 v_mfma_f32_16x16x32_bf16 v[212:215], v[44:47], v[148:151], v[212:215]
 ds_read_b128 v[32:35], v9 offset:40960
 s_waitcnt lgkmcnt(8)
 v_mfma_f32_16x16x32_bf16 v[180:183], v[48:51], v[144:147], v[180:183]
 v_mfma_f32_16x16x32_bf16 v[216:219], v[48:51], v[148:151], v[216:219]
 s_add_u32 m0, s50, 50176
 s_add_u32 s47, s48, 778752
 buffer_load_dwordx4 v3, s[28:31], s47 offen sc1 lds
 ds_read_b128 v[36:39], v9 offset:41984
 s_waitcnt lgkmcnt(8)
 v_mfma_f32_16x16x32_bf16 v[184:187], v[52:55], v[144:147], v[184:187]
 v_mfma_f32_16x16x32_bf16 v[220:223], v[52:55], v[148:151], v[220:223]
 ds_read_b128 v[40:43], v9 offset:43008
 s_waitcnt lgkmcnt(8)
 v_mfma_f32_16x16x32_bf16 v[188:191], v[56:59], v[144:147], v[188:191]
 s_add_u32 m0, s5, 36864
 s_add_u32 s47, s48, 110592
 s_mov_b64 exec, s[52:53]
 buffer_load_dwordx4 v4, s[28:31], s47 offen sc1 lds
 s_mov_b64 exec, -1
 v_mfma_f32_16x16x32_bf16 v[224:227], v[56:59], v[148:151], v[224:227]
 ds_read_b128 v[44:47], v9 offset:44032
 s_waitcnt lgkmcnt(8)
 v_mfma_f32_16x16x32_bf16 v[192:195], v[60:63], v[144:147], v[192:195]
 v_mfma_f32_16x16x32_bf16 v[228:231], v[60:63], v[148:151], v[228:231]
 s_add_u32 s47, s49, 49152
 buffer_load_dwordx4 v[120:123], v10, s[24:27], s47 offen offset:0 sc1
 ds_read_b128 v[48:51], v9 offset:45056
 s_waitcnt vmcnt(15)
 s_waitcnt lgkmcnt(8)
 v_mfma_f32_16x16x32_bf16 v[160:163], v[16:19], v[88:91], v[160:163]
 v_mfma_f32_16x16x32_bf16 v[196:199], v[16:19], v[92:95], v[196:199]
 ds_read_b128 v[52:55], v9 offset:46080
 s_waitcnt lgkmcnt(8)
 v_mfma_f32_16x16x32_bf16 v[164:167], v[20:23], v[88:91], v[164:167]
 s_add_u32 s47, s49, 49152
 buffer_load_dwordx4 v[124:127], v10, s[24:27], s47 offen offset:256 sc1
 v_mfma_f32_16x16x32_bf16 v[200:203], v[20:23], v[92:95], v[200:203]
 ds_read_b128 v[56:59], v9 offset:47104
 s_waitcnt lgkmcnt(8)
 v_mfma_f32_16x16x32_bf16 v[168:171], v[24:27], v[88:91], v[168:171]
 v_mfma_f32_16x16x32_bf16 v[204:207], v[24:27], v[92:95], v[204:207]
 s_add_u32 s47, s49, 49152
 buffer_load_dwordx4 v[128:131], v10, s[24:27], s47 offen offset:2048 sc1
 ds_read_b128 v[60:63], v9 offset:48128
 s_waitcnt lgkmcnt(8)
 v_mfma_f32_16x16x32_bf16 v[172:175], v[28:31], v[88:91], v[172:175]
 v_mfma_f32_16x16x32_bf16 v[208:211], v[28:31], v[92:95], v[208:211]
 ds_read_b128 v[16:19], v9 offset:49152
 s_waitcnt lgkmcnt(8)
 v_mfma_f32_16x16x32_bf16 v[176:179], v[32:35], v[88:91], v[176:179]
 s_add_u32 s47, s49, 49152
 buffer_load_dwordx4 v[132:135], v10, s[24:27], s47 offen offset:2304 sc1
 v_mfma_f32_16x16x32_bf16 v[212:215], v[32:35], v[92:95], v[212:215]
 ds_read_b128 v[20:23], v9 offset:50176
 s_waitcnt lgkmcnt(8)
 v_mfma_f32_16x16x32_bf16 v[180:183], v[36:39], v[88:91], v[180:183]
 v_mfma_f32_16x16x32_bf16 v[216:219], v[36:39], v[92:95], v[216:219]
 ds_read_b128 v[24:27], v9 offset:51200
 s_waitcnt lgkmcnt(8)
 v_mfma_f32_16x16x32_bf16 v[184:187], v[40:43], v[88:91], v[184:187]
 v_mfma_f32_16x16x32_bf16 v[220:223], v[40:43], v[92:95], v[220:223]
 ds_read_b128 v[28:31], v9 offset:52224
 s_waitcnt lgkmcnt(8)
 v_mfma_f32_16x16x32_bf16 v[188:191], v[44:47], v[88:91], v[188:191]
 v_mfma_f32_16x16x32_bf16 v[224:227], v[44:47], v[92:95], v[224:227]
 ds_read_b128 v[32:35], v9 offset:53248
 s_waitcnt lgkmcnt(8)
 v_mfma_f32_16x16x32_bf16 v[192:195], v[48:51], v[88:91], v[192:195]
 v_mfma_f32_16x16x32_bf16 v[228:231], v[48:51], v[92:95], v[228:231]
 ds_read_b128 v[36:39], v9 offset:54272
 s_waitcnt lgkmcnt(8)
 v_mfma_f32_16x16x32_bf16 v[160:163], v[52:55], v[96:99], v[160:163]
 v_mfma_f32_16x16x32_bf16 v[196:199], v[52:55], v[100:103], v[196:199]
 s_waitcnt vmcnt(13)
 s_barrier
 ds_read_b128 v[40:43], v8 offset:0
 s_waitcnt lgkmcnt(8)
 v_mfma_f32_16x16x32_bf16 v[164:167], v[56:59], v[96:99], v[164:167]
 s_add_u32 m0, s50, 73728
 s_add_u32 s47, s48, 129024
 buffer_load_dwordx4 v3, s[28:31], s47 offen sc1 lds
 v_mfma_f32_16x16x32_bf16 v[200:203], v[56:59], v[100:103], v[200:203]
 ds_read_b128 v[44:47], v8 offset:1024
 s_waitcnt lgkmcnt(8)
 v_mfma_f32_16x16x32_bf16 v[168:171], v[60:63], v[96:99], v[168:171]
 v_mfma_f32_16x16x32_bf16 v[204:207], v[60:63], v[100:103], v[204:207]
 s_add_u32 m0, s50, 77824
 s_add_u32 s47, s48, 792576
 buffer_load_dwordx4 v3, s[28:31], s47 offen sc1 lds
 ds_read_b128 v[48:51], v8 offset:2048
 s_waitcnt lgkmcnt(8)
 v_mfma_f32_16x16x32_bf16 v[172:175], v[16:19], v[96:99], v[172:175]
 v_mfma_f32_16x16x32_bf16 v[208:211], v[16:19], v[100:103], v[208:211]
 ds_read_b128 v[52:55], v8 offset:3072
 s_waitcnt lgkmcnt(8)
 v_mfma_f32_16x16x32_bf16 v[176:179], v[20:23], v[96:99], v[176:179]
 s_add_u32 m0, s50, 82944
 s_add_u32 s47, s48, 133632
 buffer_load_dwordx4 v3, s[28:31], s47 offen sc1 lds
 v_mfma_f32_16x16x32_bf16 v[212:215], v[20:23], v[100:103], v[212:215]
 ds_read_b128 v[56:59], v8 offset:4096
 s_waitcnt lgkmcnt(8)
 v_mfma_f32_16x16x32_bf16 v[180:183], v[24:27], v[96:99], v[180:183]
 v_mfma_f32_16x16x32_bf16 v[216:219], v[24:27], v[100:103], v[216:219]
 s_add_u32 m0, s50, 87040
 s_add_u32 s47, s48, 797184
 buffer_load_dwordx4 v3, s[28:31], s47 offen sc1 lds
 ds_read_b128 v[60:63], v8 offset:5120
 s_waitcnt lgkmcnt(8)
 v_mfma_f32_16x16x32_bf16 v[184:187], v[28:31], v[96:99], v[184:187]
 v_mfma_f32_16x16x32_bf16 v[220:223], v[28:31], v[100:103], v[220:223]
 ds_read_b128 v[16:19], v8 offset:6144
 s_waitcnt lgkmcnt(8)
 v_mfma_f32_16x16x32_bf16 v[188:191], v[32:35], v[96:99], v[188:191]
 s_add_u32 m0, s5, 73728
 s_add_u32 s47, s48, 129024
 s_mov_b64 exec, s[52:53]
 buffer_load_dwordx4 v4, s[28:31], s47 offen sc1 lds
 s_mov_b64 exec, -1
 v_mfma_f32_16x16x32_bf16 v[224:227], v[32:35], v[100:103], v[224:227]
 ds_read_b128 v[20:23], v8 offset:7168
 s_waitcnt lgkmcnt(8)
 v_mfma_f32_16x16x32_bf16 v[192:195], v[36:39], v[96:99], v[192:195]
 v_mfma_f32_16x16x32_bf16 v[228:231], v[36:39], v[100:103], v[228:231]
 s_add_u32 s47, s49, 57344
 buffer_load_dwordx4 v[136:139], v10, s[24:27], s47 offen offset:0 sc1
 ds_read_b128 v[24:27], v8 offset:8192
 s_waitcnt vmcnt(15)
 s_waitcnt lgkmcnt(8)
 v_mfma_f32_16x16x32_bf16 v[160:163], v[40:43], v[104:107], v[160:163]
 v_mfma_f32_16x16x32_bf16 v[196:199], v[40:43], v[108:111], v[196:199]
 ds_read_b128 v[28:31], v8 offset:9216
 s_waitcnt lgkmcnt(8)
 v_mfma_f32_16x16x32_bf16 v[164:167], v[44:47], v[104:107], v[164:167]
 s_add_u32 s47, s49, 57344
 buffer_load_dwordx4 v[140:143], v10, s[24:27], s47 offen offset:256 sc1
 v_mfma_f32_16x16x32_bf16 v[200:203], v[44:47], v[108:111], v[200:203]
 ds_read_b128 v[32:35], v8 offset:10240
 s_waitcnt lgkmcnt(8)
 v_mfma_f32_16x16x32_bf16 v[168:171], v[48:51], v[104:107], v[168:171]
 v_mfma_f32_16x16x32_bf16 v[204:207], v[48:51], v[108:111], v[204:207]
 s_add_u32 s47, s49, 57344
 buffer_load_dwordx4 v[144:147], v10, s[24:27], s47 offen offset:2048 sc1
 ds_read_b128 v[36:39], v8 offset:11264
 s_waitcnt lgkmcnt(8)
 v_mfma_f32_16x16x32_bf16 v[172:175], v[52:55], v[104:107], v[172:175]
 v_mfma_f32_16x16x32_bf16 v[208:211], v[52:55], v[108:111], v[208:211]
 ds_read_b128 v[40:43], v8 offset:12288
 s_waitcnt lgkmcnt(8)
 v_mfma_f32_16x16x32_bf16 v[176:179], v[56:59], v[104:107], v[176:179]
 s_add_u32 s47, s49, 57344
 buffer_load_dwordx4 v[148:151], v10, s[24:27], s47 offen offset:2304 sc1
 v_mfma_f32_16x16x32_bf16 v[212:215], v[56:59], v[108:111], v[212:215]
 ds_read_b128 v[44:47], v8 offset:13312
 s_waitcnt lgkmcnt(8)
 v_mfma_f32_16x16x32_bf16 v[180:183], v[60:63], v[104:107], v[180:183]
 v_mfma_f32_16x16x32_bf16 v[216:219], v[60:63], v[108:111], v[216:219]
 ds_read_b128 v[48:51], v8 offset:14336
 s_waitcnt lgkmcnt(8)
 v_mfma_f32_16x16x32_bf16 v[184:187], v[16:19], v[104:107], v[184:187]
 v_mfma_f32_16x16x32_bf16 v[220:223], v[16:19], v[108:111], v[220:223]
 ds_read_b128 v[52:55], v8 offset:15360
 s_waitcnt lgkmcnt(8)
 v_mfma_f32_16x16x32_bf16 v[188:191], v[20:23], v[104:107], v[188:191]
 v_mfma_f32_16x16x32_bf16 v[224:227], v[20:23], v[108:111], v[224:227]
 ds_read_b128 v[56:59], v8 offset:16384
 s_waitcnt lgkmcnt(8)
 v_mfma_f32_16x16x32_bf16 v[192:195], v[24:27], v[104:107], v[192:195]
 v_mfma_f32_16x16x32_bf16 v[228:231], v[24:27], v[108:111], v[228:231]
 ds_read_b128 v[60:63], v8 offset:17408
 s_waitcnt lgkmcnt(8)
 v_mfma_f32_16x16x32_bf16 v[160:163], v[28:31], v[112:115], v[160:163]
 v_mfma_f32_16x16x32_bf16 v[196:199], v[28:31], v[116:119], v[196:199]
 s_waitcnt vmcnt(13)
 s_barrier
 ds_read_b128 v[16:19], v8 offset:36864
 s_waitcnt lgkmcnt(8)
 v_mfma_f32_16x16x32_bf16 v[164:167], v[32:35], v[112:115], v[164:167]
 s_add_u32 m0, s50, 110592
 s_add_u32 s47, s48, 147456
 buffer_load_dwordx4 v3, s[28:31], s47 offen sc1 lds
 v_mfma_f32_16x16x32_bf16 v[200:203], v[32:35], v[116:119], v[200:203]
 ds_read_b128 v[20:23], v8 offset:37888
 s_waitcnt lgkmcnt(8)
 v_mfma_f32_16x16x32_bf16 v[168:171], v[36:39], v[112:115], v[168:171]
 v_mfma_f32_16x16x32_bf16 v[204:207], v[36:39], v[116:119], v[204:207]
 s_add_u32 m0, s50, 114688
 s_add_u32 s47, s48, 811008
 buffer_load_dwordx4 v3, s[28:31], s47 offen sc1 lds
 ds_read_b128 v[24:27], v8 offset:38912
 s_waitcnt lgkmcnt(8)
 v_mfma_f32_16x16x32_bf16 v[172:175], v[40:43], v[112:115], v[172:175]
 v_mfma_f32_16x16x32_bf16 v[208:211], v[40:43], v[116:119], v[208:211]
 ds_read_b128 v[28:31], v8 offset:39936
 s_waitcnt lgkmcnt(8)
 v_mfma_f32_16x16x32_bf16 v[176:179], v[44:47], v[112:115], v[176:179]
 s_add_u32 m0, s50, 119808
 s_add_u32 s47, s48, 152064
 buffer_load_dwordx4 v3, s[28:31], s47 offen sc1 lds
 v_mfma_f32_16x16x32_bf16 v[212:215], v[44:47], v[116:119], v[212:215]
 ds_read_b128 v[32:35], v8 offset:40960
 s_waitcnt lgkmcnt(8)
 v_mfma_f32_16x16x32_bf16 v[180:183], v[48:51], v[112:115], v[180:183]
 v_mfma_f32_16x16x32_bf16 v[216:219], v[48:51], v[116:119], v[216:219]
 s_add_u32 m0, s50, 123904
 s_add_u32 s47, s48, 815616
 buffer_load_dwordx4 v3, s[28:31], s47 offen sc1 lds
 ds_read_b128 v[36:39], v8 offset:41984
 s_waitcnt lgkmcnt(8)
 v_mfma_f32_16x16x32_bf16 v[184:187], v[52:55], v[112:115], v[184:187]
 v_mfma_f32_16x16x32_bf16 v[220:223], v[52:55], v[116:119], v[220:223]
 ds_read_b128 v[40:43], v8 offset:43008
 s_waitcnt lgkmcnt(8)
 v_mfma_f32_16x16x32_bf16 v[188:191], v[56:59], v[112:115], v[188:191]
 s_add_u32 m0, s5, 110592
 s_add_u32 s47, s48, 147456
 s_mov_b64 exec, s[52:53]
 buffer_load_dwordx4 v4, s[28:31], s47 offen sc1 lds
 s_mov_b64 exec, -1
 v_mfma_f32_16x16x32_bf16 v[224:227], v[56:59], v[116:119], v[224:227]
 ds_read_b128 v[44:47], v8 offset:44032
 s_waitcnt lgkmcnt(8)
 v_mfma_f32_16x16x32_bf16 v[192:195], v[60:63], v[112:115], v[192:195]
 v_mfma_f32_16x16x32_bf16 v[228:231], v[60:63], v[116:119], v[228:231]
 s_add_u32 s47, s49, 65536
 buffer_load_dwordx4 v[88:91], v10, s[24:27], s47 offen offset:0 sc1
 ds_read_b128 v[48:51], v8 offset:45056
 s_waitcnt vmcnt(15)
 s_waitcnt lgkmcnt(8)
 v_mfma_f32_16x16x32_bf16 v[160:163], v[16:19], v[120:123], v[160:163]
 v_mfma_f32_16x16x32_bf16 v[196:199], v[16:19], v[124:127], v[196:199]
 ds_read_b128 v[52:55], v8 offset:46080
 s_waitcnt lgkmcnt(8)
 v_mfma_f32_16x16x32_bf16 v[164:167], v[20:23], v[120:123], v[164:167]
 s_add_u32 s47, s49, 65536
 buffer_load_dwordx4 v[92:95], v10, s[24:27], s47 offen offset:256 sc1
 v_mfma_f32_16x16x32_bf16 v[200:203], v[20:23], v[124:127], v[200:203]
 ds_read_b128 v[56:59], v8 offset:47104
 s_waitcnt lgkmcnt(8)
 v_mfma_f32_16x16x32_bf16 v[168:171], v[24:27], v[120:123], v[168:171]
 v_mfma_f32_16x16x32_bf16 v[204:207], v[24:27], v[124:127], v[204:207]
 s_add_u32 s47, s49, 65536
 buffer_load_dwordx4 v[96:99], v10, s[24:27], s47 offen offset:2048 sc1
 ds_read_b128 v[60:63], v8 offset:48128
 s_waitcnt lgkmcnt(8)
 v_mfma_f32_16x16x32_bf16 v[172:175], v[28:31], v[120:123], v[172:175]
 v_mfma_f32_16x16x32_bf16 v[208:211], v[28:31], v[124:127], v[208:211]
 ds_read_b128 v[16:19], v8 offset:49152
 s_waitcnt lgkmcnt(8)
 v_mfma_f32_16x16x32_bf16 v[176:179], v[32:35], v[120:123], v[176:179]
 s_add_u32 s47, s49, 65536
 buffer_load_dwordx4 v[100:103], v10, s[24:27], s47 offen offset:2304 sc1
 v_mfma_f32_16x16x32_bf16 v[212:215], v[32:35], v[124:127], v[212:215]
 ds_read_b128 v[20:23], v8 offset:50176
 s_waitcnt lgkmcnt(8)
 v_mfma_f32_16x16x32_bf16 v[180:183], v[36:39], v[120:123], v[180:183]
 v_mfma_f32_16x16x32_bf16 v[216:219], v[36:39], v[124:127], v[216:219]
 ds_read_b128 v[24:27], v8 offset:51200
 s_waitcnt lgkmcnt(8)
 v_mfma_f32_16x16x32_bf16 v[184:187], v[40:43], v[120:123], v[184:187]
 v_mfma_f32_16x16x32_bf16 v[220:223], v[40:43], v[124:127], v[220:223]
 ds_read_b128 v[28:31], v8 offset:52224
 s_waitcnt lgkmcnt(8)
 v_mfma_f32_16x16x32_bf16 v[188:191], v[44:47], v[120:123], v[188:191]
 v_mfma_f32_16x16x32_bf16 v[224:227], v[44:47], v[124:127], v[224:227]
 ds_read_b128 v[32:35], v8 offset:53248
 s_waitcnt lgkmcnt(8)
 v_mfma_f32_16x16x32_bf16 v[192:195], v[48:51], v[120:123], v[192:195]
 v_mfma_f32_16x16x32_bf16 v[228:231], v[48:51], v[124:127], v[228:231]
 ds_read_b128 v[36:39], v8 offset:54272
 s_waitcnt lgkmcnt(8)
 v_mfma_f32_16x16x32_bf16 v[160:163], v[52:55], v[128:131], v[160:163]
 v_mfma_f32_16x16x32_bf16 v[196:199], v[52:55], v[132:135], v[196:199]
 s_waitcnt vmcnt(13)
 s_barrier
 ds_read_b128 v[40:43], v9 offset:0
 s_waitcnt lgkmcnt(8)
 v_mfma_f32_16x16x32_bf16 v[164:167], v[56:59], v[128:131], v[164:167]
 v_mfma_f32_16x16x32_bf16 v[200:203], v[56:59], v[132:135], v[200:203]
 ds_read_b128 v[44:47], v9 offset:1024
 s_waitcnt lgkmcnt(8)
 v_mfma_f32_16x16x32_bf16 v[168:171], v[60:63], v[128:131], v[168:171]
 v_mfma_f32_16x16x32_bf16 v[204:207], v[60:63], v[132:135], v[204:207]
 ds_read_b128 v[48:51], v9 offset:2048
 s_waitcnt lgkmcnt(8)
 v_mfma_f32_16x16x32_bf16 v[172:175], v[16:19], v[128:131], v[172:175]
 v_mfma_f32_16x16x32_bf16 v[208:211], v[16:19], v[132:135], v[208:211]
 ds_read_b128 v[52:55], v9 offset:3072
 s_waitcnt lgkmcnt(8)
 v_mfma_f32_16x16x32_bf16 v[176:179], v[20:23], v[128:131], v[176:179]
 v_mfma_f32_16x16x32_bf16 v[212:215], v[20:23], v[132:135], v[212:215]
 ds_read_b128 v[56:59], v9 offset:4096
 s_waitcnt lgkmcnt(8)
 v_mfma_f32_16x16x32_bf16 v[180:183], v[24:27], v[128:131], v[180:183]
 v_mfma_f32_16x16x32_bf16 v[216:219], v[24:27], v[132:135], v[216:219]
 ds_read_b128 v[60:63], v9 offset:5120
 s_waitcnt lgkmcnt(8)
 v_mfma_f32_16x16x32_bf16 v[184:187], v[28:31], v[128:131], v[184:187]
 v_mfma_f32_16x16x32_bf16 v[220:223], v[28:31], v[132:135], v[220:223]
 ds_read_b128 v[16:19], v9 offset:6144
 s_waitcnt lgkmcnt(8)
 v_mfma_f32_16x16x32_bf16 v[188:191], v[32:35], v[128:131], v[188:191]
 v_mfma_f32_16x16x32_bf16 v[224:227], v[32:35], v[132:135], v[224:227]
 ds_read_b128 v[20:23], v9 offset:7168
 s_waitcnt lgkmcnt(8)
 v_mfma_f32_16x16x32_bf16 v[192:195], v[36:39], v[128:131], v[192:195]
 v_mfma_f32_16x16x32_bf16 v[228:231], v[36:39], v[132:135], v[228:231]
 ds_read_b128 v[24:27], v9 offset:8192
 s_waitcnt vmcnt(9)
 s_waitcnt lgkmcnt(8)
 v_mfma_f32_16x16x32_bf16 v[160:163], v[40:43], v[136:139], v[160:163]
 v_mfma_f32_16x16x32_bf16 v[196:199], v[40:43], v[140:143], v[196:199]
 ds_read_b128 v[28:31], v9 offset:9216
 s_waitcnt lgkmcnt(8)
 v_mfma_f32_16x16x32_bf16 v[164:167], v[44:47], v[136:139], v[164:167]
 v_mfma_f32_16x16x32_bf16 v[200:203], v[44:47], v[140:143], v[200:203]
 ds_read_b128 v[32:35], v9 offset:10240
 s_waitcnt lgkmcnt(8)
 v_mfma_f32_16x16x32_bf16 v[168:171], v[48:51], v[136:139], v[168:171]
 v_mfma_f32_16x16x32_bf16 v[204:207], v[48:51], v[140:143], v[204:207]
 ds_read_b128 v[36:39], v9 offset:11264
 s_waitcnt lgkmcnt(8)
 v_mfma_f32_16x16x32_bf16 v[172:175], v[52:55], v[136:139], v[172:175]
 v_mfma_f32_16x16x32_bf16 v[208:211], v[52:55], v[140:143], v[208:211]
 ds_read_b128 v[40:43], v9 offset:12288
 s_waitcnt lgkmcnt(8)
 v_mfma_f32_16x16x32_bf16 v[176:179], v[56:59], v[136:139], v[176:179]
 v_mfma_f32_16x16x32_bf16 v[212:215], v[56:59], v[140:143], v[212:215]
 ds_read_b128 v[44:47], v9 offset:13312
 s_waitcnt lgkmcnt(8)
 v_mfma_f32_16x16x32_bf16 v[180:183], v[60:63], v[136:139], v[180:183]
 v_mfma_f32_16x16x32_bf16 v[216:219], v[60:63], v[140:143], v[216:219]
 ds_read_b128 v[48:51], v9 offset:14336
 s_waitcnt lgkmcnt(8)
 v_mfma_f32_16x16x32_bf16 v[184:187], v[16:19], v[136:139], v[184:187]
 v_mfma_f32_16x16x32_bf16 v[220:223], v[16:19], v[140:143], v[220:223]
 ds_read_b128 v[52:55], v9 offset:15360
 s_waitcnt lgkmcnt(8)
 v_mfma_f32_16x16x32_bf16 v[188:191], v[20:23], v[136:139], v[188:191]
 v_mfma_f32_16x16x32_bf16 v[224:227], v[20:23], v[140:143], v[224:227]
 ds_read_b128 v[56:59], v9 offset:16384
 s_waitcnt lgkmcnt(8)
 v_mfma_f32_16x16x32_bf16 v[192:195], v[24:27], v[136:139], v[192:195]
 v_mfma_f32_16x16x32_bf16 v[228:231], v[24:27], v[140:143], v[228:231]
 ds_read_b128 v[60:63], v9 offset:17408
 s_waitcnt lgkmcnt(8)
 v_mfma_f32_16x16x32_bf16 v[160:163], v[28:31], v[144:147], v[160:163]
 v_mfma_f32_16x16x32_bf16 v[196:199], v[28:31], v[148:151], v[196:199]
 s_waitcnt vmcnt(4)
 s_barrier
 ds_read_b128 v[16:19], v9 offset:36864
 s_waitcnt lgkmcnt(8)
 v_mfma_f32_16x16x32_bf16 v[164:167], v[32:35], v[144:147], v[164:167]
 v_mfma_f32_16x16x32_bf16 v[200:203], v[32:35], v[148:151], v[200:203]
 ds_read_b128 v[20:23], v9 offset:37888
 s_waitcnt lgkmcnt(8)
 v_mfma_f32_16x16x32_bf16 v[168:171], v[36:39], v[144:147], v[168:171]
 v_mfma_f32_16x16x32_bf16 v[204:207], v[36:39], v[148:151], v[204:207]
 ds_read_b128 v[24:27], v9 offset:38912
 s_waitcnt lgkmcnt(8)
 v_mfma_f32_16x16x32_bf16 v[172:175], v[40:43], v[144:147], v[172:175]
 v_mfma_f32_16x16x32_bf16 v[208:211], v[40:43], v[148:151], v[208:211]
 ds_read_b128 v[28:31], v9 offset:39936
 s_waitcnt lgkmcnt(8)
 v_mfma_f32_16x16x32_bf16 v[176:179], v[44:47], v[144:147], v[176:179]
 v_mfma_f32_16x16x32_bf16 v[212:215], v[44:47], v[148:151], v[212:215]
 ds_read_b128 v[32:35], v9 offset:40960
 s_waitcnt lgkmcnt(8)
 v_mfma_f32_16x16x32_bf16 v[180:183], v[48:51], v[144:147], v[180:183]
 v_mfma_f32_16x16x32_bf16 v[216:219], v[48:51], v[148:151], v[216:219]
 ds_read_b128 v[36:39], v9 offset:41984
 s_waitcnt lgkmcnt(8)
 v_mfma_f32_16x16x32_bf16 v[184:187], v[52:55], v[144:147], v[184:187]
 v_mfma_f32_16x16x32_bf16 v[220:223], v[52:55], v[148:151], v[220:223]
 ds_read_b128 v[40:43], v9 offset:43008
 s_waitcnt lgkmcnt(8)
 v_mfma_f32_16x16x32_bf16 v[188:191], v[56:59], v[144:147], v[188:191]
 v_mfma_f32_16x16x32_bf16 v[224:227], v[56:59], v[148:151], v[224:227]
 ds_read_b128 v[44:47], v9 offset:44032
 s_waitcnt lgkmcnt(8)
 v_mfma_f32_16x16x32_bf16 v[192:195], v[60:63], v[144:147], v[192:195]
 v_mfma_f32_16x16x32_bf16 v[228:231], v[60:63], v[148:151], v[228:231]
 ds_read_b128 v[48:51], v9 offset:45056
 s_waitcnt vmcnt(0)
 s_waitcnt lgkmcnt(8)
 v_mfma_f32_16x16x32_bf16 v[160:163], v[16:19], v[88:91], v[160:163]
 v_mfma_f32_16x16x32_bf16 v[196:199], v[16:19], v[92:95], v[196:199]
 ds_read_b128 v[52:55], v9 offset:46080
 s_waitcnt lgkmcnt(8)
 v_mfma_f32_16x16x32_bf16 v[164:167], v[20:23], v[88:91], v[164:167]
 v_mfma_f32_16x16x32_bf16 v[200:203], v[20:23], v[92:95], v[200:203]
 ds_read_b128 v[56:59], v9 offset:47104
 s_waitcnt lgkmcnt(8)
 v_mfma_f32_16x16x32_bf16 v[168:171], v[24:27], v[88:91], v[168:171]
 v_mfma_f32_16x16x32_bf16 v[204:207], v[24:27], v[92:95], v[204:207]
 ds_read_b128 v[60:63], v9 offset:48128
 s_waitcnt lgkmcnt(8)
 v_mfma_f32_16x16x32_bf16 v[172:175], v[28:31], v[88:91], v[172:175]
 v_mfma_f32_16x16x32_bf16 v[208:211], v[28:31], v[92:95], v[208:211]
 ds_read_b128 v[16:19], v9 offset:49152
 s_waitcnt lgkmcnt(8)
 v_mfma_f32_16x16x32_bf16 v[176:179], v[32:35], v[88:91], v[176:179]
 v_mfma_f32_16x16x32_bf16 v[212:215], v[32:35], v[92:95], v[212:215]
 ds_read_b128 v[20:23], v9 offset:50176
 s_waitcnt lgkmcnt(8)
 v_mfma_f32_16x16x32_bf16 v[180:183], v[36:39], v[88:91], v[180:183]
 v_mfma_f32_16x16x32_bf16 v[216:219], v[36:39], v[92:95], v[216:219]
 ds_read_b128 v[24:27], v9 offset:51200
 s_waitcnt lgkmcnt(8)
 v_mfma_f32_16x16x32_bf16 v[184:187], v[40:43], v[88:91], v[184:187]
 v_mfma_f32_16x16x32_bf16 v[220:223], v[40:43], v[92:95], v[220:223]
 ds_read_b128 v[28:31], v9 offset:52224
 s_waitcnt lgkmcnt(8)
 v_mfma_f32_16x16x32_bf16 v[188:191], v[44:47], v[88:91], v[188:191]
 v_mfma_f32_16x16x32_bf16 v[224:227], v[44:47], v[92:95], v[224:227]
 ds_read_b128 v[32:35], v9 offset:53248
 s_waitcnt lgkmcnt(8)
 v_mfma_f32_16x16x32_bf16 v[192:195], v[48:51], v[88:91], v[192:195]
 v_mfma_f32_16x16x32_bf16 v[228:231], v[48:51], v[92:95], v[228:231]
 ds_read_b128 v[36:39], v9 offset:54272
 s_waitcnt lgkmcnt(8)
 v_mfma_f32_16x16x32_bf16 v[160:163], v[52:55], v[96:99], v[160:163]
 v_mfma_f32_16x16x32_bf16 v[196:199], v[52:55], v[100:103], v[196:199]
 s_waitcnt lgkmcnt(7)
 v_mfma_f32_16x16x32_bf16 v[164:167], v[56:59], v[96:99], v[164:167]
 v_mfma_f32_16x16x32_bf16 v[200:203], v[56:59], v[100:103], v[200:203]
 s_waitcnt lgkmcnt(6)
 v_mfma_f32_16x16x32_bf16 v[168:171], v[60:63], v[96:99], v[168:171]
 v_mfma_f32_16x16x32_bf16 v[204:207], v[60:63], v[100:103], v[204:207]
 s_waitcnt lgkmcnt(5)
 v_mfma_f32_16x16x32_bf16 v[172:175], v[16:19], v[96:99], v[172:175]
 v_mfma_f32_16x16x32_bf16 v[208:211], v[16:19], v[100:103], v[208:211]
 s_waitcnt lgkmcnt(4)
 v_mfma_f32_16x16x32_bf16 v[176:179], v[20:23], v[96:99], v[176:179]
 v_mfma_f32_16x16x32_bf16 v[212:215], v[20:23], v[100:103], v[212:215]
 s_waitcnt lgkmcnt(3)
 v_mfma_f32_16x16x32_bf16 v[180:183], v[24:27], v[96:99], v[180:183]
 v_mfma_f32_16x16x32_bf16 v[216:219], v[24:27], v[100:103], v[216:219]
 s_waitcnt lgkmcnt(2)
 v_mfma_f32_16x16x32_bf16 v[184:187], v[28:31], v[96:99], v[184:187]
 v_mfma_f32_16x16x32_bf16 v[220:223], v[28:31], v[100:103], v[220:223]
 s_waitcnt lgkmcnt(1)
 v_mfma_f32_16x16x32_bf16 v[188:191], v[32:35], v[96:99], v[188:191]
 v_mfma_f32_16x16x32_bf16 v[224:227], v[32:35], v[100:103], v[224:227]
 s_waitcnt lgkmcnt(0)
 v_mfma_f32_16x16x32_bf16 v[192:195], v[36:39], v[96:99], v[192:195]
 v_mfma_f32_16x16x32_bf16 v[228:231], v[36:39], v[100:103], v[228:231]
 s_nop 5
 s_cmp_eq_u32 s46, 0
 s_cbranch_scc1 kd_x0
 ds_write_b128 v232, v[160:163] offset:0
 ds_write_b128 v232, v[164:167] offset:1024
 ds_write_b128 v232, v[168:171] offset:2048
 ds_write_b128 v232, v[172:175] offset:3072
 ds_write_b128 v232, v[176:179] offset:4096
 ds_write_b128 v232, v[180:183] offset:5120
 ds_write_b128 v232, v[184:187] offset:6144
 ds_write_b128 v232, v[188:191] offset:7168
 ds_write_b128 v232, v[192:195] offset:8192
 s_waitcnt lgkmcnt(0)
 s_barrier
 ds_read_b128 v[88:91], v233 offset:0
 ds_read_b128 v[92:95], v233 offset:1024
 ds_read_b128 v[96:99], v233 offset:2048
 ds_read_b128 v[100:103], v233 offset:3072
 ds_read_b128 v[104:107], v233 offset:4096
 ds_read_b128 v[108:111], v233 offset:5120
 ds_read_b128 v[112:115], v233 offset:6144
 ds_read_b128 v[116:119], v233 offset:7168
 ds_read_b128 v[120:123], v233 offset:8192
 s_waitcnt lgkmcnt(8)
 v_add_f32 v196, v196, v88
 v_add_f32 v197, v197, v89
 v_add_f32 v198, v198, v90
 v_add_f32 v199, v199, v91
 v_cvt_pk_bf16_f32 v16, v196, v197
 v_cvt_pk_bf16_f32 v17, v198, v199
 s_waitcnt lgkmcnt(7)
 v_add_f32 v200, v200, v92
 v_add_f32 v201, v201, v93
 v_add_f32 v202, v202, v94
 v_add_f32 v203, v203, v95
 v_cvt_pk_bf16_f32 v18, v200, v201
 v_cvt_pk_bf16_f32 v19, v202, v203
 buffer_store_dwordx4 v[16:19], v234, s[32:35], s75 offen offset:0 sc1
 s_waitcnt lgkmcnt(6)
 v_add_f32 v204, v204, v96
 v_add_f32 v205, v205, v97
 v_add_f32 v206, v206, v98
 v_add_f32 v207, v207, v99
 v_cvt_pk_bf16_f32 v20, v204, v205
 v_cvt_pk_bf16_f32 v21, v206, v207
 s_waitcnt lgkmcnt(5)
 v_add_f32 v208, v208, v100
 v_add_f32 v209, v209, v101
 v_add_f32 v210, v210, v102
 v_add_f32 v211, v211, v103
 v_cvt_pk_bf16_f32 v22, v208, v209
 v_cvt_pk_bf16_f32 v23, v210, v211
 buffer_store_dwordx4 v[20:23], v234, s[32:35], s75 offen offset:1024 sc1
 s_waitcnt lgkmcnt(4)
 v_add_f32 v212, v212, v104
 v_add_f32 v213, v213, v105
 v_add_f32 v214, v214, v106
 v_add_f32 v215, v215, v107
 v_cvt_pk_bf16_f32 v24, v212, v213
 v_cvt_pk_bf16_f32 v25, v214, v215
 s_waitcnt lgkmcnt(3)
 v_add_f32 v216, v216, v108
 v_add_f32 v217, v217, v109
 v_add_f32 v218, v218, v110
 v_add_f32 v219, v219, v111
 v_cvt_pk_bf16_f32 v26, v216, v217
 v_cvt_pk_bf16_f32 v27, v218, v219
 buffer_store_dwordx4 v[24:27], v234, s[32:35], s75 offen offset:2048 sc1
 s_waitcnt lgkmcnt(2)
 v_add_f32 v220, v220, v112
 v_add_f32 v221, v221, v113
 v_add_f32 v222, v222, v114
 v_add_f32 v223, v223, v115
 v_cvt_pk_bf16_f32 v28, v220, v221
 v_cvt_pk_bf16_f32 v29, v222, v223
 s_waitcnt lgkmcnt(1)
 v_add_f32 v224, v224, v116
 v_add_f32 v225, v225, v117
 v_add_f32 v226, v226, v118
 v_add_f32 v227, v227, v119
 v_cvt_pk_bf16_f32 v30, v224, v225
 v_cvt_pk_bf16_f32 v31, v226, v227
 buffer_store_dwordx4 v[28:31], v234, s[32:35], s75 offen offset:3072 sc1
 s_waitcnt lgkmcnt(0)
 v_add_f32 v228, v228, v120
 v_add_f32 v229, v229, v121
 v_add_f32 v230, v230, v122
 v_add_f32 v231, v231, v123
 v_cvt_pk_bf16_f32 v32, v228, v229
 v_cvt_pk_bf16_f32 v33, v230, v231
 s_branch kd_x1
kd_x0:
 ds_write_b128 v232, v[196:199] offset:0
 ds_write_b128 v232, v[200:203] offset:1024
 ds_write_b128 v232, v[204:207] offset:2048
 ds_write_b128 v232, v[208:211] offset:3072
 ds_write_b128 v232, v[212:215] offset:4096
 ds_write_b128 v232, v[216:219] offset:5120
 ds_write_b128 v232, v[220:223] offset:6144
 ds_write_b128 v232, v[224:227] offset:7168
 ds_write_b128 v232, v[228:231] offset:8192
 s_waitcnt lgkmcnt(0)
 s_barrier
 ds_read_b128 v[88:91], v233 offset:0
 ds_read_b128 v[92:95], v233 offset:1024
 ds_read_b128 v[96:99], v233 offset:2048
 ds_read_b128 v[100:103], v233 offset:3072
 ds_read_b128 v[104:107], v233 offset:4096
 ds_read_b128 v[108:111], v233 offset:5120
 ds_read_b128 v[112:115], v233 offset:6144
 ds_read_b128 v[116:119], v233 offset:7168
 ds_read_b128 v[120:123], v233 offset:8192
 s_waitcnt lgkmcnt(8)
 v_add_f32 v160, v160, v88
 v_add_f32 v161, v161, v89
 v_add_f32 v162, v162, v90
 v_add_f32 v163, v163, v91
 v_cvt_pk_bf16_f32 v16, v160, v161
 v_cvt_pk_bf16_f32 v17, v162, v163
 s_waitcnt lgkmcnt(7)
 v_add_f32 v164, v164, v92
 v_add_f32 v165, v165, v93
 v_add_f32 v166, v166, v94
 v_add_f32 v167, v167, v95
 v_cvt_pk_bf16_f32 v18, v164, v165
 v_cvt_pk_bf16_f32 v19, v166, v167
 buffer_store_dwordx4 v[16:19], v234, s[32:35], s75 offen offset:0 sc1
 s_waitcnt lgkmcnt(6)
 v_add_f32 v168, v168, v96
 v_add_f32 v169, v169, v97
 v_add_f32 v170, v170, v98
 v_add_f32 v171, v171, v99
 v_cvt_pk_bf16_f32 v20, v168, v169
 v_cvt_pk_bf16_f32 v21, v170, v171
 s_waitcnt lgkmcnt(5)
 v_add_f32 v172, v172, v100
 v_add_f32 v173, v173, v101
 v_add_f32 v174, v174, v102
 v_add_f32 v175, v175, v103
 v_cvt_pk_bf16_f32 v22, v172, v173
 v_cvt_pk_bf16_f32 v23, v174, v175
 buffer_store_dwordx4 v[20:23], v234, s[32:35], s75 offen offset:1024 sc1
 s_waitcnt lgkmcnt(4)
 v_add_f32 v176, v176, v104
 v_add_f32 v177, v177, v105
 v_add_f32 v178, v178, v106
 v_add_f32 v179, v179, v107
 v_cvt_pk_bf16_f32 v24, v176, v177
 v_cvt_pk_bf16_f32 v25, v178, v179
 s_waitcnt lgkmcnt(3)
 v_add_f32 v180, v180, v108
 v_add_f32 v181, v181, v109
 v_add_f32 v182, v182, v110
 v_add_f32 v183, v183, v111
 v_cvt_pk_bf16_f32 v26, v180, v181
 v_cvt_pk_bf16_f32 v27, v182, v183
 buffer_store_dwordx4 v[24:27], v234, s[32:35], s75 offen offset:2048 sc1
 s_waitcnt lgkmcnt(2)
 v_add_f32 v184, v184, v112
 v_add_f32 v185, v185, v113
 v_add_f32 v186, v186, v114
 v_add_f32 v187, v187, v115
 v_cvt_pk_bf16_f32 v28, v184, v185
 v_cvt_pk_bf16_f32 v29, v186, v187
 s_waitcnt lgkmcnt(1)
 v_add_f32 v188, v188, v116
 v_add_f32 v189, v189, v117
 v_add_f32 v190, v190, v118
 v_add_f32 v191, v191, v119
 v_cvt_pk_bf16_f32 v30, v188, v189
 v_cvt_pk_bf16_f32 v31, v190, v191
 buffer_store_dwordx4 v[28:31], v234, s[32:35], s75 offen offset:3072 sc1
 s_waitcnt lgkmcnt(0)
 v_add_f32 v192, v192, v120
 v_add_f32 v193, v193, v121
 v_add_f32 v194, v194, v122
 v_add_f32 v195, v195, v123
 v_cvt_pk_bf16_f32 v32, v192, v193
 v_cvt_pk_bf16_f32 v33, v194, v195
kd_x1:
 buffer_store_dwordx2 v[32:33], v235, s[32:35], s75 offen sc1
 v_mov_b32 v9, s101
 v_mov_b32 v10, 0
 s_mov_b32 s53, 0
 s_waitcnt vmcnt(0)
 s_mov_b64 exec, 1
 buffer_store_dword v9, v10, s[76:79], s57 offen sc1
 s_mov_b64 exec, -1
 s_cmp_lg_u32 s73, 0
 s_cbranch_scc1 kd_nopf
 s_load_dwordx4 s[12:15], s[0:1], 24
 v_and_b32 v124, 63, v0
 v_lshrrev_b32 v125, 3, v124
 v_and_b32 v126, 7, v124
 v_lshrrev_b32 v127, 1, v125
 v_xor_b32 v127, v127, v126
 v_lshlrev_b32 v127, 4, v127
 v_lshrrev_b32 v128, 2, v125
 v_and_b32 v126, 3, v125
 v_lshl_add_u32 v128, v128, 3, v126
 v_mul_u32_u24 v128, 1152, v128
 v_add_u32 v129, v128, v127
 v_xor_b32 v126, 64, v127
 v_add_u32 v130, v128, v126
 v_mul_u32_u24 v128, 1152, v125
 v_add_u32 v131, v128, v127
 s_lshr_b32 s4, s2, 4
 s_waitcnt lgkmcnt(0)
 s_cmp_ge_u32 s4, 8
 s_cselect_b32 s8, s14, s12
 s_cselect_b32 s9, s15, s13
 s_and_b32 s9, s9, 0xffff
 s_mov_b32 s10, 663552
 s_mov_b32 s11, 0x00020000
 s_and_b32 s4, s4, 7
 s_mul_i32 s12, s4, 82944
 s_lshl_b32 s13, s20, 7
 s_add_u32 s12, s12, s13
 s_mul_i32 s13, s20, 9216
 s_add_u32 m0, s13, 73728
 s_add_u32 s14, s12, 0
 buffer_load_dwordx4 v129, s[8:11], s14 offen lds
 s_add_u32 m0, s13, 74752
 s_add_u32 s14, s12, 18432
 buffer_load_dwordx4 v130, s[8:11], s14 offen lds
 s_add_u32 m0, s13, 75776
 s_add_u32 s14, s12, 4608
 buffer_load_dwordx4 v129, s[8:11], s14 offen lds
 s_add_u32 m0, s13, 76800
 s_add_u32 s14, s12, 23040
 buffer_load_dwordx4 v130, s[8:11], s14 offen lds
 s_add_u32 m0, s13, 77824
 s_add_u32 s14, s12, 36864
 buffer_load_dwordx4 v129, s[8:11], s14 offen lds
 s_add_u32 m0, s13, 78848
 s_add_u32 s14, s12, 55296
 buffer_load_dwordx4 v130, s[8:11], s14 offen lds
 s_add_u32 m0, s13, 79872
 s_add_u32 s14, s12, 41472
 buffer_load_dwordx4 v129, s[8:11], s14 offen lds
 s_add_u32 m0, s13, 80896
 s_add_u32 s14, s12, 59904
 buffer_load_dwordx4 v130, s[8:11], s14 offen lds
 s_add_u32 m0, s13, 81920
 s_add_u32 s14, s12, 73728
 buffer_load_dwordx4 v131, s[8:11], s14 offen lds
kd_nopf:
 s_mov_b64 exec, 1
kd_poll:
 buffer_load_dwordx4 v[108:111], v10, s[76:79], s56 offen sc1
 s_add_u32 s53, s53, 1
 s_waitcnt vmcnt(0)
 v_xor_b32 v108, s101, v108
 v_xor_b32 v109, s101, v109
 v_xor_b32 v110, s101, v110
 v_xor_b32 v111, s101, v111
 v_or_b32 v108, v108, v109
 v_or_b32 v110, v110, v111
 v_or_b32 v108, v108, v110
 s_nop 0
 v_readfirstlane_b32 s54, v108
 s_cmp_ge_u32 s53, 0x40000
 s_cbranch_scc1 kd_pollx
 s_cmp_eq_u32 s54, 0
 s_cbranch_scc1 kd_pollx
 s_sleep 4
 s_branch kd_poll
kd_pollx:
 s_mov_b64 exec, -1
 buffer_load_dwordx4 v[16:19], v234, s[32:35], s6 offen sc1
 buffer_load_dwordx2 v[20:21], v235, s[32:35], s7 offen sc1
 s_add_u32 s6, s6, 36864
 s_add_u32 s7, s7, 36864
 buffer_load_dwordx4 v[22:25], v234, s[32:35], s6 offen sc1
 buffer_load_dwordx2 v[26:27], v235, s[32:35], s7 offen sc1
 s_add_u32 s6, s6, 36864
 s_add_u32 s7, s7, 36864
 buffer_load_dwordx4 v[28:31], v234, s[32:35], s6 offen sc1
 buffer_load_dwordx2 v[32:33], v235, s[32:35], s7 offen sc1
 s_add_u32 s6, s6, 36864
 s_add_u32 s7, s7, 36864
 buffer_load_dwordx4 v[34:37], v234, s[32:35], s6 offen sc1
 buffer_load_dwordx2 v[38:39], v235, s[32:35], s7 offen sc1
 v_mov_b32 v120, 0
 v_mov_b32 v121, 0
 v_lshlrev_b32 v60, 16, v248
 v_and_b32 v61, s58, v248
 v_lshlrev_b32 v62, 16, v249
 v_and_b32 v63, s58, v249
 v_lshlrev_b32 v64, 16, v250
 v_and_b32 v65, s58, v250
 v_lshlrev_b32 v66, 16, v251
 v_and_b32 v67, s58, v251
 v_lshlrev_b32 v68, 16, v252
 v_and_b32 v69, s58, v252
 v_lshlrev_b32 v70, 16, v253
 v_and_b32 v71, s58, v253
 s_waitcnt vmcnt(0)
 v_lshlrev_b32 v40, 16, v16
 v_and_b32 v41, s58, v16
 v_lshlrev_b32 v42, 16, v22
 v_and_b32 v43, s58, v22
 v_lshlrev_b32 v44, 16, v28
 v_and_b32 v45, s58, v28
 v_lshlrev_b32 v46, 16, v34
 v_and_b32 v47, s58, v34
 v_add_f32 v40, v40, v42
 v_add_f32 v41, v41, v43
 v_add_f32 v44, v44, v46
 v_add_f32 v45, v45, v47
 v_add_f32 v40, v40, v44
 v_add_f32 v41, v41, v45
 v_cvt_pk_bf16_f32 v48, v40, v41
 v_lshlrev_b32 v40, 16, v48
 v_and_b32 v41, s58, v48
 v_add_f32 v40, v40, v60
 v_add_f32 v41, v41, v61
 v_cvt_pk_bf16_f32 v248, v40, v41
 v_lshlrev_b32 v40, 16, v248
 v_and_b32 v41, s58, v248
 v_add_f32 v120, v120, v40
 v_fmac_f32 v121, v40, v40
 v_add_f32 v120, v120, v41
 v_fmac_f32 v121, v41, v41
 v_lshlrev_b32 v40, 16, v17
 v_and_b32 v41, s58, v17
 v_lshlrev_b32 v42, 16, v23
 v_and_b32 v43, s58, v23
 v_lshlrev_b32 v44, 16, v29
 v_and_b32 v45, s58, v29
 v_lshlrev_b32 v46, 16, v35
 v_and_b32 v47, s58, v35
 v_add_f32 v40, v40, v42
 v_add_f32 v41, v41, v43
 v_add_f32 v44, v44, v46
 v_add_f32 v45, v45, v47
 v_add_f32 v40, v40, v44
 v_add_f32 v41, v41, v45
 v_cvt_pk_bf16_f32 v48, v40, v41
 v_lshlrev_b32 v40, 16, v48
 v_and_b32 v41, s58, v48
 v_add_f32 v40, v40, v62
 v_add_f32 v41, v41, v63
 v_cvt_pk_bf16_f32 v249, v40, v41
 v_lshlrev_b32 v40, 16, v249
 v_and_b32 v41, s58, v249
 v_add_f32 v120, v120, v40
 v_fmac_f32 v121, v40, v40
 v_add_f32 v120, v120, v41
 v_fmac_f32 v121, v41, v41
 v_lshlrev_b32 v40, 16, v18
 v_and_b32 v41, s58, v18
 v_lshlrev_b32 v42, 16, v24
 v_and_b32 v43, s58, v24
 v_lshlrev_b32 v44, 16, v30
 v_and_b32 v45, s58, v30
 v_lshlrev_b32 v46, 16, v36
 v_and_b32 v47, s58, v36
 v_add_f32 v40, v40, v42
 v_add_f32 v41, v41, v43
 v_add_f32 v44, v44, v46
 v_add_f32 v45, v45, v47
 v_add_f32 v40, v40, v44
 v_add_f32 v41, v41, v45
 v_cvt_pk_bf16_f32 v48, v40, v41
 v_lshlrev_b32 v40, 16, v48
 v_and_b32 v41, s58, v48
 v_add_f32 v40, v40, v64
 v_add_f32 v41, v41, v65
 v_cvt_pk_bf16_f32 v250, v40, v41
 v_lshlrev_b32 v40, 16, v250
 v_and_b32 v41, s58, v250
 v_add_f32 v120, v120, v40
 v_fmac_f32 v121, v40, v40
 v_add_f32 v120, v120, v41
 v_fmac_f32 v121, v41, v41
 v_lshlrev_b32 v40, 16, v19
 v_and_b32 v41, s58, v19
 v_lshlrev_b32 v42, 16, v25
 v_and_b32 v43, s58, v25
 v_lshlrev_b32 v44, 16, v31
 v_and_b32 v45, s58, v31
 v_lshlrev_b32 v46, 16, v37
 v_and_b32 v47, s58, v37
 v_add_f32 v40, v40, v42
 v_add_f32 v41, v41, v43
 v_add_f32 v44, v44, v46
 v_add_f32 v45, v45, v47
 v_add_f32 v40, v40, v44
 v_add_f32 v41, v41, v45
 v_cvt_pk_bf16_f32 v48, v40, v41
 v_lshlrev_b32 v40, 16, v48
 v_and_b32 v41, s58, v48
 v_add_f32 v40, v40, v66
 v_add_f32 v41, v41, v67
 v_cvt_pk_bf16_f32 v251, v40, v41
 v_lshlrev_b32 v40, 16, v251
 v_and_b32 v41, s58, v251
 v_add_f32 v120, v120, v40
 v_fmac_f32 v121, v40, v40
 v_add_f32 v120, v120, v41
 v_fmac_f32 v121, v41, v41
 buffer_store_dwordx4 v[248:251], v246, s[40:43], s16 offen sc1
 v_lshlrev_b32 v40, 16, v20
 v_and_b32 v41, s58, v20
 v_lshlrev_b32 v42, 16, v26
 v_and_b32 v43, s58, v26
 v_lshlrev_b32 v44, 16, v32
 v_and_b32 v45, s58, v32
 v_lshlrev_b32 v46, 16, v38
 v_and_b32 v47, s58, v38
 v_add_f32 v40, v40, v42
 v_add_f32 v41, v41, v43
 v_add_f32 v44, v44, v46
 v_add_f32 v45, v45, v47
 v_add_f32 v40, v40, v44
 v_add_f32 v41, v41, v45
 v_cvt_pk_bf16_f32 v48, v40, v41
 v_lshlrev_b32 v40, 16, v48
 v_and_b32 v41, s58, v48
 v_add_f32 v40, v40, v68
 v_add_f32 v41, v41, v69
 v_cvt_pk_bf16_f32 v252, v40, v41
 v_lshlrev_b32 v40, 16, v252
 v_and_b32 v41, s58, v252
 v_add_f32 v120, v120, v40
 v_fmac_f32 v121, v40, v40
 v_add_f32 v120, v120, v41
 v_fmac_f32 v121, v41, v41
 v_lshlrev_b32 v40, 16, v21
 v_and_b32 v41, s58, v21
 v_lshlrev_b32 v42, 16, v27
 v_and_b32 v43, s58, v27
 v_lshlrev_b32 v44, 16, v33
 v_and_b32 v45, s58, v33
 v_lshlrev_b32 v46, 16, v39
 v_and_b32 v47, s58, v39
 v_add_f32 v40, v40, v42
 v_add_f32 v41, v41, v43
 v_add_f32 v44, v44, v46
 v_add_f32 v45, v45, v47
 v_add_f32 v40, v40, v44
 v_add_f32 v41, v41, v45
 v_cvt_pk_bf16_f32 v48, v40, v41
 v_lshlrev_b32 v40, 16, v48
 v_and_b32 v41, s58, v48
 v_add_f32 v40, v40, v70
 v_add_f32 v41, v41, v71
 v_cvt_pk_bf16_f32 v253, v40, v41
 v_lshlrev_b32 v40, 16, v253
 v_and_b32 v41, s58, v253
 v_add_f32 v120, v120, v40
 v_fmac_f32 v121, v40, v40
 v_add_f32 v120, v120, v41
 v_fmac_f32 v121, v41, v41
 buffer_store_dwordx2 v[252:253], v247, s[40:43], s17 offen sc1
 v_mov_b32 v44, v120
 v_mov_b32 v45, v121
 s_nop 1
 v_permlane16_swap_b32 v120, v44
 v_permlane16_swap_b32 v121, v45
 s_nop 1
 v_add_f32 v120, v120, v44
 v_add_f32 v121, v121, v45
 v_mov_b32 v44, v120
 v_mov_b32 v45, v121
 s_nop 1
 v_permlane32_swap_b32 v120, v44
 v_permlane32_swap_b32 v121, v45
 s_nop 1
 v_add_f32 v120, v120, v44
 v_add_f32 v121, v121, v45
 s_mov_b64 exec, 0xffff
 buffer_store_dwordx2 v[120:121], v238, s[60:63], s59 offen sc1
 s_mov_b64 exec, -1
 v_mov_b32 v9, s101
 v_mov_b32 v10, 0
 s_waitcnt vmcnt(0)
 s_mov_b64 exec, 1
 buffer_store_dword v9, v10, s[76:79], s67 offen sc1
 s_mov_b64 exec, -1
kd_end:
 s_cmp_eq_u32 s100, 3
 s_cbranch_scc1 mega_p4
 s_endpgm
.section .rodata,"a"
.p2align 6
.amdhsa_kernel mega_kernel
  .amdhsa_next_free_vgpr 256
  .amdhsa_next_free_sgpr 102
  .amdhsa_accum_offset 256
  .amdhsa_group_segment_fixed_size 0
  .amdhsa_kernarg_size 96
  .amdhsa_user_sgpr_count 2
  .amdhsa_user_sgpr_kernarg_segment_ptr 1
  .amdhsa_system_sgpr_workgroup_id_x 1
.end_amdhsa_kernel
```
